```python
import torch

def _softmax(x, axis=-1):
    return torch.softmax(x, dim=axis)

def _gelu(x):
    return torch.nn.functional.gelu(x, approximate='tanh')

def _silu(x):
    return torch.nn.functional.silu(x)

def _sigmoid(x):
    return torch.sigmoid(x)

def _layernorm(x, axis=-1, eps=1e-05):
    m = x.mean(dim=axis, keepdim=True)
    v = x.var(dim=axis, keepdim=True, unbiased=False)
    return (x - m) / torch.sqrt(v + eps)

def _scatter_add(tgt, idx, src, axis=0):
    return tgt.clone().index_add_(axis, idx, src)

def _segment_sum(src, seg, n):
    out = torch.zeros((n,) + src.shape[1:], dtype=src.dtype)
    return out.index_add_(0, seg, src)

def _pad(x, pw):
    flat = tuple((v for pair in reversed(pw) for v in pair))
    return torch.nn.functional.pad(x, flat)
kernel_name = 'recurrent_scan__memory_aug_recurrent_mem_tr__dense_activation_gelu__prompt'

def setup_inputs():

    _w = lambda a: (lambda t: t.to(torch.bfloat16) if t.is_floating_point() else t)(torch.as_tensor(a))

    def _A_setup():
        B, S, Dm = (1, 2048, 640)
        H, Dh = (32, 192)
        M, seg = (8, 32)
        seg = min(seg, S)
        S = S // seg * seg
        return {'x': _w((lambda *s: torch.randn(*s, dtype=torch.bfloat16) * 0.1)(B, S, Dm)), 'mem0': _w((lambda *s: torch.randn(*s, dtype=torch.bfloat16) * 1.6)(B, M, Dm)), 'Wq': _w((lambda *s: torch.randn(*s, dtype=torch.bfloat16) * 0.8)(Dm, H, Dh) * Dm ** (-0.5)), 'Wk': _w((lambda *s: torch.randn(*s, dtype=torch.bfloat16) * 0.8)(Dm, H, Dh) * Dm ** (-0.5)), 'Wv': _w((lambda *s: torch.randn(*s, dtype=torch.bfloat16) * 1.6)(Dm, H, Dh) * Dm ** (-0.5)), 'Wo': _w((lambda *s: torch.randn(*s, dtype=torch.bfloat16) * 1.6)(H, Dh, Dm) * (H * Dh) ** (-0.5)), 'seg_len': seg}
    _A_in = _A_setup()

    def _B_setup():
        B, S, D, F = (1, 2048, 640, 1536)
        return {'x': _w((lambda *s: torch.randn(*s, dtype=torch.bfloat16) * 0.1)(B, S, D)), 'w1': _w((lambda *s: torch.randn(*s, dtype=torch.bfloat16) * 0.4)(D, F) * D ** (-0.5)), 'b1': _w((lambda *s: torch.randn(*s, dtype=torch.bfloat16) * 0.4)(F) * 0.01), 'w2': _w((lambda *s: torch.randn(*s, dtype=torch.bfloat16) * 0.4)(F, D) * F ** (-0.5)), 'b2': _w((lambda *s: torch.randn(*s, dtype=torch.bfloat16) * 0.4)(D) * 0.01)}
    _B_in = _B_setup()
    return {'A_x': _A_in['x'], 'A_mem0': _A_in['mem0'], 'A_Wq': _A_in['Wq'], 'A_Wk': _A_in['Wk'], 'A_Wv': _A_in['Wv'], 'A_Wo': _A_in['Wo'], 'A_seg_len': _A_in['seg_len'], 'B_x': _B_in['x'], 'B_w1': _B_in['w1'], 'B_b1': _B_in['b1'], 'B_w2': _B_in['w2'], 'B_b2': _B_in['b2']}

def reference(A_x, A_mem0, A_Wq, A_Wk, A_Wv, A_Wo, A_seg_len, B_x, B_w1, B_b1, B_w2, B_b2):

    def _A_ref(x, mem0, Wq, Wk, Wv, Wo, seg_len):
        B, S, Dm = x.shape
        H, Dh = (Wq.shape[1], Wq.shape[2])
        M = mem0.shape[1]
        scale = Dh ** (-0.5)
        n_seg = S // seg_len
        L = M + seg_len
        idx = torch.arange(L)
        mask = (idx[:, None] < M) | (idx[:, None] >= idx[None, :])
        mem = mem0
        outs = []
        for s in range(n_seg):
            xs = x[:, s * seg_len:(s + 1) * seg_len, :].clone()
            h = torch.concatenate([mem, xs], axis=1)
            q = torch.einsum('btd,dhe->bhte', h, Wq)
            k = torch.einsum('btd,dhe->bhte', h, Wk)
            v = torch.einsum('btd,dhe->bhte', h, Wv)
            scores = torch.einsum('bhqe,bhke->bhqk', q, k) * scale
            scores = torch.where(mask[None, None], scores, -1000000000.0)
            p = _softmax(scores, axis=-1)
            o = torch.einsum('bhqk,bhke->bhqe', p, v)
            o = torch.einsum('bhte,hed->btd', o, Wo)
            mem = o[:, :M, :].clone()
            outs.append(o[:, M:, :])
        return torch.concatenate(outs, axis=1)

    def _B_ref(x, w1, b1, w2, b2):
        h = torch.einsum('bsd,df->bsf', x, w1) + b1
        h = _gelu(h)
        return torch.einsum('bsf,fd->bsd', h, w2) + b2
    x = A_x
    xn = _layernorm(x, axis=-1)
    s = _A_ref(xn, A_mem0, A_Wq, A_Wk, A_Wv, A_Wo, A_seg_len)
    g = _silu(_B_ref(xn, B_w1, B_b1, B_w2, B_b2))
    return x + s * g
```

```asm
; @launch kernel=prep_kernel grid=(256,1,1) block=(256,1,1) lds=0
; @launch kernel=main_kernel grid=(256,1,1) block=(256,1,1) lds=163840
.amdgcn_target "amdgcn-amd-amdhsa--gfx950"
.text
.globl prep_kernel
.p2align 8
.type prep_kernel,@function
prep_kernel:
  s_cmp_ge_u32 s2, 256
  s_cbranch_scc1 prep_done
  s_load_dwordx16 s[64:79], s[0:1], 0
  s_load_dwordx8 s[80:87], s[0:1], 64
  s_load_dwordx2 s[88:89], s[0:1], 96
  s_load_dwordx2 s[90:91], s[0:1], 112
  v_and_b32 v1, 63, v0
  v_lshrrev_b32 v2, 6, v0
  s_nop 0
  v_readfirstlane_b32 s56, v2
  s_waitcnt lgkmcnt(0)
  s_mov_b32 s4, s64
  s_and_b32 s5, s65, 65535
  s_mov_b32 s6, 2621440
  s_mov_b32 s7, 131072
  s_mov_b32 s8, s66
  s_and_b32 s9, s67, 65535
  s_mov_b32 s10, 10240
  s_mov_b32 s11, 131072
  s_mov_b32 s12, s68
  s_and_b32 s13, s69, 65535
  s_mov_b32 s14, 7864320
  s_mov_b32 s15, 131072
  s_mov_b32 s16, s70
  s_and_b32 s17, s71, 65535
  s_mov_b32 s18, 7864320
  s_mov_b32 s19, 131072
  s_mov_b32 s20, s72
  s_and_b32 s21, s73, 65535
  s_mov_b32 s22, 7864320
  s_mov_b32 s23, 131072
  s_mov_b32 s24, s74
  s_and_b32 s25, s75, 65535
  s_mov_b32 s26, 7864320
  s_mov_b32 s27, 131072
  s_mov_b32 s28, s80
  s_and_b32 s29, s81, 65535
  s_mov_b32 s30, 1966080
  s_mov_b32 s31, 131072
  s_mov_b32 s32, s82
  s_and_b32 s33, s83, 65535
  s_mov_b32 s34, 3072
  s_mov_b32 s35, 131072
  s_mov_b32 s36, s84
  s_and_b32 s37, s85, 65535
  s_mov_b32 s38, 1966080
  s_mov_b32 s39, 131072
  s_mov_b32 s40, s86
  s_and_b32 s41, s87, 65535
  s_mov_b32 s42, 1280
  s_mov_b32 s43, 131072
  s_mov_b32 s44, s88
  s_and_b32 s45, s89, 65535
  s_mov_b32 s46, 2621440
  s_mov_b32 s47, 131072
  s_mov_b32 s48, s90
  s_and_b32 s49, s91, 65535
  s_mov_b32 s50, 268435456
  s_mov_b32 s51, 131072
  s_mov_b32 s52, s68
  s_and_b32 s53, s69, 65535
  s_mov_b32 s54, 7864320
  s_mov_b32 s55, 131072
  s_lshl_b32 s57, s2, 2
  s_add_u32 s57, s57, s56
  s_lshl_b32 s57, s57, 1
  s_mul_i32 s57, s57, 1280
  v_lshlrev_b32 v2, 2, v1
  buffer_load_dword v4, v2, s[4:7], s57 offen offset:0
  buffer_load_dword v5, v2, s[4:7], s57 offen offset:256
  buffer_load_dword v6, v2, s[4:7], s57 offen offset:512
  buffer_load_dword v7, v2, s[4:7], s57 offen offset:768
  buffer_load_dword v8, v2, s[4:7], s57 offen offset:1024
  buffer_load_dword v9, v2, s[4:7], s57 offen offset:1280
  buffer_load_dword v10, v2, s[4:7], s57 offen offset:1536
  buffer_load_dword v11, v2, s[4:7], s57 offen offset:1792
  buffer_load_dword v12, v2, s[4:7], s57 offen offset:2048
  buffer_load_dword v13, v2, s[4:7], s57 offen offset:2304
  v_lshrrev_b32 v36, 4, v1
  v_lshlrev_b32 v36, 11, v36
  v_bfe_u32 v37, v1, 2, 2
  v_lshl_add_u32 v36, v37, 8, v36
  v_and_b32 v37, 3, v1
  v_lshl_add_u32 v36, v37, 2, v36
  s_lshl_b32 s58, s2, 2
  s_add_u32 s58, s58, s56
  s_lshl_b32 s58, s58, 1
  s_lshr_b32 s59, s58, 5
  s_mul_i32 s59, s59, 40960
  s_bfe_u32 s60, s58, 65538
  s_lshl_b32 s60, s60, 10
  s_add_u32 s59, s59, s60
  s_bfe_u32 s60, s58, 131075
  s_lshl_b32 s60, s60, 6
  s_add_u32 s59, s59, s60
  s_and_b32 s60, s58, 3
  s_lshl_b32 s60, s60, 4
  s_add_u32 s59, s59, s60
  s_add_u32 s63, s59, 36122624
  s_waitcnt vmcnt(5)
  v_lshlrev_b32 v20, 16, v4
  v_and_b32 v21, 4294901760, v4
  v_lshlrev_b32 v22, 16, v5
  v_and_b32 v23, 4294901760, v5
  v_lshlrev_b32 v24, 16, v6
  v_and_b32 v25, 4294901760, v6
  v_lshlrev_b32 v26, 16, v7
  v_and_b32 v27, 4294901760, v7
  v_lshlrev_b32 v28, 16, v8
  v_and_b32 v29, 4294901760, v8
  v_add_f32 v30, v20, v21
  v_add_f32 v30, v30, v22
  v_add_f32 v30, v30, v23
  v_add_f32 v30, v30, v24
  v_add_f32 v30, v30, v25
  v_add_f32 v30, v30, v26
  v_add_f32 v30, v30, v27
  v_add_f32 v30, v30, v28
  v_add_f32 v30, v30, v29
  s_nop 1
  v_add_f32_dpp v31, v30, v30 quad_perm:[1,0,3,2] row_mask:0xf bank_mask:0xf
  v_mov_b32 v30, v31
  s_nop 1
  v_add_f32_dpp v31, v30, v30 quad_perm:[2,3,0,1] row_mask:0xf bank_mask:0xf
  v_mov_b32 v30, v31
  s_nop 1
  v_add_f32_dpp v31, v30, v30 row_half_mirror row_mask:0xf bank_mask:0xf
  v_mov_b32 v30, v31
  s_nop 1
  v_add_f32_dpp v31, v30, v30 row_mirror row_mask:0xf bank_mask:0xf
  v_mov_b32 v30, v31
  s_nop 0
  v_readlane_b32 s59, v30, 0
  v_readlane_b32 s60, v30, 16
  v_readlane_b32 s61, v30, 32
  v_readlane_b32 s62, v30, 48
  v_mov_b32 v30, s59
  v_add_f32 v30, s60, v30
  v_add_f32 v30, s61, v30
  v_add_f32 v30, s62, v30
  v_mul_f32 v32, 986500301, v30
  v_sub_f32 v31, v20, v32
  v_mul_f32 v30, v31, v31
  v_sub_f32 v31, v21, v32
  v_fmac_f32 v30, v31, v31
  v_sub_f32 v31, v22, v32
  v_fmac_f32 v30, v31, v31
  v_sub_f32 v31, v23, v32
  v_fmac_f32 v30, v31, v31
  v_sub_f32 v31, v24, v32
  v_fmac_f32 v30, v31, v31
  v_sub_f32 v31, v25, v32
  v_fmac_f32 v30, v31, v31
  v_sub_f32 v31, v26, v32
  v_fmac_f32 v30, v31, v31
  v_sub_f32 v31, v27, v32
  v_fmac_f32 v30, v31, v31
  v_sub_f32 v31, v28, v32
  v_fmac_f32 v30, v31, v31
  v_sub_f32 v31, v29, v32
  v_fmac_f32 v30, v31, v31
  s_nop 1
  v_add_f32_dpp v31, v30, v30 quad_perm:[1,0,3,2] row_mask:0xf bank_mask:0xf
  v_mov_b32 v30, v31
  s_nop 1
  v_add_f32_dpp v31, v30, v30 quad_perm:[2,3,0,1] row_mask:0xf bank_mask:0xf
  v_mov_b32 v30, v31
  s_nop 1
  v_add_f32_dpp v31, v30, v30 row_half_mirror row_mask:0xf bank_mask:0xf
  v_mov_b32 v30, v31
  s_nop 1
  v_add_f32_dpp v31, v30, v30 row_mirror row_mask:0xf bank_mask:0xf
  v_mov_b32 v30, v31
  s_nop 0
  v_readlane_b32 s59, v30, 0
  v_readlane_b32 s60, v30, 16
  v_readlane_b32 s61, v30, 32
  v_readlane_b32 s62, v30, 48
  v_mov_b32 v30, s59
  v_add_f32 v30, s60, v30
  v_add_f32 v30, s61, v30
  v_add_f32 v30, s62, v30
  v_mul_f32 v33, 986500301, v30
  v_cvt_pk_bf16_f32 v32, v32, v32
  v_lshlrev_b32 v32, 16, v32
  v_cvt_pk_bf16_f32 v33, v33, v33
  v_lshlrev_b32 v33, 16, v33
  v_add_f32 v33, 925353388, v33
  v_cvt_pk_bf16_f32 v33, v33, v33
  v_lshlrev_b32 v33, 16, v33
  v_sqrt_f32 v33, v33
  s_nop 0
  v_cvt_pk_bf16_f32 v33, v33, v33
  v_lshlrev_b32 v33, 16, v33
  v_rcp_f32 v34, v33
  v_sub_f32 v20, v20, v32
  v_cvt_pk_bf16_f32 v20, v20, v20
  v_lshlrev_b32 v20, 16, v20
  v_mul_f32 v31, v20, v34
  v_fma_f32 v20, -v31, v33, v20
  v_fma_f32 v20, v20, v34, v31
  v_sub_f32 v21, v21, v32
  v_cvt_pk_bf16_f32 v21, v21, v21
  v_lshlrev_b32 v21, 16, v21
  v_mul_f32 v31, v21, v34
  v_fma_f32 v21, -v31, v33, v21
  v_fma_f32 v21, v21, v34, v31
  v_sub_f32 v22, v22, v32
  v_cvt_pk_bf16_f32 v22, v22, v22
  v_lshlrev_b32 v22, 16, v22
  v_mul_f32 v31, v22, v34
  v_fma_f32 v22, -v31, v33, v22
  v_fma_f32 v22, v22, v34, v31
  v_sub_f32 v23, v23, v32
  v_cvt_pk_bf16_f32 v23, v23, v23
  v_lshlrev_b32 v23, 16, v23
  v_mul_f32 v31, v23, v34
  v_fma_f32 v23, -v31, v33, v23
  v_fma_f32 v23, v23, v34, v31
  v_sub_f32 v24, v24, v32
  v_cvt_pk_bf16_f32 v24, v24, v24
  v_lshlrev_b32 v24, 16, v24
  v_mul_f32 v31, v24, v34
  v_fma_f32 v24, -v31, v33, v24
  v_fma_f32 v24, v24, v34, v31
  v_sub_f32 v25, v25, v32
  v_cvt_pk_bf16_f32 v25, v25, v25
  v_lshlrev_b32 v25, 16, v25
  v_mul_f32 v31, v25, v34
  v_fma_f32 v25, -v31, v33, v25
  v_fma_f32 v25, v25, v34, v31
  v_sub_f32 v26, v26, v32
  v_cvt_pk_bf16_f32 v26, v26, v26
  v_lshlrev_b32 v26, 16, v26
  v_mul_f32 v31, v26, v34
  v_fma_f32 v26, -v31, v33, v26
  v_fma_f32 v26, v26, v34, v31
  v_sub_f32 v27, v27, v32
  v_cvt_pk_bf16_f32 v27, v27, v27
  v_lshlrev_b32 v27, 16, v27
  v_mul_f32 v31, v27, v34
  v_fma_f32 v27, -v31, v33, v27
  v_fma_f32 v27, v27, v34, v31
  v_sub_f32 v28, v28, v32
  v_cvt_pk_bf16_f32 v28, v28, v28
  v_lshlrev_b32 v28, 16, v28
  v_mul_f32 v31, v28, v34
  v_fma_f32 v28, -v31, v33, v28
  v_fma_f32 v28, v28, v34, v31
  v_sub_f32 v29, v29, v32
  v_cvt_pk_bf16_f32 v29, v29, v29
  v_lshlrev_b32 v29, 16, v29
  v_mul_f32 v31, v29, v34
  v_fma_f32 v29, -v31, v33, v29
  v_fma_f32 v29, v29, v34, v31
  v_cvt_pk_bf16_f32 v4, v20, v21
  s_add_u32 s58, s63, 0
  buffer_store_dword v4, v36, s[48:51], s58 offen
  v_cvt_pk_bf16_f32 v5, v22, v23
  s_add_u32 s58, s63, 8192
  buffer_store_dword v5, v36, s[48:51], s58 offen
  v_cvt_pk_bf16_f32 v6, v24, v25
  s_add_u32 s58, s63, 16384
  buffer_store_dword v6, v36, s[48:51], s58 offen
  v_cvt_pk_bf16_f32 v7, v26, v27
  s_add_u32 s58, s63, 24576
  buffer_store_dword v7, v36, s[48:51], s58 offen
  v_cvt_pk_bf16_f32 v8, v28, v29
  s_add_u32 s58, s63, 32768
  buffer_store_dword v8, v36, s[48:51], s58 offen
  s_waitcnt vmcnt(0)
  v_lshlrev_b32 v20, 16, v9
  v_and_b32 v21, 4294901760, v9
  v_lshlrev_b32 v22, 16, v10
  v_and_b32 v23, 4294901760, v10
  v_lshlrev_b32 v24, 16, v11
  v_and_b32 v25, 4294901760, v11
  v_lshlrev_b32 v26, 16, v12
  v_and_b32 v27, 4294901760, v12
  v_lshlrev_b32 v28, 16, v13
  v_and_b32 v29, 4294901760, v13
  v_add_f32 v30, v20, v21
  v_add_f32 v30, v30, v22
  v_add_f32 v30, v30, v23
  v_add_f32 v30, v30, v24
  v_add_f32 v30, v30, v25
  v_add_f32 v30, v30, v26
  v_add_f32 v30, v30, v27
  v_add_f32 v30, v30, v28
  v_add_f32 v30, v30, v29
  s_nop 1
  v_add_f32_dpp v31, v30, v30 quad_perm:[1,0,3,2] row_mask:0xf bank_mask:0xf
  v_mov_b32 v30, v31
  s_nop 1
  v_add_f32_dpp v31, v30, v30 quad_perm:[2,3,0,1] row_mask:0xf bank_mask:0xf
  v_mov_b32 v30, v31
  s_nop 1
  v_add_f32_dpp v31, v30, v30 row_half_mirror row_mask:0xf bank_mask:0xf
  v_mov_b32 v30, v31
  s_nop 1
  v_add_f32_dpp v31, v30, v30 row_mirror row_mask:0xf bank_mask:0xf
  v_mov_b32 v30, v31
  s_nop 0
  v_readlane_b32 s59, v30, 0
  v_readlane_b32 s60, v30, 16
  v_readlane_b32 s61, v30, 32
  v_readlane_b32 s62, v30, 48
  v_mov_b32 v30, s59
  v_add_f32 v30, s60, v30
  v_add_f32 v30, s61, v30
  v_add_f32 v30, s62, v30
  v_mul_f32 v32, 986500301, v30
  v_sub_f32 v31, v20, v32
  v_mul_f32 v30, v31, v31
  v_sub_f32 v31, v21, v32
  v_fmac_f32 v30, v31, v31
  v_sub_f32 v31, v22, v32
  v_fmac_f32 v30, v31, v31
  v_sub_f32 v31, v23, v32
  v_fmac_f32 v30, v31, v31
  v_sub_f32 v31, v24, v32
  v_fmac_f32 v30, v31, v31
  v_sub_f32 v31, v25, v32
  v_fmac_f32 v30, v31, v31
  v_sub_f32 v31, v26, v32
  v_fmac_f32 v30, v31, v31
  v_sub_f32 v31, v27, v32
  v_fmac_f32 v30, v31, v31
  v_sub_f32 v31, v28, v32
  v_fmac_f32 v30, v31, v31
  v_sub_f32 v31, v29, v32
  v_fmac_f32 v30, v31, v31
  s_nop 1
  v_add_f32_dpp v31, v30, v30 quad_perm:[1,0,3,2] row_mask:0xf bank_mask:0xf
  v_mov_b32 v30, v31
  s_nop 1
  v_add_f32_dpp v31, v30, v30 quad_perm:[2,3,0,1] row_mask:0xf bank_mask:0xf
  v_mov_b32 v30, v31
  s_nop 1
  v_add_f32_dpp v31, v30, v30 row_half_mirror row_mask:0xf bank_mask:0xf
  v_mov_b32 v30, v31
  s_nop 1
  v_add_f32_dpp v31, v30, v30 row_mirror row_mask:0xf bank_mask:0xf
  v_mov_b32 v30, v31
  s_nop 0
  v_readlane_b32 s59, v30, 0
  v_readlane_b32 s60, v30, 16
  v_readlane_b32 s61, v30, 32
  v_readlane_b32 s62, v30, 48
  v_mov_b32 v30, s59
  v_add_f32 v30, s60, v30
  v_add_f32 v30, s61, v30
  v_add_f32 v30, s62, v30
  v_mul_f32 v33, 986500301, v30
  v_cvt_pk_bf16_f32 v32, v32, v32
  v_lshlrev_b32 v32, 16, v32
  v_cvt_pk_bf16_f32 v33, v33, v33
  v_lshlrev_b32 v33, 16, v33
  v_add_f32 v33, 925353388, v33
  v_cvt_pk_bf16_f32 v33, v33, v33
  v_lshlrev_b32 v33, 16, v33
  v_sqrt_f32 v33, v33
  s_nop 0
  v_cvt_pk_bf16_f32 v33, v33, v33
  v_lshlrev_b32 v33, 16, v33
  v_rcp_f32 v34, v33
  v_sub_f32 v20, v20, v32
  v_cvt_pk_bf16_f32 v20, v20, v20
  v_lshlrev_b32 v20, 16, v20
  v_mul_f32 v31, v20, v34
  v_fma_f32 v20, -v31, v33, v20
  v_fma_f32 v20, v20, v34, v31
  v_sub_f32 v21, v21, v32
  v_cvt_pk_bf16_f32 v21, v21, v21
  v_lshlrev_b32 v21, 16, v21
  v_mul_f32 v31, v21, v34
  v_fma_f32 v21, -v31, v33, v21
  v_fma_f32 v21, v21, v34, v31
  v_sub_f32 v22, v22, v32
  v_cvt_pk_bf16_f32 v22, v22, v22
  v_lshlrev_b32 v22, 16, v22
  v_mul_f32 v31, v22, v34
  v_fma_f32 v22, -v31, v33, v22
  v_fma_f32 v22, v22, v34, v31
  v_sub_f32 v23, v23, v32
  v_cvt_pk_bf16_f32 v23, v23, v23
  v_lshlrev_b32 v23, 16, v23
  v_mul_f32 v31, v23, v34
  v_fma_f32 v23, -v31, v33, v23
  v_fma_f32 v23, v23, v34, v31
  v_sub_f32 v24, v24, v32
  v_cvt_pk_bf16_f32 v24, v24, v24
  v_lshlrev_b32 v24, 16, v24
  v_mul_f32 v31, v24, v34
  v_fma_f32 v24, -v31, v33, v24
  v_fma_f32 v24, v24, v34, v31
  v_sub_f32 v25, v25, v32
  v_cvt_pk_bf16_f32 v25, v25, v25
  v_lshlrev_b32 v25, 16, v25
  v_mul_f32 v31, v25, v34
  v_fma_f32 v25, -v31, v33, v25
  v_fma_f32 v25, v25, v34, v31
  v_sub_f32 v26, v26, v32
  v_cvt_pk_bf16_f32 v26, v26, v26
  v_lshlrev_b32 v26, 16, v26
  v_mul_f32 v31, v26, v34
  v_fma_f32 v26, -v31, v33, v26
  v_fma_f32 v26, v26, v34, v31
  v_sub_f32 v27, v27, v32
  v_cvt_pk_bf16_f32 v27, v27, v27
  v_lshlrev_b32 v27, 16, v27
  v_mul_f32 v31, v27, v34
  v_fma_f32 v27, -v31, v33, v27
  v_fma_f32 v27, v27, v34, v31
  v_sub_f32 v28, v28, v32
  v_cvt_pk_bf16_f32 v28, v28, v28
  v_lshlrev_b32 v28, 16, v28
  v_mul_f32 v31, v28, v34
  v_fma_f32 v28, -v31, v33, v28
  v_fma_f32 v28, v28, v34, v31
  v_sub_f32 v29, v29, v32
  v_cvt_pk_bf16_f32 v29, v29, v29
  v_lshlrev_b32 v29, 16, v29
  v_mul_f32 v31, v29, v34
  v_fma_f32 v29, -v31, v33, v29
  v_fma_f32 v29, v29, v34, v31
  v_cvt_pk_bf16_f32 v9, v20, v21
  s_add_u32 s58, s63, 16
  buffer_store_dword v9, v36, s[48:51], s58 offen
  v_cvt_pk_bf16_f32 v10, v22, v23
  s_add_u32 s58, s63, 8208
  buffer_store_dword v10, v36, s[48:51], s58 offen
  v_cvt_pk_bf16_f32 v11, v24, v25
  s_add_u32 s58, s63, 16400
  buffer_store_dword v11, v36, s[48:51], s58 offen
  v_cvt_pk_bf16_f32 v12, v26, v27
  s_add_u32 s58, s63, 24592
  buffer_store_dword v12, v36, s[48:51], s58 offen
  v_cvt_pk_bf16_f32 v13, v28, v29
  s_add_u32 s58, s63, 32784
  buffer_store_dword v13, v36, s[48:51], s58 offen
  s_lshl_b32 s57, s2, 8
  v_add_u32 v3, s57, v0
  v_lshlrev_b32 v3, 4, v3
  v_mov_b32 v40, -1
  v_mov_b32 v44, 0
  v_mov_b32 v41, -1
  v_mov_b32 v45, 0
  v_mov_b32 v42, -1
  v_mov_b32 v46, 0
  v_mov_b32 v43, -1
  v_mov_b32 v47, 0
  s_mov_b32 s57, 600064
  s_mov_b32 s58, 0
  s_mov_b32 s96, s48
  s_mov_b32 s97, s49
  s_mov_b32 s98, 7811072
  s_mov_b32 s99, 131072
prep_fill:
  buffer_store_dwordx4 v[40:43], v3, s[96:99], s57 offen
  s_add_u32 s57, s57, 1048576
  s_add_u32 s58, s58, 1
  s_cmp_lt_u32 s58, 7
  s_cbranch_scc1 prep_fill
  s_mov_b32 s98, 589824
  buffer_store_dwordx4 v[44:47], v3, s[96:99], 0 offen
  s_cmp_ge_u32 s2, 3
  s_cbranch_scc1 prep_done
  v_lshrrev_b32 v4, 4, v3
  v_and_b32 v5, 7, v4
  v_lshrrev_b32 v6, 3, v4
  v_mul_u32_u24 v5, 1280, v5
  v_lshl_add_u32 v5, v6, 4, v5
  v_cmp_gt_u32 vcc, 640, v4
  v_mov_b32 v7, 2147483392
  s_nop 0
  v_cndmask_b32 v5, v7, v5, vcc
  buffer_load_dwordx4 v[8:11], v5, s[8:11], 0 offen
  s_mov_b32 s98, 600064
  s_mov_b32 s57, 589824
  s_waitcnt vmcnt(0)
  buffer_store_dwordx4 v[8:11], v3, s[96:99], s57 offen
prep_done:
  s_endpgm
.globl main_kernel
.p2align 8
.type main_kernel,@function
main_kernel:
  s_cmp_ge_u32 s2, 256
  s_cbranch_scc1 mai_k_exit
  s_load_dwordx16 s[64:79], s[0:1], 0
  s_load_dwordx8 s[80:87], s[0:1], 64
  s_load_dwordx2 s[88:89], s[0:1], 96
  s_load_dwordx2 s[90:91], s[0:1], 112
  v_and_b32 v1, 63, v0
  v_lshrrev_b32 v2, 6, v0
  s_nop 0
  v_readfirstlane_b32 s56, v2
  s_waitcnt lgkmcnt(0)
  s_mov_b32 s4, s64
  s_and_b32 s5, s65, 65535
  s_mov_b32 s6, 2621440
  s_mov_b32 s7, 131072
  s_mov_b32 s8, s66
  s_and_b32 s9, s67, 65535
  s_mov_b32 s10, 10240
  s_mov_b32 s11, 131072
  s_mov_b32 s12, s68
  s_and_b32 s13, s69, 65535
  s_mov_b32 s14, 7864320
  s_mov_b32 s15, 131072
  s_mov_b32 s16, s70
  s_and_b32 s17, s71, 65535
  s_mov_b32 s18, 7864320
  s_mov_b32 s19, 131072
  s_mov_b32 s20, s72
  s_and_b32 s21, s73, 65535
  s_mov_b32 s22, 7864320
  s_mov_b32 s23, 131072
  s_mov_b32 s24, s74
  s_and_b32 s25, s75, 65535
  s_mov_b32 s26, 7864320
  s_mov_b32 s27, 131072
  s_mov_b32 s28, s80
  s_and_b32 s29, s81, 65535
  s_mov_b32 s30, 1966080
  s_mov_b32 s31, 131072
  s_mov_b32 s32, s82
  s_and_b32 s33, s83, 65535
  s_mov_b32 s34, 3072
  s_mov_b32 s35, 131072
  s_mov_b32 s36, s84
  s_and_b32 s37, s85, 65535
  s_mov_b32 s38, 1966080
  s_mov_b32 s39, 131072
  s_mov_b32 s40, s86
  s_and_b32 s41, s87, 65535
  s_mov_b32 s42, 1280
  s_mov_b32 s43, 131072
  s_mov_b32 s44, s88
  s_and_b32 s45, s89, 65535
  s_mov_b32 s46, 2621440
  s_mov_b32 s47, 131072
  s_mov_b32 s48, s90
  s_and_b32 s49, s91, 65535
  s_mov_b32 s50, 268435456
  s_mov_b32 s51, 131072
  s_mov_b32 s52, s68
  s_and_b32 s53, s69, 65535
  s_mov_b32 s54, 7864320
  s_mov_b32 s55, 131072
  s_cmp_ge_u32 s2, 128
  s_cbranch_scc1 mai_k_map
  s_lshr_b32 s57, s2, 3
  s_lshl_b32 s57, s57, 2
  s_and_b32 s58, s2, 3
  s_add_u32 s57, s57, s58
  s_and_b32 s58, s2, 4
  s_lshl_b32 s58, s58, 4
  s_add_u32 s2, s57, s58
mai_k_map:
  s_cmp_ge_u32 s2, 64
  s_cbranch_scc1 mai_k_worker
  s_and_b32 s65, s2, 31
  s_lshr_b32 s66, s2, 5
  v_lshrrev_b32 v98, 4, v1
  v_and_b32 v99, 7, v1
  v_and_b32 v100, 15, v1
  v_lshlrev_b32 v2, 4, v0
  v_add_u32 v3, 8192, v2
  v_cmp_gt_u32 vcc, 128, v0
  s_nop 1
  v_cndmask_b32 v3, v2, v3, vcc
  v_lshlrev_b32 v4, 7, v98
  v_lshl_add_u32 v4, v99, 4, v4
  v_lshlrev_b32 v16, 4, v1
  s_mul_i32 s57, s56, 20480
  s_add_u32 s57, s57, 65536
  v_add_u32 v5, s57, v16
  s_lshl_b32 s57, s56, 13
  v_add_u32 v17, s57, v16
  v_lshlrev_b32 v15, 4, v100
  v_lshl_add_u32 v15, v98, 3, v15
  s_mov_b32 s68, 16711935
  s_mov_b32 s69, 0
  s_cmp_lt_u32 s2, 32
  s_cbranch_scc1 mai_rg_1
  s_cmp_ge_u32 s2, 48
  s_cbranch_scc1 mai_rg_1
  s_sub_u32 s67, s2, 32
  s_lshl_b32 s67, s67, 1
  s_mov_b32 s101, 2
  s_branch mai_rg_2
mai_rg_1:
  s_sub_u32 s57, s2, 16
  s_cmp_lt_u32 s2, 32
  s_cselect_b32 s67, s2, s57
  s_add_u32 s67, s67, 32
  s_mov_b32 s101, 1
mai_rg_2:
  s_lshl_b32 s58, s56, 12
  v_add_u32 v6, s58, v16
  s_lshl_b32 s58, s56, 10
  s_add_u32 s58, s58, 16384
  v_add_u32 v7, s58, v16
  v_bfe_u32 v102, v1, 3, 1
  v_lshlrev_b32 v8, 9, v102
  v_lshl_add_u32 v8, v98, 7, v8
  v_lshl_add_u32 v8, v99, 4, v8
  s_lshl_b32 s57, s67, 12
  s_lshl_b32 s58, s56, 10
  s_add_u32 s57, s57, s58
  v_add_u32 v8, s57, v8
  v_lshlrev_b32 v9, 9, v102
  v_lshl_add_u32 v9, v99, 6, v9
  v_lshl_add_u32 v9, v98, 4, v9
  s_mul_i32 s57, s67, 16384
  s_lshl_b32 s58, s56, 12
  s_add_u32 s57, s57, s58
  v_add_u32 v9, s57, v9
  s_mov_b32 s84, 589824
  s_mov_b32 s85, 593920
  s_mov_b32 s86, 1257472
  s_mov_b32 s88, 2568192
  s_mov_b32 s89, 2572288
  s_lshl_b32 s90, s67, 7
  s_add_u32 s90, s90, 600064
  s_mul_i32 s91, s65, 6144
  s_add_u32 s91, s91, 23539712
  s_mul_i32 s94, s65, 12288
  s_add_u32 s94, s94, 38744064
  s_mov_b32 s96, 89075712
  s_lshl_b32 s98, s2, 7
  s_add_u32 s98, s98, 65536
  s_mov_b32 s99, 1037384597
  s_mov_b32 s100, 4294901759
  s_mov_b32 s79, 320
  s_cmp_lg_u32 s66, 0
  s_cbranch_scc1 mai_r_init_vo
  v_lshrrev_b32 v98, 4, v1
  v_bfe_u32 v99, v1, 2, 2
  v_and_b32 v100, 3, v1
  s_mul_i32 s57, s56, 192
  v_add_u32 v101, s57, v1
  v_add_u32 v101, 0, v101
  v_mul_u32_u24 v102, 2731, v101
  v_lshrrev_b32 v102, 16, v102
  v_mul_u32_u24 v103, 24, v102
  v_sub_u32 v103, v101, v103
  v_mul_u32_u24 v106, 12288, v102
  v_lshl_add_u32 v106, v103, 4, v106
  v_add_u32 v101, s57, v1
  v_add_u32 v101, 64, v101
  v_mul_u32_u24 v102, 2731, v101
  v_lshrrev_b32 v102, 16, v102
  v_mul_u32_u24 v103, 24, v102
  v_sub_u32 v103, v101, v103
  v_mul_u32_u24 v107, 12288, v102
  v_lshl_add_u32 v107, v103, 4, v107
  v_add_u32 v101, s57, v1
  v_add_u32 v101, 128, v101
  v_mul_u32_u24 v102, 2731, v101
  v_lshrrev_b32 v102, 16, v102
  v_mul_u32_u24 v103, 24, v102
  v_sub_u32 v103, v101, v103
  v_mul_u32_u24 v108, 12288, v102
  v_lshl_add_u32 v108, v103, 4, v108
  v_lshl_add_u32 v104, v98, 3, v99
  v_mul_u32_u24 v104, 384, v104
  v_lshl_add_u32 v104, v100, 3, v104
  s_mul_i32 s57, s56, 96
  v_add_u32 v104, s57, v104
  s_mul_i32 s72, s65, 384
  s_mul_i32 s73, s56, 3072
  s_add_u32 m0, s73, 0
  s_nop 0
  buffer_load_dwordx4 v106, s[12:15], s72 offen lds
  s_add_u32 m0, s73, 1024
  s_nop 0
  buffer_load_dwordx4 v107, s[12:15], s72 offen lds
  s_add_u32 m0, s73, 2048
  s_nop 0
  buffer_load_dwordx4 v108, s[12:15], s72 offen lds
  s_add_u32 m0, s73, 12288
  s_nop 0
  buffer_load_dwordx4 v106, s[16:19], s72 offen lds
  s_add_u32 m0, s73, 13312
  s_nop 0
  buffer_load_dwordx4 v107, s[16:19], s72 offen lds
  s_add_u32 m0, s73, 14336
  s_nop 0
  buffer_load_dwordx4 v108, s[16:19], s72 offen lds
  s_add_u32 s72, s72, 393216
  s_add_u32 m0, s73, 24576
  s_nop 0
  buffer_load_dwordx4 v106, s[12:15], s72 offen lds
  s_add_u32 m0, s73, 25600
  s_nop 0
  buffer_load_dwordx4 v107, s[12:15], s72 offen lds
  s_add_u32 m0, s73, 26624
  s_nop 0
  buffer_load_dwordx4 v108, s[12:15], s72 offen lds
  s_add_u32 m0, s73, 36864
  s_nop 0
  buffer_load_dwordx4 v106, s[16:19], s72 offen lds
  s_add_u32 m0, s73, 37888
  s_nop 0
  buffer_load_dwordx4 v107, s[16:19], s72 offen lds
  s_add_u32 m0, s73, 38912
  s_nop 0
  buffer_load_dwordx4 v108, s[16:19], s72 offen lds
  s_add_u32 s72, s72, 393216
  s_add_u32 m0, s73, 49152
  s_nop 0
  buffer_load_dwordx4 v106, s[12:15], s72 offen lds
  s_add_u32 m0, s73, 50176
  s_nop 0
  buffer_load_dwordx4 v107, s[12:15], s72 offen lds
  s_add_u32 m0, s73, 51200
  s_nop 0
  buffer_load_dwordx4 v108, s[12:15], s72 offen lds
  s_add_u32 m0, s73, 61440
  s_nop 0
  buffer_load_dwordx4 v106, s[16:19], s72 offen lds
  s_add_u32 m0, s73, 62464
  s_nop 0
  buffer_load_dwordx4 v107, s[16:19], s72 offen lds
  s_add_u32 m0, s73, 63488
  s_nop 0
  buffer_load_dwordx4 v108, s[16:19], s72 offen lds
  s_add_u32 s72, s72, 393216
  s_add_u32 m0, s73, 73728
  s_nop 0
  buffer_load_dwordx4 v106, s[12:15], s72 offen lds
  s_add_u32 m0, s73, 74752
  s_nop 0
  buffer_load_dwordx4 v107, s[12:15], s72 offen lds
  s_add_u32 m0, s73, 75776
  s_nop 0
  buffer_load_dwordx4 v108, s[12:15], s72 offen lds
  s_add_u32 m0, s73, 86016
  s_nop 0
  buffer_load_dwordx4 v106, s[16:19], s72 offen lds
  s_add_u32 m0, s73, 87040
  s_nop 0
  buffer_load_dwordx4 v107, s[16:19], s72 offen lds
  s_add_u32 m0, s73, 88064
  s_nop 0
  buffer_load_dwordx4 v108, s[16:19], s72 offen lds
  s_add_u32 s72, s72, 393216
  s_add_u32 m0, s73, 98304
  s_nop 0
  buffer_load_dwordx4 v106, s[12:15], s72 offen lds
  s_add_u32 m0, s73, 99328
  s_nop 0
  buffer_load_dwordx4 v107, s[12:15], s72 offen lds
  s_add_u32 m0, s73, 100352
  s_nop 0
  buffer_load_dwordx4 v108, s[12:15], s72 offen lds
  s_add_u32 m0, s73, 110592
  s_nop 0
  buffer_load_dwordx4 v106, s[16:19], s72 offen lds
  s_add_u32 m0, s73, 111616
  s_nop 0
  buffer_load_dwordx4 v107, s[16:19], s72 offen lds
  s_add_u32 m0, s73, 112640
  s_nop 0
  buffer_load_dwordx4 v108, s[16:19], s72 offen lds
  s_add_u32 s72, s72, 393216
  s_waitcnt vmcnt(24)
  s_barrier
  s_add_u32 m0, s73, 122880
  s_nop 0
  buffer_load_dwordx4 v106, s[12:15], s72 offen lds
  s_add_u32 m0, s73, 123904
  s_nop 0
  buffer_load_dwordx4 v107, s[12:15], s72 offen lds
  s_add_u32 m0, s73, 124928
  s_nop 0
  buffer_load_dwordx4 v108, s[12:15], s72 offen lds
  s_add_u32 m0, s73, 135168
  s_nop 0
  buffer_load_dwordx4 v106, s[16:19], s72 offen lds
  s_add_u32 m0, s73, 136192
  s_nop 0
  buffer_load_dwordx4 v107, s[16:19], s72 offen lds
  s_add_u32 m0, s73, 137216
  s_nop 0
  buffer_load_dwordx4 v108, s[16:19], s72 offen lds
  s_add_u32 s72, s72, 393216
  v_add_u32 v105, 0, v104
  ds_read_b64_tr_b16 a[0:1], v105 offset:0
  ds_read_b64_tr_b16 a[2:3], v105 offset:1536
  ds_read_b64_tr_b16 a[4:5], v105 offset:32
  ds_read_b64_tr_b16 a[6:7], v105 offset:1568
  ds_read_b64_tr_b16 a[8:9], v105 offset:64
  ds_read_b64_tr_b16 a[10:11], v105 offset:1600
  ds_read_b64_tr_b16 a[12:13], v105 offset:12288
  ds_read_b64_tr_b16 a[14:15], v105 offset:13824
  ds_read_b64_tr_b16 a[16:17], v105 offset:12320
  ds_read_b64_tr_b16 a[18:19], v105 offset:13856
  ds_read_b64_tr_b16 v[18:19], v105 offset:12352
  ds_read_b64_tr_b16 v[20:21], v105 offset:13888
  s_waitcnt lgkmcnt(0)
  s_waitcnt vmcnt(24)
  s_barrier
  s_add_u32 m0, s73, 0
  s_nop 0
  buffer_load_dwordx4 v106, s[12:15], s72 offen lds
  s_add_u32 m0, s73, 1024
  s_nop 0
  buffer_load_dwordx4 v107, s[12:15], s72 offen lds
  s_add_u32 m0, s73, 2048
  s_nop 0
  buffer_load_dwordx4 v108, s[12:15], s72 offen lds
  s_add_u32 m0, s73, 12288
  s_nop 0
  buffer_load_dwordx4 v106, s[16:19], s72 offen lds
  s_add_u32 m0, s73, 13312
  s_nop 0
  buffer_load_dwordx4 v107, s[16:19], s72 offen lds
  s_add_u32 m0, s73, 14336
  s_nop 0
  buffer_load_dwordx4 v108, s[16:19], s72 offen lds
  s_add_u32 s72, s72, 393216
  v_add_u32 v105, 24576, v104
  ds_read_b64_tr_b16 a[20:21], v105 offset:0
  ds_read_b64_tr_b16 a[22:23], v105 offset:1536
  ds_read_b64_tr_b16 a[24:25], v105 offset:32
  ds_read_b64_tr_b16 a[26:27], v105 offset:1568
  ds_read_b64_tr_b16 a[28:29], v105 offset:64
  ds_read_b64_tr_b16 a[30:31], v105 offset:1600
  ds_read_b64_tr_b16 a[32:33], v105 offset:12288
  ds_read_b64_tr_b16 a[34:35], v105 offset:13824
  ds_read_b64_tr_b16 a[36:37], v105 offset:12320
  ds_read_b64_tr_b16 a[38:39], v105 offset:13856
  ds_read_b64_tr_b16 v[22:23], v105 offset:12352
  ds_read_b64_tr_b16 v[24:25], v105 offset:13888
  s_waitcnt lgkmcnt(0)
  s_waitcnt vmcnt(24)
  s_barrier
  s_add_u32 m0, s73, 24576
  s_nop 0
  buffer_load_dwordx4 v106, s[12:15], s72 offen lds
  s_add_u32 m0, s73, 25600
  s_nop 0
  buffer_load_dwordx4 v107, s[12:15], s72 offen lds
  s_add_u32 m0, s73, 26624
  s_nop 0
  buffer_load_dwordx4 v108, s[12:15], s72 offen lds
  s_add_u32 m0, s73, 36864
  s_nop 0
  buffer_load_dwordx4 v106, s[16:19], s72 offen lds
  s_add_u32 m0, s73, 37888
  s_nop 0
  buffer_load_dwordx4 v107, s[16:19], s72 offen lds
  s_add_u32 m0, s73, 38912
  s_nop 0
  buffer_load_dwordx4 v108, s[16:19], s72 offen lds
  s_add_u32 s72, s72, 393216
  v_add_u32 v105, 49152, v104
  ds_read_b64_tr_b16 a[40:41], v105 offset:0
  ds_read_b64_tr_b16 a[42:43], v105 offset:1536
  ds_read_b64_tr_b16 a[44:45], v105 offset:32
  ds_read_b64_tr_b16 a[46:47], v105 offset:1568
  ds_read_b64_tr_b16 a[48:49], v105 offset:64
  ds_read_b64_tr_b16 a[50:51], v105 offset:1600
  ds_read_b64_tr_b16 a[52:53], v105 offset:12288
  ds_read_b64_tr_b16 a[54:55], v105 offset:13824
  ds_read_b64_tr_b16 a[56:57], v105 offset:12320
  ds_read_b64_tr_b16 a[58:59], v105 offset:13856
  ds_read_b64_tr_b16 v[26:27], v105 offset:12352
  ds_read_b64_tr_b16 v[28:29], v105 offset:13888
  s_waitcnt lgkmcnt(0)
  s_waitcnt vmcnt(24)
  s_barrier
  s_add_u32 m0, s73, 49152
  s_nop 0
  buffer_load_dwordx4 v106, s[12:15], s72 offen lds
  s_add_u32 m0, s73, 50176
  s_nop 0
  buffer_load_dwordx4 v107, s[12:15], s72 offen lds
  s_add_u32 m0, s73, 51200
  s_nop 0
  buffer_load_dwordx4 v108, s[12:15], s72 offen lds
  s_add_u32 m0, s73, 61440
  s_nop 0
  buffer_load_dwordx4 v106, s[16:19], s72 offen lds
  s_add_u32 m0, s73, 62464
  s_nop 0
  buffer_load_dwordx4 v107, s[16:19], s72 offen lds
  s_add_u32 m0, s73, 63488
  s_nop 0
  buffer_load_dwordx4 v108, s[16:19], s72 offen lds
  s_add_u32 s72, s72, 393216
  v_add_u32 v105, 73728, v104
  ds_read_b64_tr_b16 a[60:61], v105 offset:0
  ds_read_b64_tr_b16 a[62:63], v105 offset:1536
  ds_read_b64_tr_b16 a[64:65], v105 offset:32
  ds_read_b64_tr_b16 a[66:67], v105 offset:1568
  ds_read_b64_tr_b16 a[68:69], v105 offset:64
  ds_read_b64_tr_b16 a[70:71], v105 offset:1600
  ds_read_b64_tr_b16 a[72:73], v105 offset:12288
  ds_read_b64_tr_b16 a[74:75], v105 offset:13824
  ds_read_b64_tr_b16 a[76:77], v105 offset:12320
  ds_read_b64_tr_b16 a[78:79], v105 offset:13856
  ds_read_b64_tr_b16 v[30:31], v105 offset:12352
  ds_read_b64_tr_b16 v[32:33], v105 offset:13888
  s_waitcnt lgkmcnt(0)
  s_waitcnt vmcnt(24)
  s_barrier
  s_add_u32 m0, s73, 73728
  s_nop 0
  buffer_load_dwordx4 v106, s[12:15], s72 offen lds
  s_add_u32 m0, s73, 74752
  s_nop 0
  buffer_load_dwordx4 v107, s[12:15], s72 offen lds
  s_add_u32 m0, s73, 75776
  s_nop 0
  buffer_load_dwordx4 v108, s[12:15], s72 offen lds
  s_add_u32 m0, s73, 86016
  s_nop 0
  buffer_load_dwordx4 v106, s[16:19], s72 offen lds
  s_add_u32 m0, s73, 87040
  s_nop 0
  buffer_load_dwordx4 v107, s[16:19], s72 offen lds
  s_add_u32 m0, s73, 88064
  s_nop 0
  buffer_load_dwordx4 v108, s[16:19], s72 offen lds
  s_add_u32 s72, s72, 393216
  v_add_u32 v105, 98304, v104
  ds_read_b64_tr_b16 a[80:81], v105 offset:0
  ds_read_b64_tr_b16 a[82:83], v105 offset:1536
  ds_read_b64_tr_b16 a[84:85], v105 offset:32
  ds_read_b64_tr_b16 a[86:87], v105 offset:1568
  ds_read_b64_tr_b16 a[88:89], v105 offset:64
  ds_read_b64_tr_b16 a[90:91], v105 offset:1600
  ds_read_b64_tr_b16 a[92:93], v105 offset:12288
  ds_read_b64_tr_b16 a[94:95], v105 offset:13824
  ds_read_b64_tr_b16 a[96:97], v105 offset:12320
  ds_read_b64_tr_b16 a[98:99], v105 offset:13856
  ds_read_b64_tr_b16 v[34:35], v105 offset:12352
  ds_read_b64_tr_b16 v[36:37], v105 offset:13888
  s_waitcnt lgkmcnt(0)
  s_waitcnt vmcnt(24)
  s_barrier
  s_add_u32 m0, s73, 98304
  s_nop 0
  buffer_load_dwordx4 v106, s[12:15], s72 offen lds
  s_add_u32 m0, s73, 99328
  s_nop 0
  buffer_load_dwordx4 v107, s[12:15], s72 offen lds
  s_add_u32 m0, s73, 100352
  s_nop 0
  buffer_load_dwordx4 v108, s[12:15], s72 offen lds
  s_add_u32 m0, s73, 110592
  s_nop 0
  buffer_load_dwordx4 v106, s[16:19], s72 offen lds
  s_add_u32 m0, s73, 111616
  s_nop 0
  buffer_load_dwordx4 v107, s[16:19], s72 offen lds
  s_add_u32 m0, s73, 112640
  s_nop 0
  buffer_load_dwordx4 v108, s[16:19], s72 offen lds
  s_add_u32 s72, s72, 393216
  v_add_u32 v105, 122880, v104
  ds_read_b64_tr_b16 a[100:101], v105 offset:0
  ds_read_b64_tr_b16 a[102:103], v105 offset:1536
  ds_read_b64_tr_b16 a[104:105], v105 offset:32
  ds_read_b64_tr_b16 a[106:107], v105 offset:1568
  ds_read_b64_tr_b16 a[108:109], v105 offset:64
  ds_read_b64_tr_b16 a[110:111], v105 offset:1600
  ds_read_b64_tr_b16 a[112:113], v105 offset:12288
  ds_read_b64_tr_b16 a[114:115], v105 offset:13824
  ds_read_b64_tr_b16 a[116:117], v105 offset:12320
  ds_read_b64_tr_b16 a[118:119], v105 offset:13856
  ds_read_b64_tr_b16 v[38:39], v105 offset:12352
  ds_read_b64_tr_b16 v[40:41], v105 offset:13888
  s_waitcnt lgkmcnt(0)
  s_waitcnt vmcnt(24)
  s_barrier
  s_add_u32 m0, s73, 122880
  s_nop 0
  buffer_load_dwordx4 v106, s[12:15], s72 offen lds
  s_add_u32 m0, s73, 123904
  s_nop 0
  buffer_load_dwordx4 v107, s[12:15], s72 offen lds
  s_add_u32 m0, s73, 124928
  s_nop 0
  buffer_load_dwordx4 v108, s[12:15], s72 offen lds
  s_add_u32 m0, s73, 135168
  s_nop 0
  buffer_load_dwordx4 v106, s[16:19], s72 offen lds
  s_add_u32 m0, s73, 136192
  s_nop 0
  buffer_load_dwordx4 v107, s[16:19], s72 offen lds
  s_add_u32 m0, s73, 137216
  s_nop 0
  buffer_load_dwordx4 v108, s[16:19], s72 offen lds
  s_add_u32 s72, s72, 393216
  v_add_u32 v105, 0, v104
  ds_read_b64_tr_b16 a[120:121], v105 offset:0
  ds_read_b64_tr_b16 a[122:123], v105 offset:1536
  ds_read_b64_tr_b16 a[124:125], v105 offset:32
  ds_read_b64_tr_b16 a[126:127], v105 offset:1568
  ds_read_b64_tr_b16 a[128:129], v105 offset:64
  ds_read_b64_tr_b16 a[130:131], v105 offset:1600
  ds_read_b64_tr_b16 a[132:133], v105 offset:12288
  ds_read_b64_tr_b16 a[134:135], v105 offset:13824
  ds_read_b64_tr_b16 a[136:137], v105 offset:12320
  ds_read_b64_tr_b16 a[138:139], v105 offset:13856
  ds_read_b64_tr_b16 v[42:43], v105 offset:12352
  ds_read_b64_tr_b16 v[44:45], v105 offset:13888
  s_waitcnt lgkmcnt(0)
  s_waitcnt vmcnt(24)
  s_barrier
  s_add_u32 m0, s73, 0
  s_nop 0
  buffer_load_dwordx4 v106, s[12:15], s72 offen lds
  s_add_u32 m0, s73, 1024
  s_nop 0
  buffer_load_dwordx4 v107, s[12:15], s72 offen lds
  s_add_u32 m0, s73, 2048
  s_nop 0
  buffer_load_dwordx4 v108, s[12:15], s72 offen lds
  s_add_u32 m0, s73, 12288
  s_nop 0
  buffer_load_dwordx4 v106, s[16:19], s72 offen lds
  s_add_u32 m0, s73, 13312
  s_nop 0
  buffer_load_dwordx4 v107, s[16:19], s72 offen lds
  s_add_u32 m0, s73, 14336
  s_nop 0
  buffer_load_dwordx4 v108, s[16:19], s72 offen lds
  s_add_u32 s72, s72, 393216
  v_add_u32 v105, 24576, v104
  ds_read_b64_tr_b16 a[140:141], v105 offset:0
  ds_read_b64_tr_b16 a[142:143], v105 offset:1536
  ds_read_b64_tr_b16 a[144:145], v105 offset:32
  ds_read_b64_tr_b16 a[146:147], v105 offset:1568
  ds_read_b64_tr_b16 a[148:149], v105 offset:64
  ds_read_b64_tr_b16 a[150:151], v105 offset:1600
  ds_read_b64_tr_b16 a[152:153], v105 offset:12288
  ds_read_b64_tr_b16 a[154:155], v105 offset:13824
  ds_read_b64_tr_b16 a[156:157], v105 offset:12320
  ds_read_b64_tr_b16 a[158:159], v105 offset:13856
  ds_read_b64_tr_b16 v[46:47], v105 offset:12352
  ds_read_b64_tr_b16 v[48:49], v105 offset:13888
  s_waitcnt lgkmcnt(0)
  s_waitcnt vmcnt(24)
  s_barrier
  s_add_u32 m0, s73, 24576
  s_nop 0
  buffer_load_dwordx4 v106, s[12:15], s72 offen lds
  s_add_u32 m0, s73, 25600
  s_nop 0
  buffer_load_dwordx4 v107, s[12:15], s72 offen lds
  s_add_u32 m0, s73, 26624
  s_nop 0
  buffer_load_dwordx4 v108, s[12:15], s72 offen lds
  s_add_u32 m0, s73, 36864
  s_nop 0
  buffer_load_dwordx4 v106, s[16:19], s72 offen lds
  s_add_u32 m0, s73, 37888
  s_nop 0
  buffer_load_dwordx4 v107, s[16:19], s72 offen lds
  s_add_u32 m0, s73, 38912
  s_nop 0
  buffer_load_dwordx4 v108, s[16:19], s72 offen lds
  s_add_u32 s72, s72, 393216
  v_add_u32 v105, 49152, v104
  ds_read_b64_tr_b16 a[160:161], v105 offset:0
  ds_read_b64_tr_b16 a[162:163], v105 offset:1536
  ds_read_b64_tr_b16 a[164:165], v105 offset:32
  ds_read_b64_tr_b16 a[166:167], v105 offset:1568
  ds_read_b64_tr_b16 a[168:169], v105 offset:64
  ds_read_b64_tr_b16 a[170:171], v105 offset:1600
  ds_read_b64_tr_b16 a[172:173], v105 offset:12288
  ds_read_b64_tr_b16 a[174:175], v105 offset:13824
  ds_read_b64_tr_b16 a[176:177], v105 offset:12320
  ds_read_b64_tr_b16 a[178:179], v105 offset:13856
  ds_read_b64_tr_b16 v[50:51], v105 offset:12352
  ds_read_b64_tr_b16 v[52:53], v105 offset:13888
  s_waitcnt lgkmcnt(0)
  s_waitcnt vmcnt(24)
  s_barrier
  s_add_u32 m0, s73, 49152
  s_nop 0
  buffer_load_dwordx4 v106, s[12:15], s72 offen lds
  s_add_u32 m0, s73, 50176
  s_nop 0
  buffer_load_dwordx4 v107, s[12:15], s72 offen lds
  s_add_u32 m0, s73, 51200
  s_nop 0
  buffer_load_dwordx4 v108, s[12:15], s72 offen lds
  s_add_u32 m0, s73, 61440
  s_nop 0
  buffer_load_dwordx4 v106, s[16:19], s72 offen lds
  s_add_u32 m0, s73, 62464
  s_nop 0
  buffer_load_dwordx4 v107, s[16:19], s72 offen lds
  s_add_u32 m0, s73, 63488
  s_nop 0
  buffer_load_dwordx4 v108, s[16:19], s72 offen lds
  s_add_u32 s72, s72, 393216
  v_add_u32 v105, 73728, v104
  ds_read_b64_tr_b16 a[180:181], v105 offset:0
  ds_read_b64_tr_b16 a[182:183], v105 offset:1536
  ds_read_b64_tr_b16 a[184:185], v105 offset:32
  ds_read_b64_tr_b16 a[186:187], v105 offset:1568
  ds_read_b64_tr_b16 a[188:189], v105 offset:64
  ds_read_b64_tr_b16 a[190:191], v105 offset:1600
  ds_read_b64_tr_b16 a[192:193], v105 offset:12288
  ds_read_b64_tr_b16 a[194:195], v105 offset:13824
  ds_read_b64_tr_b16 a[196:197], v105 offset:12320
  ds_read_b64_tr_b16 a[198:199], v105 offset:13856
  ds_read_b64_tr_b16 v[54:55], v105 offset:12352
  ds_read_b64_tr_b16 v[56:57], v105 offset:13888
  s_waitcnt lgkmcnt(0)
  s_waitcnt vmcnt(24)
  s_barrier
  s_add_u32 m0, s73, 73728
  s_nop 0
  buffer_load_dwordx4 v106, s[12:15], s72 offen lds
  s_add_u32 m0, s73, 74752
  s_nop 0
  buffer_load_dwordx4 v107, s[12:15], s72 offen lds
  s_add_u32 m0, s73, 75776
  s_nop 0
  buffer_load_dwordx4 v108, s[12:15], s72 offen lds
  s_add_u32 m0, s73, 86016
  s_nop 0
  buffer_load_dwordx4 v106, s[16:19], s72 offen lds
  s_add_u32 m0, s73, 87040
  s_nop 0
  buffer_load_dwordx4 v107, s[16:19], s72 offen lds
  s_add_u32 m0, s73, 88064
  s_nop 0
  buffer_load_dwordx4 v108, s[16:19], s72 offen lds
  s_add_u32 s72, s72, 393216
  v_add_u32 v105, 98304, v104
  ds_read_b64_tr_b16 a[200:201], v105 offset:0
  ds_read_b64_tr_b16 a[202:203], v105 offset:1536
  ds_read_b64_tr_b16 a[204:205], v105 offset:32
  ds_read_b64_tr_b16 a[206:207], v105 offset:1568
  ds_read_b64_tr_b16 a[208:209], v105 offset:64
  ds_read_b64_tr_b16 a[210:211], v105 offset:1600
  ds_read_b64_tr_b16 a[212:213], v105 offset:12288
  ds_read_b64_tr_b16 a[214:215], v105 offset:13824
  ds_read_b64_tr_b16 a[216:217], v105 offset:12320
  ds_read_b64_tr_b16 a[218:219], v105 offset:13856
  ds_read_b64_tr_b16 v[58:59], v105 offset:12352
  ds_read_b64_tr_b16 v[60:61], v105 offset:13888
  s_waitcnt lgkmcnt(0)
  s_waitcnt vmcnt(24)
  s_barrier
  s_add_u32 m0, s73, 98304
  s_nop 0
  buffer_load_dwordx4 v106, s[12:15], s72 offen lds
  s_add_u32 m0, s73, 99328
  s_nop 0
  buffer_load_dwordx4 v107, s[12:15], s72 offen lds
  s_add_u32 m0, s73, 100352
  s_nop 0
  buffer_load_dwordx4 v108, s[12:15], s72 offen lds
  s_add_u32 m0, s73, 110592
  s_nop 0
  buffer_load_dwordx4 v106, s[16:19], s72 offen lds
  s_add_u32 m0, s73, 111616
  s_nop 0
  buffer_load_dwordx4 v107, s[16:19], s72 offen lds
  s_add_u32 m0, s73, 112640
  s_nop 0
  buffer_load_dwordx4 v108, s[16:19], s72 offen lds
  s_add_u32 s72, s72, 393216
  v_add_u32 v105, 122880, v104
  ds_read_b64_tr_b16 a[220:221], v105 offset:0
  ds_read_b64_tr_b16 a[222:223], v105 offset:1536
  ds_read_b64_tr_b16 a[224:225], v105 offset:32
  ds_read_b64_tr_b16 a[226:227], v105 offset:1568
  ds_read_b64_tr_b16 a[228:229], v105 offset:64
  ds_read_b64_tr_b16 a[230:231], v105 offset:1600
  ds_read_b64_tr_b16 a[232:233], v105 offset:12288
  ds_read_b64_tr_b16 a[234:235], v105 offset:13824
  ds_read_b64_tr_b16 a[236:237], v105 offset:12320
  ds_read_b64_tr_b16 a[238:239], v105 offset:13856
  ds_read_b64_tr_b16 v[62:63], v105 offset:12352
  ds_read_b64_tr_b16 v[64:65], v105 offset:13888
  s_waitcnt lgkmcnt(0)
  s_waitcnt vmcnt(24)
  s_barrier
  s_add_u32 m0, s73, 122880
  s_nop 0
  buffer_load_dwordx4 v106, s[12:15], s72 offen lds
  s_add_u32 m0, s73, 123904
  s_nop 0
  buffer_load_dwordx4 v107, s[12:15], s72 offen lds
  s_add_u32 m0, s73, 124928
  s_nop 0
  buffer_load_dwordx4 v108, s[12:15], s72 offen lds
  s_add_u32 m0, s73, 135168
  s_nop 0
  buffer_load_dwordx4 v106, s[16:19], s72 offen lds
  s_add_u32 m0, s73, 136192
  s_nop 0
  buffer_load_dwordx4 v107, s[16:19], s72 offen lds
  s_add_u32 m0, s73, 137216
  s_nop 0
  buffer_load_dwordx4 v108, s[16:19], s72 offen lds
  s_add_u32 s72, s72, 393216
  v_add_u32 v105, 0, v104
  ds_read_b64_tr_b16 a[240:241], v105 offset:0
  ds_read_b64_tr_b16 a[242:243], v105 offset:1536
  ds_read_b64_tr_b16 a[244:245], v105 offset:32
  ds_read_b64_tr_b16 a[246:247], v105 offset:1568
  ds_read_b64_tr_b16 a[248:249], v105 offset:64
  ds_read_b64_tr_b16 a[250:251], v105 offset:1600
  ds_read_b64_tr_b16 a[252:253], v105 offset:12288
  ds_read_b64_tr_b16 a[254:255], v105 offset:13824
  ds_read_b64_tr_b16 v[112:113], v105 offset:12320
  ds_read_b64_tr_b16 v[114:115], v105 offset:13856
  ds_read_b64_tr_b16 v[66:67], v105 offset:12352
  ds_read_b64_tr_b16 v[68:69], v105 offset:13888
  s_waitcnt lgkmcnt(0)
  s_waitcnt vmcnt(24)
  s_barrier
  s_add_u32 m0, s73, 0
  s_nop 0
  buffer_load_dwordx4 v106, s[12:15], s72 offen lds
  s_add_u32 m0, s73, 1024
  s_nop 0
  buffer_load_dwordx4 v107, s[12:15], s72 offen lds
  s_add_u32 m0, s73, 2048
  s_nop 0
  buffer_load_dwordx4 v108, s[12:15], s72 offen lds
  s_add_u32 m0, s73, 12288
  s_nop 0
  buffer_load_dwordx4 v106, s[16:19], s72 offen lds
  s_add_u32 m0, s73, 13312
  s_nop 0
  buffer_load_dwordx4 v107, s[16:19], s72 offen lds
  s_add_u32 m0, s73, 14336
  s_nop 0
  buffer_load_dwordx4 v108, s[16:19], s72 offen lds
  s_add_u32 s72, s72, 393216
  v_add_u32 v105, 24576, v104
  ds_read_b64_tr_b16 v[116:117], v105 offset:0
  ds_read_b64_tr_b16 v[118:119], v105 offset:1536
  ds_read_b64_tr_b16 v[120:121], v105 offset:32
  ds_read_b64_tr_b16 v[122:123], v105 offset:1568
  ds_read_b64_tr_b16 v[124:125], v105 offset:64
  ds_read_b64_tr_b16 v[126:127], v105 offset:1600
  ds_read_b64_tr_b16 v[128:129], v105 offset:12288
  ds_read_b64_tr_b16 v[130:131], v105 offset:13824
  ds_read_b64_tr_b16 v[132:133], v105 offset:12320
  ds_read_b64_tr_b16 v[134:135], v105 offset:13856
  ds_read_b64_tr_b16 v[70:71], v105 offset:12352
  ds_read_b64_tr_b16 v[72:73], v105 offset:13888
  s_waitcnt lgkmcnt(0)
  s_waitcnt vmcnt(24)
  s_barrier
  s_add_u32 m0, s73, 24576
  s_nop 0
  buffer_load_dwordx4 v106, s[12:15], s72 offen lds
  s_add_u32 m0, s73, 25600
  s_nop 0
  buffer_load_dwordx4 v107, s[12:15], s72 offen lds
  s_add_u32 m0, s73, 26624
  s_nop 0
  buffer_load_dwordx4 v108, s[12:15], s72 offen lds
  s_add_u32 m0, s73, 36864
  s_nop 0
  buffer_load_dwordx4 v106, s[16:19], s72 offen lds
  s_add_u32 m0, s73, 37888
  s_nop 0
  buffer_load_dwordx4 v107, s[16:19], s72 offen lds
  s_add_u32 m0, s73, 38912
  s_nop 0
  buffer_load_dwordx4 v108, s[16:19], s72 offen lds
  s_add_u32 s72, s72, 393216
  v_add_u32 v105, 49152, v104
  ds_read_b64_tr_b16 v[136:137], v105 offset:0
  ds_read_b64_tr_b16 v[138:139], v105 offset:1536
  ds_read_b64_tr_b16 v[140:141], v105 offset:32
  ds_read_b64_tr_b16 v[142:143], v105 offset:1568
  ds_read_b64_tr_b16 v[144:145], v105 offset:64
  ds_read_b64_tr_b16 v[146:147], v105 offset:1600
  ds_read_b64_tr_b16 v[148:149], v105 offset:12288
  ds_read_b64_tr_b16 v[150:151], v105 offset:13824
  ds_read_b64_tr_b16 v[152:153], v105 offset:12320
  ds_read_b64_tr_b16 v[154:155], v105 offset:13856
  ds_read_b64_tr_b16 v[74:75], v105 offset:12352
  ds_read_b64_tr_b16 v[76:77], v105 offset:13888
  s_waitcnt lgkmcnt(0)
  s_waitcnt vmcnt(24)
  s_barrier
  v_add_u32 v105, 73728, v104
  ds_read_b64_tr_b16 v[156:157], v105 offset:0
  ds_read_b64_tr_b16 v[158:159], v105 offset:1536
  ds_read_b64_tr_b16 v[160:161], v105 offset:32
  ds_read_b64_tr_b16 v[162:163], v105 offset:1568
  ds_read_b64_tr_b16 v[164:165], v105 offset:64
  ds_read_b64_tr_b16 v[166:167], v105 offset:1600
  ds_read_b64_tr_b16 v[168:169], v105 offset:12288
  ds_read_b64_tr_b16 v[170:171], v105 offset:13824
  ds_read_b64_tr_b16 v[172:173], v105 offset:12320
  ds_read_b64_tr_b16 v[174:175], v105 offset:13856
  ds_read_b64_tr_b16 v[78:79], v105 offset:12352
  ds_read_b64_tr_b16 v[80:81], v105 offset:13888
  s_waitcnt lgkmcnt(0)
  s_waitcnt vmcnt(18)
  s_barrier
  v_add_u32 v105, 98304, v104
  ds_read_b64_tr_b16 v[176:177], v105 offset:0
  ds_read_b64_tr_b16 v[178:179], v105 offset:1536
  ds_read_b64_tr_b16 v[180:181], v105 offset:32
  ds_read_b64_tr_b16 v[182:183], v105 offset:1568
  ds_read_b64_tr_b16 v[184:185], v105 offset:64
  ds_read_b64_tr_b16 v[186:187], v105 offset:1600
  ds_read_b64_tr_b16 v[188:189], v105 offset:12288
  ds_read_b64_tr_b16 v[190:191], v105 offset:13824
  ds_read_b64_tr_b16 v[192:193], v105 offset:12320
  ds_read_b64_tr_b16 v[194:195], v105 offset:13856
  ds_read_b64_tr_b16 v[82:83], v105 offset:12352
  ds_read_b64_tr_b16 v[84:85], v105 offset:13888
  s_waitcnt lgkmcnt(0)
  s_waitcnt vmcnt(12)
  s_barrier
  v_add_u32 v105, 122880, v104
  ds_read_b64_tr_b16 v[196:197], v105 offset:0
  ds_read_b64_tr_b16 v[198:199], v105 offset:1536
  ds_read_b64_tr_b16 v[200:201], v105 offset:32
  ds_read_b64_tr_b16 v[202:203], v105 offset:1568
  ds_read_b64_tr_b16 v[204:205], v105 offset:64
  ds_read_b64_tr_b16 v[206:207], v105 offset:1600
  ds_read_b64_tr_b16 v[208:209], v105 offset:12288
  ds_read_b64_tr_b16 v[210:211], v105 offset:13824
  ds_read_b64_tr_b16 v[212:213], v105 offset:12320
  ds_read_b64_tr_b16 v[214:215], v105 offset:13856
  ds_read_b64_tr_b16 v[86:87], v105 offset:12352
  ds_read_b64_tr_b16 v[88:89], v105 offset:13888
  s_waitcnt lgkmcnt(0)
  s_waitcnt vmcnt(6)
  s_barrier
  v_add_u32 v105, 0, v104
  ds_read_b64_tr_b16 v[216:217], v105 offset:0
  ds_read_b64_tr_b16 v[218:219], v105 offset:1536
  ds_read_b64_tr_b16 v[220:221], v105 offset:32
  ds_read_b64_tr_b16 v[222:223], v105 offset:1568
  ds_read_b64_tr_b16 v[224:225], v105 offset:64
  ds_read_b64_tr_b16 v[226:227], v105 offset:1600
  ds_read_b64_tr_b16 v[228:229], v105 offset:12288
  ds_read_b64_tr_b16 v[230:231], v105 offset:13824
  ds_read_b64_tr_b16 v[232:233], v105 offset:12320
  ds_read_b64_tr_b16 v[234:235], v105 offset:13856
  ds_read_b64_tr_b16 v[90:91], v105 offset:12352
  ds_read_b64_tr_b16 v[92:93], v105 offset:13888
  s_waitcnt lgkmcnt(0)
  s_waitcnt vmcnt(0)
  s_barrier
  v_add_u32 v105, 24576, v104
  ds_read_b64_tr_b16 v[236:237], v105 offset:0
  ds_read_b64_tr_b16 v[238:239], v105 offset:1536
  ds_read_b64_tr_b16 v[240:241], v105 offset:32
  ds_read_b64_tr_b16 v[242:243], v105 offset:1568
  ds_read_b64_tr_b16 v[244:245], v105 offset:64
  ds_read_b64_tr_b16 v[246:247], v105 offset:1600
  ds_read_b64_tr_b16 v[248:249], v105 offset:12288
  ds_read_b64_tr_b16 v[250:251], v105 offset:13824
  ds_read_b64_tr_b16 v[252:253], v105 offset:12320
  ds_read_b64_tr_b16 v[254:255], v105 offset:13856
  ds_read_b64_tr_b16 v[94:95], v105 offset:12352
  ds_read_b64_tr_b16 v[96:97], v105 offset:13888
  s_waitcnt lgkmcnt(0)
  s_barrier
  ds_write_b128 v5, v[18:21] offset:0
  ds_write_b128 v5, v[22:25] offset:1024
  ds_write_b128 v5, v[26:29] offset:2048
  ds_write_b128 v5, v[30:33] offset:3072
  ds_write_b128 v5, v[34:37] offset:4096
  ds_write_b128 v5, v[38:41] offset:5120
  ds_write_b128 v5, v[42:45] offset:6144
  ds_write_b128 v5, v[46:49] offset:7168
  ds_write_b128 v5, v[50:53] offset:8192
  ds_write_b128 v5, v[54:57] offset:9216
  ds_write_b128 v5, v[58:61] offset:10240
  ds_write_b128 v5, v[62:65] offset:11264
  ds_write_b128 v5, v[66:69] offset:12288
  ds_write_b128 v5, v[70:73] offset:13312
  ds_write_b128 v5, v[74:77] offset:14336
  ds_write_b128 v5, v[78:81] offset:15360
  ds_write_b128 v5, v[82:85] offset:16384
  ds_write_b128 v5, v[86:89] offset:17408
  ds_write_b128 v5, v[90:93] offset:18432
  ds_write_b128 v5, v[94:97] offset:19456
  s_waitcnt lgkmcnt(0)
  v_lshrrev_b32 v98, 4, v1
  v_and_b32 v100, 15, v1
  s_mul_i32 s57, s56, 3
  s_add_u32 s57, s57, 0
  s_lshr_b32 s58, s57, 1
  s_lshl_b32 s58, s58, 11
  s_and_b32 s57, s57, 1
  s_lshl_b32 s57, s57, 3
  s_add_u32 s57, s57, s58
  v_add_u32 v11, s57, v16
  s_mul_i32 s57, s56, 3
  s_add_u32 s57, s57, 1
  s_lshr_b32 s58, s57, 1
  s_lshl_b32 s58, s58, 11
  s_and_b32 s57, s57, 1
  s_lshl_b32 s57, s57, 3
  s_add_u32 s57, s57, s58
  v_add_u32 v108, s57, v16
  s_mul_i32 s57, s56, 3
  s_add_u32 s57, s57, 2
  s_lshr_b32 s58, s57, 1
  s_lshl_b32 s58, s58, 11
  s_and_b32 s57, s57, 1
  s_lshl_b32 s57, s57, 3
  s_add_u32 s57, s57, s58
  v_add_u32 v109, s57, v16
  s_mul_i32 s58, s56, 1536
  v_lshlrev_b32 v10, 3, v1
  v_add_u32 v10, s58, v10
  v_mul_u32_u24 v101, 208, v100
  s_mul_i32 s57, s56, 3328
  s_add_u32 s57, s57, 10240
  v_add_u32 v101, s57, v101
  v_lshl_add_u32 v12, v98, 4, v101
  v_lshl_add_u32 v110, v98, 5, v101
  v_lshrrev_b32 v101, 3, v1
  v_and_b32 v102, 7, v1
  v_mul_u32_u24 v13, 208, v101
  v_add_u32 v13, 10240, v13
  v_lshlrev_b32 v98, 5, v102
  v_add_u32 v98, 32, v98
  v_cmp_lt_u32 vcc, 0, v102
  s_nop 1
  v_cndmask_b32 v98, 0, v98, vcc
  v_cmp_gt_u32 vcc, 5, v102
  s_nop 1
  v_cndmask_b32 v98, 0, v98, vcc
  v_cndmask_b32 v111, 0, 1.0, vcc
  v_add_u32 v13, v13, v98
  s_lshr_b32 s57, s65, 1
  s_lshl_b32 s57, s57, 10
  s_and_b32 s58, s65, 1
  s_lshl_b32 s58, s58, 7
  s_add_u32 s57, s57, s58
  s_sub_u32 s57, s57, 256
  v_lshlrev_b32 v103, 8, v102
  v_add_u32 v103, s57, v103
  s_lshr_b32 s57, s65, 3
  s_lshl_b32 s57, s57, 10
  s_and_b32 s58, s65, 3
  s_lshl_b32 s58, s58, 8
  s_add_u32 s57, s57, s58
  s_bfe_u32 s58, s65, 65538
  s_lshl_b32 s58, s58, 7
  s_add_u32 s57, s57, s58
  s_add_u32 s57, s57, 16384
  v_mov_b32 v98, s57
  v_cmp_lt_u32 vcc, 0, v102
  s_nop 1
  v_cndmask_b32 v14, v98, v103, vcc
  v_lshl_add_u32 v14, v101, 4, v14
  s_mov_b32 s82, 522133279
  s_mov_b32 s83, 522133279
  s_mov_b32 s87, 1257472
  s_mov_b32 s64, 0
  s_mov_b32 s70, 11
  s_mov_b32 s71, 4
  s_mov_b32 s3, 0
  s_mov_b32 s77, 0
  s_mov_b32 s72, 0
  s_cmp_lg_u32 s56, 0
  s_cbranch_scc1 mai_spindkz0q_4
  s_mov_b32 s58, 0
mai_spinkz0q_3:
  buffer_load_dword v18, off, s[48:51], s72 sc1
  s_waitcnt vmcnt(0)
  v_readfirstlane_b32 s57, v18
  s_cmp_ge_u32 s57, 320
  s_cbranch_scc1 mai_spindkz0q_4
  s_sleep 10
  s_add_u32 s58, s58, 1
  s_cmp_lt_u32 s58, 4194304
  s_cbranch_scc1 mai_spinkz0q_3
mai_spindkz0q_4:
  s_barrier
mai_r_loopq:
  s_mov_b32 s57, s70
mai_dl_7:
  s_cmp_eq_u32 s57, 0
  s_cbranch_scc1 mai_dld_8
  s_sleep 1
  s_sub_u32 s57, s57, 1
  s_branch mai_dl_7
mai_dld_8:
  buffer_load_dwordx4 v[20:23], v2, s[48:51], s84 offen sc1
  buffer_load_dwordx4 v[24:27], v2, s[48:51], s85 offen sc1
  buffer_load_dwordx4 v[28:31], v3, s[48:51], s84 offen sc1
  s_mov_b32 s78, 0
  s_waitcnt vmcnt(0)
  v_max3_u32 v18, v20, v21, v22
  v_max3_u32 v18, v18, v23, v24
  v_max3_u32 v18, v18, v25, v26
  v_max3_u32 v18, v18, v27, v28
  v_max3_u32 v18, v18, v29, v30
  v_max_u32 v18, v18, v31
  v_cmp_eq_u32 vcc, -1, v18
  s_cbranch_vccz mai_gmd_6
mai_gm_5:
  buffer_load_dwordx4 v[20:23], v2, s[48:51], s84 offen sc1
  buffer_load_dwordx4 v[24:27], v2, s[48:51], s85 offen sc1
  buffer_load_dwordx4 v[28:31], v3, s[48:51], s84 offen sc1
  s_add_u32 s78, s78, 1
  s_waitcnt vmcnt(0)
  v_max3_u32 v18, v20, v21, v22
  v_max3_u32 v18, v18, v23, v24
  v_max3_u32 v18, v18, v25, v26
  v_max3_u32 v18, v18, v27, v28
  v_max3_u32 v18, v18, v29, v30
  v_max_u32 v18, v18, v31
  v_cmp_eq_u32 vcc, -1, v18
  s_cbranch_vccz mai_gmd_6
  s_cmp_lt_u32 s78, 1048576
  s_cbranch_scc1 mai_gm_5
mai_gmd_6:
  ds_write_b128 v2, v[20:23] offset:0
  ds_write_b128 v2, v[24:27] offset:4096
  ds_write_b128 v3, v[28:31] offset:0
  s_cmp_eq_u32 s78, 0
  s_cbranch_scc1 mai_ad_9
  s_add_u32 s70, s70, 2
  s_min_u32 s70, s70, 30
  s_mov_b32 s3, 0
  s_branch mai_ad_10
mai_ad_9:
  s_add_u32 s3, s3, 1
  s_cmp_lt_u32 s3, 4
  s_cbranch_scc1 mai_ad_10
  s_mov_b32 s3, 0
  s_max_u32 s70, s70, 1
  s_sub_u32 s70, s70, 1
mai_ad_10:
  s_waitcnt lgkmcnt(0)
  s_barrier
  ds_read_b128 v[20:23], v4 offset:0
  ds_read_b128 v[24:27], v4 offset:512
  buffer_load_dwordx2 v[84:85], v11, s[48:51], s94 offen offset:0 sc1
  buffer_load_dwordx2 v[86:87], v108, s[48:51], s94 offen offset:0 sc1
  s_waitcnt lgkmcnt(1)
  v_mfma_f32_16x16x32_bf16 v[44:47], a[0:3], v[20:23], 0
  ds_read_b128 v[28:31], v4 offset:1024
  v_mfma_f32_16x16x32_bf16 v[48:51], a[4:7], v[20:23], 0
  buffer_load_dwordx2 v[88:89], v109, s[48:51], s94 offen offset:0 sc1
  v_mfma_f32_16x16x32_bf16 v[52:55], a[8:11], v[20:23], 0
  s_waitcnt lgkmcnt(1)
  v_mfma_f32_16x16x32_bf16 v[44:47], a[20:23], v[24:27], v[44:47]
  ds_read_b128 v[20:23], v4 offset:1536
  v_mfma_f32_16x16x32_bf16 v[48:51], a[24:27], v[24:27], v[48:51]
  buffer_load_dwordx2 v[90:91], v11, s[48:51], s94 offen offset:1024 sc1
  v_mfma_f32_16x16x32_bf16 v[52:55], a[28:31], v[24:27], v[52:55]
  s_waitcnt lgkmcnt(1)
  v_mfma_f32_16x16x32_bf16 v[44:47], a[40:43], v[28:31], v[44:47]
  ds_read_b128 v[24:27], v4 offset:2048
  v_mfma_f32_16x16x32_bf16 v[48:51], a[44:47], v[28:31], v[48:51]
  buffer_load_dwordx2 v[92:93], v108, s[48:51], s94 offen offset:1024 sc1
  v_mfma_f32_16x16x32_bf16 v[52:55], a[48:51], v[28:31], v[52:55]
  s_waitcnt lgkmcnt(1)
  v_mfma_f32_16x16x32_bf16 v[44:47], a[60:63], v[20:23], v[44:47]
  ds_read_b128 v[28:31], v4 offset:2560
  v_mfma_f32_16x16x32_bf16 v[48:51], a[64:67], v[20:23], v[48:51]
  buffer_load_dwordx2 v[94:95], v109, s[48:51], s94 offen offset:1024 sc1
  v_mfma_f32_16x16x32_bf16 v[52:55], a[68:71], v[20:23], v[52:55]
  s_waitcnt lgkmcnt(1)
  v_mfma_f32_16x16x32_bf16 v[44:47], a[80:83], v[24:27], v[44:47]
  ds_read_b128 v[20:23], v4 offset:3072
  v_mfma_f32_16x16x32_bf16 v[48:51], a[84:87], v[24:27], v[48:51]
  s_lshl_b32 s75, s56, 13
  s_add_u32 s75, s75, 32768
  s_add_u32 s72, s96, 16384
  s_cmp_lt_u32 s101, 2
  s_cselect_b32 s76, s96, s72
  s_add_u32 s72, s96, 0
  s_add_u32 m0, s75, 0
  s_nop 0
  buffer_load_dwordx4 v9, s[48:51], s72 offen sc1 lds
  v_mfma_f32_16x16x32_bf16 v[52:55], a[88:91], v[24:27], v[52:55]
  s_waitcnt lgkmcnt(1)
  v_mfma_f32_16x16x32_bf16 v[44:47], a[100:103], v[28:31], v[44:47]
  ds_read_b128 v[24:27], v4 offset:3584
  v_mfma_f32_16x16x32_bf16 v[48:51], a[104:107], v[28:31], v[48:51]
  s_add_u32 s72, s96, 1024
  s_add_u32 m0, s75, 1024
  s_nop 0
  buffer_load_dwordx4 v9, s[48:51], s72 offen sc1 lds
  v_mfma_f32_16x16x32_bf16 v[52:55], a[108:111], v[28:31], v[52:55]
  s_waitcnt lgkmcnt(1)
  v_mfma_f32_16x16x32_bf16 v[44:47], a[120:123], v[20:23], v[44:47]
  ds_read_b128 v[28:31], v4 offset:4096
  v_mfma_f32_16x16x32_bf16 v[48:51], a[124:127], v[20:23], v[48:51]
  s_add_u32 s72, s96, 2048
  s_add_u32 m0, s75, 2048
  s_nop 0
  buffer_load_dwordx4 v9, s[48:51], s72 offen sc1 lds
  v_mfma_f32_16x16x32_bf16 v[52:55], a[128:131], v[20:23], v[52:55]
  s_waitcnt lgkmcnt(1)
  v_mfma_f32_16x16x32_bf16 v[44:47], a[140:143], v[24:27], v[44:47]
  ds_read_b128 v[20:23], v4 offset:4608
  v_mfma_f32_16x16x32_bf16 v[48:51], a[144:147], v[24:27], v[48:51]
  s_add_u32 s72, s96, 3072
  s_add_u32 m0, s75, 3072
  s_nop 0
  buffer_load_dwordx4 v9, s[48:51], s72 offen sc1 lds
  v_mfma_f32_16x16x32_bf16 v[52:55], a[148:151], v[24:27], v[52:55]
  s_waitcnt lgkmcnt(1)
  v_mfma_f32_16x16x32_bf16 v[44:47], a[160:163], v[28:31], v[44:47]
  ds_read_b128 v[24:27], v4 offset:5120
  v_mfma_f32_16x16x32_bf16 v[48:51], a[164:167], v[28:31], v[48:51]
  s_cmp_lg_u32 s56, 0
  s_cbranch_scc1 mai_rs_11
  s_cmp_eq_u32 s64, 0
  s_cbranch_scc1 mai_rs_11
  v_mov_b32 v19, 1
  s_sub_u32 s57, s98, 8192
  s_mov_b64 exec, 1
  buffer_store_dword v19, off, s[48:51], s57 sc1
  s_mov_b64 exec, -1
mai_rs_11:
  v_mfma_f32_16x16x32_bf16 v[52:55], a[168:171], v[28:31], v[52:55]
  s_waitcnt lgkmcnt(1)
  v_mfma_f32_16x16x32_bf16 v[44:47], a[180:183], v[20:23], v[44:47]
  ds_read_b128 v[28:31], v4 offset:5632
  v_mfma_f32_16x16x32_bf16 v[48:51], a[184:187], v[20:23], v[48:51]
  v_mfma_f32_16x16x32_bf16 v[52:55], a[188:191], v[20:23], v[52:55]
  s_waitcnt lgkmcnt(1)
  v_mfma_f32_16x16x32_bf16 v[44:47], a[200:203], v[24:27], v[44:47]
  ds_read_b128 v[20:23], v4 offset:6144
  v_mfma_f32_16x16x32_bf16 v[48:51], a[204:207], v[24:27], v[48:51]
  v_mfma_f32_16x16x32_bf16 v[52:55], a[208:211], v[24:27], v[52:55]
  s_waitcnt lgkmcnt(1)
  v_mfma_f32_16x16x32_bf16 v[44:47], a[220:223], v[28:31], v[44:47]
  ds_read_b128 v[24:27], v4 offset:6656
  v_mfma_f32_16x16x32_bf16 v[48:51], a[224:227], v[28:31], v[48:51]
  v_mfma_f32_16x16x32_bf16 v[52:55], a[228:231], v[28:31], v[52:55]
  s_waitcnt lgkmcnt(1)
  v_mfma_f32_16x16x32_bf16 v[44:47], a[240:243], v[20:23], v[44:47]
  ds_read_b128 v[28:31], v4 offset:7168
  v_mfma_f32_16x16x32_bf16 v[48:51], a[244:247], v[20:23], v[48:51]
  v_mfma_f32_16x16x32_bf16 v[52:55], a[248:251], v[20:23], v[52:55]
  s_waitcnt lgkmcnt(1)
  v_mfma_f32_16x16x32_bf16 v[44:47], v[116:119], v[24:27], v[44:47]
  ds_read_b128 v[20:23], v4 offset:7680
  v_mfma_f32_16x16x32_bf16 v[48:51], v[120:123], v[24:27], v[48:51]
  v_mfma_f32_16x16x32_bf16 v[52:55], v[124:127], v[24:27], v[52:55]
  s_waitcnt lgkmcnt(1)
  v_mfma_f32_16x16x32_bf16 v[44:47], v[136:139], v[28:31], v[44:47]
  ds_read_b128 v[24:27], v4 offset:8192
  v_mfma_f32_16x16x32_bf16 v[48:51], v[140:143], v[28:31], v[48:51]
  v_mfma_f32_16x16x32_bf16 v[52:55], v[144:147], v[28:31], v[52:55]
  s_waitcnt lgkmcnt(1)
  v_mfma_f32_16x16x32_bf16 v[44:47], v[156:159], v[20:23], v[44:47]
  ds_read_b128 v[28:31], v4 offset:8704
  v_mfma_f32_16x16x32_bf16 v[48:51], v[160:163], v[20:23], v[48:51]
  v_mfma_f32_16x16x32_bf16 v[52:55], v[164:167], v[20:23], v[52:55]
  s_waitcnt lgkmcnt(1)
  v_mfma_f32_16x16x32_bf16 v[44:47], v[176:179], v[24:27], v[44:47]
  ds_read_b128 v[20:23], v4 offset:9216
  v_mfma_f32_16x16x32_bf16 v[48:51], v[180:183], v[24:27], v[48:51]
  v_mfma_f32_16x16x32_bf16 v[52:55], v[184:187], v[24:27], v[52:55]
  s_waitcnt lgkmcnt(1)
  v_mfma_f32_16x16x32_bf16 v[44:47], v[196:199], v[28:31], v[44:47]
  ds_read_b128 v[24:27], v4 offset:9728
  v_mfma_f32_16x16x32_bf16 v[48:51], v[200:203], v[28:31], v[48:51]
  v_mfma_f32_16x16x32_bf16 v[52:55], v[204:207], v[28:31], v[52:55]
  s_waitcnt lgkmcnt(1)
  v_mfma_f32_16x16x32_bf16 v[44:47], v[216:219], v[20:23], v[44:47]
  ds_read_b128 v[28:31], v4 offset:0
  ds_read_b128 v[40:43], v5 offset:0
  v_mfma_f32_16x16x32_bf16 v[48:51], v[220:223], v[20:23], v[48:51]
  v_mfma_f32_16x16x32_bf16 v[52:55], v[224:227], v[20:23], v[52:55]
  s_waitcnt lgkmcnt(2)
  v_mfma_f32_16x16x32_bf16 v[44:47], v[236:239], v[24:27], v[44:47]
  ds_read_b128 v[20:23], v4 offset:512
  ds_read_b128 v[32:35], v5 offset:1024
  v_mfma_f32_16x16x32_bf16 v[48:51], v[240:243], v[24:27], v[48:51]
  v_mfma_f32_16x16x32_bf16 v[52:55], v[244:247], v[24:27], v[52:55]
  s_waitcnt lgkmcnt(2)
  v_mfma_f32_16x16x32_bf16 v[56:59], a[12:15], v[28:31], 0
  ds_read_b128 v[24:27], v4 offset:1024
  ds_read_b128 v[36:39], v5 offset:2048
  v_mfma_f32_16x16x32_bf16 v[60:63], a[16:19], v[28:31], 0
  v_mfma_f32_16x16x32_bf16 v[64:67], v[40:43], v[28:31], 0
  s_waitcnt lgkmcnt(2)
  v_mfma_f32_16x16x32_bf16 v[56:59], a[32:35], v[20:23], v[56:59]
  ds_read_b128 v[28:31], v4 offset:1536
  ds_read_b128 v[40:43], v5 offset:3072
  v_mfma_f32_16x16x32_bf16 v[60:63], a[36:39], v[20:23], v[60:63]
  v_mfma_f32_16x16x32_bf16 v[64:67], v[32:35], v[20:23], v[64:67]
  s_waitcnt lgkmcnt(2)
  v_mfma_f32_16x16x32_bf16 v[56:59], a[52:55], v[24:27], v[56:59]
  ds_read_b128 v[20:23], v4 offset:2048
  ds_read_b128 v[32:35], v5 offset:4096
  v_mfma_f32_16x16x32_bf16 v[60:63], a[56:59], v[24:27], v[60:63]
  v_mfma_f32_16x16x32_bf16 v[64:67], v[36:39], v[24:27], v[64:67]
  s_waitcnt lgkmcnt(2)
  v_mfma_f32_16x16x32_bf16 v[56:59], a[72:75], v[28:31], v[56:59]
  ds_read_b128 v[24:27], v4 offset:2560
  ds_read_b128 v[36:39], v5 offset:5120
  v_mfma_f32_16x16x32_bf16 v[60:63], a[76:79], v[28:31], v[60:63]
  v_mfma_f32_16x16x32_bf16 v[64:67], v[40:43], v[28:31], v[64:67]
  s_waitcnt lgkmcnt(2)
  v_mfma_f32_16x16x32_bf16 v[56:59], a[92:95], v[20:23], v[56:59]
  ds_read_b128 v[28:31], v4 offset:3072
  ds_read_b128 v[40:43], v5 offset:6144
  v_mfma_f32_16x16x32_bf16 v[60:63], a[96:99], v[20:23], v[60:63]
  v_cvt_pk_bf16_f32 v96, v44, v45
  v_cvt_pk_bf16_f32 v97, v46, v47
  v_cvt_pk_bf16_f32 v98, v48, v49
  v_cvt_pk_bf16_f32 v99, v50, v51
  v_cvt_pk_bf16_f32 v100, v52, v53
  v_cvt_pk_bf16_f32 v101, v54, v55
  v_mfma_f32_16x16x32_bf16 v[64:67], v[32:35], v[20:23], v[64:67]
  s_waitcnt lgkmcnt(2)
  v_mfma_f32_16x16x32_bf16 v[56:59], a[112:115], v[24:27], v[56:59]
  ds_read_b128 v[20:23], v4 offset:3584
  ds_read_b128 v[32:35], v5 offset:7168
  v_mfma_f32_16x16x32_bf16 v[60:63], a[116:119], v[24:27], v[60:63]
  v_mfma_f32_16x16x32_bf16 v[64:67], v[36:39], v[24:27], v[64:67]
  s_waitcnt lgkmcnt(2)
  v_mfma_f32_16x16x32_bf16 v[56:59], a[132:135], v[28:31], v[56:59]
  ds_read_b128 v[24:27], v4 offset:4096
  ds_read_b128 v[36:39], v5 offset:8192
  v_mfma_f32_16x16x32_bf16 v[60:63], a[136:139], v[28:31], v[60:63]
  v_mfma_f32_16x16x32_bf16 v[64:67], v[40:43], v[28:31], v[64:67]
  s_waitcnt lgkmcnt(2)
  v_mfma_f32_16x16x32_bf16 v[56:59], a[152:155], v[20:23], v[56:59]
  ds_read_b128 v[28:31], v4 offset:4608
  ds_read_b128 v[40:43], v5 offset:9216
  v_mfma_f32_16x16x32_bf16 v[60:63], a[156:159], v[20:23], v[60:63]
  v_mfma_f32_16x16x32_bf16 v[64:67], v[32:35], v[20:23], v[64:67]
  s_waitcnt lgkmcnt(2)
  v_mfma_f32_16x16x32_bf16 v[56:59], a[172:175], v[24:27], v[56:59]
  ds_read_b128 v[20:23], v4 offset:5120
  ds_read_b128 v[32:35], v5 offset:10240
  v_mfma_f32_16x16x32_bf16 v[60:63], a[176:179], v[24:27], v[60:63]
  v_mfma_f32_16x16x32_bf16 v[64:67], v[36:39], v[24:27], v[64:67]
  s_waitcnt lgkmcnt(2)
  v_mfma_f32_16x16x32_bf16 v[56:59], a[192:195], v[28:31], v[56:59]
  ds_read_b128 v[24:27], v4 offset:5632
  ds_read_b128 v[36:39], v5 offset:11264
  v_mfma_f32_16x16x32_bf16 v[60:63], a[196:199], v[28:31], v[60:63]
  v_mfma_f32_16x16x32_bf16 v[64:67], v[40:43], v[28:31], v[64:67]
  s_waitcnt lgkmcnt(2)
  v_mfma_f32_16x16x32_bf16 v[56:59], a[212:215], v[20:23], v[56:59]
  ds_read_b128 v[28:31], v4 offset:6144
  ds_read_b128 v[40:43], v5 offset:12288
  v_mfma_f32_16x16x32_bf16 v[60:63], a[216:219], v[20:23], v[60:63]
  s_waitcnt vmcnt(4)
  v_mfma_f32_16x16x16_bf16 v[72:75], v[84:85], v[96:97], 0
  v_mfma_f32_16x16x16_bf16 v[76:79], v[90:91], v[96:97], 0
  v_mfma_f32_16x16x32_bf16 v[64:67], v[32:35], v[20:23], v[64:67]
  s_waitcnt lgkmcnt(2)
  v_mfma_f32_16x16x32_bf16 v[56:59], a[232:235], v[24:27], v[56:59]
  ds_read_b128 v[20:23], v4 offset:6656
  ds_read_b128 v[32:35], v5 offset:13312
  v_mfma_f32_16x16x32_bf16 v[60:63], a[236:239], v[24:27], v[60:63]
  v_mfma_f32_16x16x16_bf16 v[72:75], v[86:87], v[98:99], v[72:75]
  v_mfma_f32_16x16x16_bf16 v[76:79], v[92:93], v[98:99], v[76:79]
  v_mfma_f32_16x16x32_bf16 v[64:67], v[36:39], v[24:27], v[64:67]
  s_waitcnt lgkmcnt(2)
  v_mfma_f32_16x16x32_bf16 v[56:59], a[252:255], v[28:31], v[56:59]
  ds_read_b128 v[24:27], v4 offset:7168
  ds_read_b128 v[36:39], v5 offset:14336
  v_mfma_f32_16x16x32_bf16 v[60:63], v[112:115], v[28:31], v[60:63]
  v_mfma_f32_16x16x16_bf16 v[72:75], v[88:89], v[100:101], v[72:75]
  v_mfma_f32_16x16x16_bf16 v[76:79], v[94:95], v[100:101], v[76:79]
  v_mfma_f32_16x16x32_bf16 v[64:67], v[40:43], v[28:31], v[64:67]
  s_waitcnt lgkmcnt(2)
  v_mfma_f32_16x16x32_bf16 v[56:59], v[128:131], v[20:23], v[56:59]
  ds_read_b128 v[28:31], v4 offset:7680
  ds_read_b128 v[40:43], v5 offset:15360
  v_mfma_f32_16x16x32_bf16 v[60:63], v[132:135], v[20:23], v[60:63]
  v_mfma_f32_16x16x32_bf16 v[64:67], v[32:35], v[20:23], v[64:67]
  s_waitcnt lgkmcnt(2)
  v_mfma_f32_16x16x32_bf16 v[56:59], v[148:151], v[24:27], v[56:59]
  ds_read_b128 v[20:23], v4 offset:8192
  ds_read_b128 v[32:35], v5 offset:16384
  v_mfma_f32_16x16x32_bf16 v[60:63], v[152:155], v[24:27], v[60:63]
  v_mfma_f32_16x16x32_bf16 v[64:67], v[36:39], v[24:27], v[64:67]
  s_waitcnt lgkmcnt(2)
  v_mfma_f32_16x16x32_bf16 v[56:59], v[168:171], v[28:31], v[56:59]
  ds_read_b128 v[24:27], v4 offset:8704
  ds_read_b128 v[36:39], v5 offset:17408
  v_mfma_f32_16x16x32_bf16 v[60:63], v[172:175], v[28:31], v[60:63]
  v_mfma_f32_16x16x32_bf16 v[64:67], v[40:43], v[28:31], v[64:67]
  s_waitcnt lgkmcnt(2)
  v_mfma_f32_16x16x32_bf16 v[56:59], v[188:191], v[20:23], v[56:59]
  ds_read_b128 v[28:31], v4 offset:9216
  ds_read_b128 v[40:43], v5 offset:18432
  v_mfma_f32_16x16x32_bf16 v[60:63], v[192:195], v[20:23], v[60:63]
  v_mfma_f32_16x16x32_bf16 v[64:67], v[32:35], v[20:23], v[64:67]
  s_waitcnt lgkmcnt(2)
  v_mfma_f32_16x16x32_bf16 v[56:59], v[208:211], v[24:27], v[56:59]
  ds_read_b128 v[20:23], v4 offset:9728
  ds_read_b128 v[32:35], v5 offset:19456
  v_mfma_f32_16x16x32_bf16 v[60:63], v[212:215], v[24:27], v[60:63]
  v_mfma_f32_16x16x32_bf16 v[64:67], v[36:39], v[24:27], v[64:67]
  s_waitcnt lgkmcnt(2)
  v_mfma_f32_16x16x32_bf16 v[56:59], v[228:231], v[28:31], v[56:59]
  v_mfma_f32_16x16x32_bf16 v[60:63], v[232:235], v[28:31], v[60:63]
  v_mfma_f32_16x16x32_bf16 v[64:67], v[40:43], v[28:31], v[64:67]
  s_waitcnt lgkmcnt(0)
  v_mfma_f32_16x16x32_bf16 v[56:59], v[248:251], v[20:23], v[56:59]
  v_mfma_f32_16x16x32_bf16 v[60:63], v[252:255], v[20:23], v[60:63]
  v_mfma_f32_16x16x32_bf16 v[64:67], v[32:35], v[20:23], v[64:67]
  s_waitcnt vmcnt(0)
  ds_write_b128 v110, v[72:75] offset:64
  ds_write_b128 v110, v[76:79] offset:80
  s_nop 2
  v_cvt_pk_bf16_f32 v102, v56, v57
  v_cvt_pk_bf16_f32 v103, v58, v59
  v_cvt_pk_bf16_f32 v104, v60, v61
  v_cvt_pk_bf16_f32 v105, v62, v63
  v_cvt_pk_bf16_f32 v106, v64, v65
  v_cvt_pk_bf16_f32 v107, v66, v67
  v_mfma_f32_16x16x16_bf16 v[68:71], v[102:103], v[96:97], 0
  v_mfma_f32_16x16x16_bf16 v[68:71], v[104:105], v[98:99], v[68:71]
  v_mfma_f32_16x16x16_bf16 v[68:71], v[106:107], v[100:101], v[68:71]
  s_nop 7
  ds_write_b128 v12, v[68:71]
  s_waitcnt lgkmcnt(0)
  s_barrier
  s_cmp_lg_u32 s56, 0
  s_cbranch_scc1 mai_qksk_12
  ds_read_b128 v[20:23], v13 offset:0
  ds_read_b128 v[24:27], v13 offset:16
  ds_read_b128 v[28:31], v13 offset:3328
  ds_read_b128 v[32:35], v13 offset:3344
  ds_read_b128 v[36:39], v13 offset:6656
  ds_read_b128 v[40:43], v13 offset:6672
  ds_read_b128 v[44:47], v13 offset:9984
  ds_read_b128 v[48:51], v13 offset:10000
  s_waitcnt lgkmcnt(4)
  v_pk_add_f32 v[20:21], v[20:21], v[28:29]
  v_pk_add_f32 v[22:23], v[22:23], v[30:31]
  v_pk_add_f32 v[24:25], v[24:25], v[32:33]
  v_pk_add_f32 v[26:27], v[26:27], v[34:35]
  s_waitcnt lgkmcnt(0)
  v_pk_add_f32 v[36:37], v[36:37], v[44:45]
  v_pk_add_f32 v[38:39], v[38:39], v[46:47]
  v_pk_add_f32 v[40:41], v[40:41], v[48:49]
  v_pk_add_f32 v[42:43], v[42:43], v[50:51]
  v_pk_add_f32 v[52:53], v[20:21], v[36:37]
  v_pk_add_f32 v[54:55], v[22:23], v[38:39]
  v_pk_add_f32 v[56:57], v[24:25], v[40:41]
  v_pk_add_f32 v[58:59], v[26:27], v[42:43]
  v_max3_f32 v60, v52, v53, v54
  v_max3_f32 v61, v55, v56, v57
  v_max3_f32 v60, v60, v58, v59
  v_max_f32 v60, v60, v61
  s_nop 1
  v_max_f32_dpp v60, v60, v60 quad_perm:[1,0,3,2] row_mask:0xf bank_mask:0xf
  s_nop 1
  v_max_f32_dpp v60, v60, v60 quad_perm:[2,3,0,1] row_mask:0xf bank_mask:0xf
  s_nop 1
  v_max_f32_dpp v60, v60, v60 row_half_mirror row_mask:0xf bank_mask:0xf
  v_sub_f32 v52, v52, v60
  v_sub_f32 v53, v53, v60
  v_sub_f32 v54, v54, v60
  v_sub_f32 v55, v55, v60
  v_sub_f32 v56, v56, v60
  v_sub_f32 v57, v57, v60
  v_sub_f32 v58, v58, v60
  v_sub_f32 v59, v59, v60
  v_mul_f32 v52, s99, v52
  v_mul_f32 v53, s99, v53
  v_mul_f32 v54, s99, v54
  v_mul_f32 v55, s99, v55
  v_mul_f32 v56, s99, v56
  v_mul_f32 v57, s99, v57
  v_mul_f32 v58, s99, v58
  v_mul_f32 v59, s99, v59
  v_exp_f32 v52, v52
  v_exp_f32 v53, v53
  v_exp_f32 v54, v54
  v_exp_f32 v55, v55
  v_exp_f32 v56, v56
  v_exp_f32 v57, v57
  v_exp_f32 v58, v58
  v_exp_f32 v59, v59
  v_pk_add_f32 v[20:21], v[52:53], v[54:55]
  v_pk_add_f32 v[22:23], v[56:57], v[58:59]
  v_pk_add_f32 v[20:21], v[20:21], v[22:23]
  v_add_f32 v60, v20, v21
  v_mul_f32 v60, v60, v111
  s_nop 1
  v_add_f32_dpp v60, v60, v60 quad_perm:[1,0,3,2] row_mask:0xf bank_mask:0xf
  s_nop 1
  v_add_f32_dpp v60, v60, v60 quad_perm:[2,3,0,1] row_mask:0xf bank_mask:0xf
  s_nop 1
  v_add_f32_dpp v60, v60, v60 row_half_mirror row_mask:0xf bank_mask:0xf
  v_rcp_f32 v60, v60
  s_nop 0
  v_mul_f32 v52, v52, v60
  v_mul_f32 v53, v53, v60
  v_mul_f32 v54, v54, v60
  v_mul_f32 v55, v55, v60
  v_mul_f32 v56, v56, v60
  v_mul_f32 v57, v57, v60
  v_mul_f32 v58, v58, v60
  v_mul_f32 v59, v59, v60
  v_cvt_pk_bf16_f32 v64, v52, v53
  v_cvt_pk_bf16_f32 v65, v54, v55
  v_cvt_pk_bf16_f32 v66, v56, v57
  v_cvt_pk_bf16_f32 v67, v58, v59
  v_min_u32 v64, s100, v64
  v_min_u32 v65, s100, v65
  v_min_u32 v66, s100, v66
  v_min_u32 v67, s100, v67
  s_mov_b64 exec, s[82:83]
  buffer_store_dwordx4 v[64:67], v14, s[48:51], s87 offen sc1
  s_mov_b64 exec, -1
mai_qksk_12:
  s_barrier
  buffer_store_dwordx2 v[102:103], v10, s[48:51], s91 offen offset:0 sc1
  buffer_store_dwordx2 v[104:105], v10, s[48:51], s91 offen offset:512 sc1
  buffer_store_dwordx2 v[106:107], v10, s[48:51], s91 offen offset:1024 sc1
  s_cmp_eq_u32 s64, 63
  s_cbranch_scc1 mai_r_finq
  s_add_u32 s97, s64, 1
  s_lshr_b32 s97, s97, 2
  s_min_u32 s97, s97, 15
  s_lshl_b32 s97, s97, 7
  s_add_u32 s97, s97, 0
  s_cmp_eq_u32 s64, 14
  s_cselect_b32 s97, 24576, s97
  s_cselect_b32 s79, 3, 1
  s_mul_i32 s79, s79, 320
  ds_read_b128 v[52:55], v17 offset:32768
  ds_read_b128 v[56:59], v17 offset:33792
  ds_read_b128 v[60:63], v17 offset:34816
  ds_read_b128 v[64:67], v17 offset:35840
  s_cmp_lt_u32 s101, 2
  s_cselect_b32 s74, s88, s89
  s_mov_b32 s57, s71
mai_dl_15:
  s_cmp_eq_u32 s57, 0
  s_cbranch_scc1 mai_dld_16
  s_sleep 1
  s_sub_u32 s57, s57, 1
  s_branch mai_dl_15
mai_dld_16:
  buffer_load_dwordx4 v[20:23], v6, s[48:51], s86 offen offset:0 sc1
  buffer_load_dwordx4 v[24:27], v6, s[48:51], s86 offen offset:1024 sc1
  buffer_load_dwordx4 v[28:31], v6, s[48:51], s86 offen offset:2048 sc1
  buffer_load_dwordx4 v[32:35], v6, s[48:51], s86 offen offset:3072 sc1
  buffer_load_dwordx4 v[36:39], v7, s[48:51], s86 offen sc1
  buffer_load_dwordx4 v[40:43], v8, s[48:51], s88 offen sc1
  buffer_load_dword v48, off, s[48:51], s97 sc1
  s_mov_b32 s78, 0
  s_waitcnt lgkmcnt(0)
  s_waitcnt vmcnt(0)
  v_max3_u32 v18, v20, v21, v22
  v_max3_u32 v18, v18, v23, v24
  v_max3_u32 v18, v18, v25, v26
  v_max3_u32 v18, v18, v27, v28
  v_max3_u32 v18, v18, v29, v30
  v_max3_u32 v18, v18, v31, v32
  v_max3_u32 v18, v18, v33, v34
  v_max3_u32 v18, v18, v35, v36
  v_max3_u32 v18, v18, v37, v38
  v_max3_u32 v18, v18, v39, v40
  v_max3_u32 v18, v18, v41, v42
  v_max_u32 v18, v18, v43
  v_cmp_eq_u32 vcc, -1, v18
  v_cmp_gt_u32 s[80:81], s79, v48
  s_or_b64 vcc, vcc, s[80:81]
  s_cbranch_vccz mai_gbd_14
mai_gb_13:
  buffer_load_dwordx4 v[20:23], v6, s[48:51], s86 offen offset:0 sc1
  buffer_load_dwordx4 v[24:27], v6, s[48:51], s86 offen offset:1024 sc1
  buffer_load_dwordx4 v[28:31], v6, s[48:51], s86 offen offset:2048 sc1
  buffer_load_dwordx4 v[32:35], v6, s[48:51], s86 offen offset:3072 sc1
  buffer_load_dwordx4 v[36:39], v7, s[48:51], s86 offen sc1
  buffer_load_dwordx4 v[40:43], v8, s[48:51], s88 offen sc1
  buffer_load_dword v48, off, s[48:51], s97 sc1
  s_add_u32 s78, s78, 1
  s_waitcnt vmcnt(0)
  v_max3_u32 v18, v20, v21, v22
  v_max3_u32 v18, v18, v23, v24
  v_max3_u32 v18, v18, v25, v26
  v_max3_u32 v18, v18, v27, v28
  v_max3_u32 v18, v18, v29, v30
  v_max3_u32 v18, v18, v31, v32
  v_max3_u32 v18, v18, v33, v34
  v_max3_u32 v18, v18, v35, v36
  v_max3_u32 v18, v18, v37, v38
  v_max3_u32 v18, v18, v39, v40
  v_max3_u32 v18, v18, v41, v42
  v_max_u32 v18, v18, v43
  v_cmp_eq_u32 vcc, -1, v18
  v_cmp_gt_u32 s[80:81], s79, v48
  s_or_b64 vcc, vcc, s[80:81]
  s_cbranch_vccz mai_gbd_14
  s_cmp_lt_u32 s78, 1048576
  s_cbranch_scc1 mai_gb_13
mai_gbd_14:
  v_mfma_f32_16x16x32_bf16 v[84:87], v[40:43], v[36:39], 0
  v_mfma_f32_16x16x32_bf16 v[84:87], v[52:55], v[20:23], v[84:87]
  v_mfma_f32_16x16x32_bf16 v[84:87], v[56:59], v[24:27], v[84:87]
  v_mfma_f32_16x16x32_bf16 v[84:87], v[60:63], v[28:31], v[84:87]
  v_mfma_f32_16x16x32_bf16 v[84:87], v[64:67], v[32:35], v[84:87]
  s_cmp_eq_u32 s78, 0
  s_cbranch_scc1 mai_ad_17
  s_add_u32 s71, s71, 2
  s_min_u32 s71, s71, 30
  s_mov_b32 s77, 0
  s_branch mai_ad_18
mai_ad_17:
  s_add_u32 s77, s77, 1
  s_cmp_lt_u32 s77, 4
  s_cbranch_scc1 mai_ad_18
  s_mov_b32 s77, 0
  s_max_u32 s71, s71, 1
  s_sub_u32 s71, s71, 1
mai_ad_18:
  s_lshl_b32 s57, s56, 10
  v_add_u32 v18, s57, v16
  s_nop 0
  ds_write_b128 v18, v[84:87] offset:23552
  s_lshl_b32 s57, s56, 12
  v_add_u32 v19, s57, v16
  s_lshl_b32 s58, s56, 7
  s_add_u32 s58, s58, s90
  s_waitcnt lgkmcnt(0)
  s_barrier
  s_cmp_ge_u32 s56, s101
  s_cbranch_scc1 mai_cbsk_19
  ds_read_b128 v[20:23], v19 offset:23552
  ds_read_b128 v[24:27], v19 offset:24192
  ds_read_b128 v[28:31], v19 offset:24576
  ds_read_b128 v[32:35], v19 offset:25216
  ds_read_b128 v[36:39], v19 offset:25600
  ds_read_b128 v[40:43], v19 offset:26240
  ds_read_b128 v[44:47], v19 offset:26624
  ds_read_b128 v[48:51], v19 offset:27264
  s_waitcnt lgkmcnt(4)
  v_pk_add_f32 v[20:21], v[20:21], v[24:25]
  v_pk_add_f32 v[28:29], v[28:29], v[32:33]
  v_pk_add_f32 v[22:23], v[22:23], v[26:27]
  v_pk_add_f32 v[30:31], v[30:31], v[34:35]
  s_waitcnt lgkmcnt(0)
  v_pk_add_f32 v[36:37], v[36:37], v[40:41]
  v_pk_add_f32 v[44:45], v[44:45], v[48:49]
  v_pk_add_f32 v[38:39], v[38:39], v[42:43]
  v_pk_add_f32 v[46:47], v[46:47], v[50:51]
  v_pk_add_f32 v[20:21], v[20:21], v[28:29]
  v_pk_add_f32 v[36:37], v[36:37], v[44:45]
  v_pk_add_f32 v[22:23], v[22:23], v[30:31]
  v_pk_add_f32 v[38:39], v[38:39], v[46:47]
  v_pk_add_f32 v[20:21], v[20:21], v[36:37]
  v_pk_add_f32 v[22:23], v[22:23], v[38:39]
  v_cvt_pk_bf16_f32 v52, v20, v21
  v_cvt_pk_bf16_f32 v53, v22, v23
  v_min_u32 v52, s100, v52
  v_min_u32 v53, s100, v53
  s_mov_b64 exec, s[68:69]
  buffer_store_dwordx2 v[52:53], v15, s[48:51], s58 offen sc1
mai_cbsk_19:
  s_mov_b64 exec, -1
  s_barrier
  s_add_u32 s64, s64, 1
  s_add_u32 s84, s84, 10240
  s_add_u32 s85, s85, 10240
  s_add_u32 s86, s86, 20480
  s_add_u32 s88, s88, 327680
  s_add_u32 s89, s89, 327680
  s_add_u32 s90, s90, 10240
  s_add_u32 s91, s91, 196608
  s_add_u32 s94, s94, 393216
  s_add_u32 s96, s96, 1310720
  s_add_u32 s98, s98, 8192
  s_add_u32 s87, s87, 20480
  s_branch mai_r_loopq
mai_r_finq:
  s_waitcnt vmcnt(0)
  s_barrier
  s_add_u32 s64, s64, 1
  s_add_u32 s98, s98, 8192
  s_cmp_lg_u32 s56, 0
  s_cbranch_scc1 mai_rs_20
  s_cmp_eq_u32 s64, 0
  s_cbranch_scc1 mai_rs_20
  v_mov_b32 v19, 1
  s_sub_u32 s57, s98, 8192
  s_mov_b64 exec, 1
  buffer_store_dword v19, off, s[48:51], s57 sc1
  s_mov_b64 exec, -1
mai_rs_20:
  s_branch mai_k_exit
mai_r_init_vo:
  v_lshrrev_b32 v98, 4, v1
  v_bfe_u32 v99, v1, 2, 2
  v_and_b32 v100, 3, v1
  s_mul_i32 s57, s56, 192
  v_add_u32 v101, s57, v1
  v_add_u32 v101, 0, v101
  v_mul_u32_u24 v102, 2731, v101
  v_lshrrev_b32 v102, 16, v102
  v_mul_u32_u24 v103, 24, v102
  v_sub_u32 v103, v101, v103
  v_mul_u32_u24 v106, 12288, v102
  v_lshl_add_u32 v106, v103, 4, v106
  v_add_u32 v101, s57, v1
  v_add_u32 v101, 64, v101
  v_mul_u32_u24 v102, 2731, v101
  v_lshrrev_b32 v102, 16, v102
  v_mul_u32_u24 v103, 24, v102
  v_sub_u32 v103, v101, v103
  v_mul_u32_u24 v107, 12288, v102
  v_lshl_add_u32 v107, v103, 4, v107
  v_add_u32 v101, s57, v1
  v_add_u32 v101, 128, v101
  v_mul_u32_u24 v102, 2731, v101
  v_lshrrev_b32 v102, 16, v102
  v_mul_u32_u24 v103, 24, v102
  v_sub_u32 v103, v101, v103
  v_mul_u32_u24 v108, 12288, v102
  v_lshl_add_u32 v108, v103, 4, v108
  v_lshl_add_u32 v104, v98, 3, v99
  v_mul_u32_u24 v104, 384, v104
  v_lshl_add_u32 v104, v100, 3, v104
  s_mul_i32 s57, s56, 96
  v_add_u32 v104, s57, v104
  s_mul_i32 s72, s65, 384
  s_mul_i32 s73, s56, 3072
  s_add_u32 m0, s73, 0
  s_nop 0
  buffer_load_dwordx4 v106, s[20:23], s72 offen lds
  s_add_u32 m0, s73, 1024
  s_nop 0
  buffer_load_dwordx4 v107, s[20:23], s72 offen lds
  s_add_u32 m0, s73, 2048
  s_nop 0
  buffer_load_dwordx4 v108, s[20:23], s72 offen lds
  s_add_u32 s72, s72, 393216
  s_add_u32 m0, s73, 12288
  s_nop 0
  buffer_load_dwordx4 v106, s[20:23], s72 offen lds
  s_add_u32 m0, s73, 13312
  s_nop 0
  buffer_load_dwordx4 v107, s[20:23], s72 offen lds
  s_add_u32 m0, s73, 14336
  s_nop 0
  buffer_load_dwordx4 v108, s[20:23], s72 offen lds
  s_add_u32 s72, s72, 393216
  s_add_u32 m0, s73, 24576
  s_nop 0
  buffer_load_dwordx4 v106, s[20:23], s72 offen lds
  s_add_u32 m0, s73, 25600
  s_nop 0
  buffer_load_dwordx4 v107, s[20:23], s72 offen lds
  s_add_u32 m0, s73, 26624
  s_nop 0
  buffer_load_dwordx4 v108, s[20:23], s72 offen lds
  s_add_u32 s72, s72, 393216
  s_add_u32 m0, s73, 36864
  s_nop 0
  buffer_load_dwordx4 v106, s[20:23], s72 offen lds
  s_add_u32 m0, s73, 37888
  s_nop 0
  buffer_load_dwordx4 v107, s[20:23], s72 offen lds
  s_add_u32 m0, s73, 38912
  s_nop 0
  buffer_load_dwordx4 v108, s[20:23], s72 offen lds
  s_add_u32 s72, s72, 393216
  s_add_u32 m0, s73, 49152
  s_nop 0
  buffer_load_dwordx4 v106, s[20:23], s72 offen lds
  s_add_u32 m0, s73, 50176
  s_nop 0
  buffer_load_dwordx4 v107, s[20:23], s72 offen lds
  s_add_u32 m0, s73, 51200
  s_nop 0
  buffer_load_dwordx4 v108, s[20:23], s72 offen lds
  s_add_u32 s72, s72, 393216
  s_add_u32 m0, s73, 61440
  s_nop 0
  buffer_load_dwordx4 v106, s[20:23], s72 offen lds
  s_add_u32 m0, s73, 62464
  s_nop 0
  buffer_load_dwordx4 v107, s[20:23], s72 offen lds
  s_add_u32 m0, s73, 63488
  s_nop 0
  buffer_load_dwordx4 v108, s[20:23], s72 offen lds
  s_add_u32 s72, s72, 393216
  s_add_u32 m0, s73, 73728
  s_nop 0
  buffer_load_dwordx4 v106, s[20:23], s72 offen lds
  s_add_u32 m0, s73, 74752
  s_nop 0
  buffer_load_dwordx4 v107, s[20:23], s72 offen lds
  s_add_u32 m0, s73, 75776
  s_nop 0
  buffer_load_dwordx4 v108, s[20:23], s72 offen lds
  s_add_u32 s72, s72, 393216
  s_add_u32 m0, s73, 86016
  s_nop 0
  buffer_load_dwordx4 v106, s[20:23], s72 offen lds
  s_add_u32 m0, s73, 87040
  s_nop 0
  buffer_load_dwordx4 v107, s[20:23], s72 offen lds
  s_add_u32 m0, s73, 88064
  s_nop 0
  buffer_load_dwordx4 v108, s[20:23], s72 offen lds
  s_add_u32 s72, s72, 393216
  s_add_u32 m0, s73, 98304
  s_nop 0
  buffer_load_dwordx4 v106, s[20:23], s72 offen lds
  s_add_u32 m0, s73, 99328
  s_nop 0
  buffer_load_dwordx4 v107, s[20:23], s72 offen lds
  s_add_u32 m0, s73, 100352
  s_nop 0
  buffer_load_dwordx4 v108, s[20:23], s72 offen lds
  s_add_u32 s72, s72, 393216
  s_add_u32 m0, s73, 110592
  s_nop 0
  buffer_load_dwordx4 v106, s[20:23], s72 offen lds
  s_add_u32 m0, s73, 111616
  s_nop 0
  buffer_load_dwordx4 v107, s[20:23], s72 offen lds
  s_add_u32 m0, s73, 112640
  s_nop 0
  buffer_load_dwordx4 v108, s[20:23], s72 offen lds
  s_add_u32 s72, s72, 393216
  s_add_u32 m0, s73, 122880
  s_nop 0
  buffer_load_dwordx4 v106, s[20:23], s72 offen lds
  s_add_u32 m0, s73, 123904
  s_nop 0
  buffer_load_dwordx4 v107, s[20:23], s72 offen lds
  s_add_u32 m0, s73, 124928
  s_nop 0
  buffer_load_dwordx4 v108, s[20:23], s72 offen lds
  s_add_u32 s72, s72, 393216
  s_waitcnt vmcnt(30)
  s_barrier
  s_add_u32 m0, s73, 135168
  s_nop 0
  buffer_load_dwordx4 v106, s[20:23], s72 offen lds
  s_add_u32 m0, s73, 136192
  s_nop 0
  buffer_load_dwordx4 v107, s[20:23], s72 offen lds
  s_add_u32 m0, s73, 137216
  s_nop 0
  buffer_load_dwordx4 v108, s[20:23], s72 offen lds
  s_add_u32 s72, s72, 393216
  v_add_u32 v105, 0, v104
  ds_read_b64_tr_b16 a[0:1], v105 offset:0
  ds_read_b64_tr_b16 a[2:3], v105 offset:1536
  ds_read_b64_tr_b16 a[4:5], v105 offset:32
  ds_read_b64_tr_b16 a[6:7], v105 offset:1568
  ds_read_b64_tr_b16 v[18:19], v105 offset:64
  ds_read_b64_tr_b16 v[20:21], v105 offset:1600
  s_waitcnt lgkmcnt(0)
  s_waitcnt vmcnt(30)
  s_barrier
  s_add_u32 m0, s73, 0
  s_nop 0
  buffer_load_dwordx4 v106, s[20:23], s72 offen lds
  s_add_u32 m0, s73, 1024
  s_nop 0
  buffer_load_dwordx4 v107, s[20:23], s72 offen lds
  s_add_u32 m0, s73, 2048
  s_nop 0
  buffer_load_dwordx4 v108, s[20:23], s72 offen lds
  s_add_u32 s72, s72, 393216
  v_add_u32 v105, 12288, v104
  ds_read_b64_tr_b16 a[8:9], v105 offset:0
  ds_read_b64_tr_b16 a[10:11], v105 offset:1536
  ds_read_b64_tr_b16 a[12:13], v105 offset:32
  ds_read_b64_tr_b16 a[14:15], v105 offset:1568
  ds_read_b64_tr_b16 v[22:23], v105 offset:64
  ds_read_b64_tr_b16 v[24:25], v105 offset:1600
  s_waitcnt lgkmcnt(0)
  s_waitcnt vmcnt(30)
  s_barrier
  s_add_u32 m0, s73, 12288
  s_nop 0
  buffer_load_dwordx4 v106, s[20:23], s72 offen lds
  s_add_u32 m0, s73, 13312
  s_nop 0
  buffer_load_dwordx4 v107, s[20:23], s72 offen lds
  s_add_u32 m0, s73, 14336
  s_nop 0
  buffer_load_dwordx4 v108, s[20:23], s72 offen lds
  s_add_u32 s72, s72, 393216
  v_add_u32 v105, 24576, v104
  ds_read_b64_tr_b16 a[16:17], v105 offset:0
  ds_read_b64_tr_b16 a[18:19], v105 offset:1536
  ds_read_b64_tr_b16 a[20:21], v105 offset:32
  ds_read_b64_tr_b16 a[22:23], v105 offset:1568
  ds_read_b64_tr_b16 v[26:27], v105 offset:64
  ds_read_b64_tr_b16 v[28:29], v105 offset:1600
  s_waitcnt lgkmcnt(0)
  s_waitcnt vmcnt(30)
  s_barrier
  s_add_u32 m0, s73, 24576
  s_nop 0
  buffer_load_dwordx4 v106, s[20:23], s72 offen lds
  s_add_u32 m0, s73, 25600
  s_nop 0
  buffer_load_dwordx4 v107, s[20:23], s72 offen lds
  s_add_u32 m0, s73, 26624
  s_nop 0
  buffer_load_dwordx4 v108, s[20:23], s72 offen lds
  s_add_u32 s72, s72, 393216
  v_add_u32 v105, 36864, v104
  ds_read_b64_tr_b16 a[24:25], v105 offset:0
  ds_read_b64_tr_b16 a[26:27], v105 offset:1536
  ds_read_b64_tr_b16 a[28:29], v105 offset:32
  ds_read_b64_tr_b16 a[30:31], v105 offset:1568
  ds_read_b64_tr_b16 v[30:31], v105 offset:64
  ds_read_b64_tr_b16 v[32:33], v105 offset:1600
  s_waitcnt lgkmcnt(0)
  s_waitcnt vmcnt(30)
  s_barrier
  s_add_u32 m0, s73, 36864
  s_nop 0
  buffer_load_dwordx4 v106, s[20:23], s72 offen lds
  s_add_u32 m0, s73, 37888
  s_nop 0
  buffer_load_dwordx4 v107, s[20:23], s72 offen lds
  s_add_u32 m0, s73, 38912
  s_nop 0
  buffer_load_dwordx4 v108, s[20:23], s72 offen lds
  s_add_u32 s72, s72, 393216
  v_add_u32 v105, 49152, v104
  ds_read_b64_tr_b16 a[32:33], v105 offset:0
  ds_read_b64_tr_b16 a[34:35], v105 offset:1536
  ds_read_b64_tr_b16 a[36:37], v105 offset:32
  ds_read_b64_tr_b16 a[38:39], v105 offset:1568
  ds_read_b64_tr_b16 v[34:35], v105 offset:64
  ds_read_b64_tr_b16 v[36:37], v105 offset:1600
  s_waitcnt lgkmcnt(0)
  s_waitcnt vmcnt(30)
  s_barrier
  s_add_u32 m0, s73, 49152
  s_nop 0
  buffer_load_dwordx4 v106, s[20:23], s72 offen lds
  s_add_u32 m0, s73, 50176
  s_nop 0
  buffer_load_dwordx4 v107, s[20:23], s72 offen lds
  s_add_u32 m0, s73, 51200
  s_nop 0
  buffer_load_dwordx4 v108, s[20:23], s72 offen lds
  s_add_u32 s72, s72, 393216
  v_add_u32 v105, 61440, v104
  ds_read_b64_tr_b16 a[40:41], v105 offset:0
  ds_read_b64_tr_b16 a[42:43], v105 offset:1536
  ds_read_b64_tr_b16 a[44:45], v105 offset:32
  ds_read_b64_tr_b16 a[46:47], v105 offset:1568
  ds_read_b64_tr_b16 v[38:39], v105 offset:64
  ds_read_b64_tr_b16 v[40:41], v105 offset:1600
  s_waitcnt lgkmcnt(0)
  s_waitcnt vmcnt(30)
  s_barrier
  s_add_u32 m0, s73, 61440
  s_nop 0
  buffer_load_dwordx4 v106, s[20:23], s72 offen lds
  s_add_u32 m0, s73, 62464
  s_nop 0
  buffer_load_dwordx4 v107, s[20:23], s72 offen lds
  s_add_u32 m0, s73, 63488
  s_nop 0
  buffer_load_dwordx4 v108, s[20:23], s72 offen lds
  s_add_u32 s72, s72, 393216
  v_add_u32 v105, 73728, v104
  ds_read_b64_tr_b16 a[48:49], v105 offset:0
  ds_read_b64_tr_b16 a[50:51], v105 offset:1536
  ds_read_b64_tr_b16 a[52:53], v105 offset:32
  ds_read_b64_tr_b16 a[54:55], v105 offset:1568
  ds_read_b64_tr_b16 v[42:43], v105 offset:64
  ds_read_b64_tr_b16 v[44:45], v105 offset:1600
  s_waitcnt lgkmcnt(0)
  s_waitcnt vmcnt(30)
  s_barrier
  s_add_u32 m0, s73, 73728
  s_nop 0
  buffer_load_dwordx4 v106, s[20:23], s72 offen lds
  s_add_u32 m0, s73, 74752
  s_nop 0
  buffer_load_dwordx4 v107, s[20:23], s72 offen lds
  s_add_u32 m0, s73, 75776
  s_nop 0
  buffer_load_dwordx4 v108, s[20:23], s72 offen lds
  s_add_u32 s72, s72, 393216
  v_add_u32 v105, 86016, v104
  ds_read_b64_tr_b16 a[56:57], v105 offset:0
  ds_read_b64_tr_b16 a[58:59], v105 offset:1536
  ds_read_b64_tr_b16 a[60:61], v105 offset:32
  ds_read_b64_tr_b16 a[62:63], v105 offset:1568
  ds_read_b64_tr_b16 v[46:47], v105 offset:64
  ds_read_b64_tr_b16 v[48:49], v105 offset:1600
  s_waitcnt lgkmcnt(0)
  s_waitcnt vmcnt(30)
  s_barrier
  s_add_u32 m0, s73, 86016
  s_nop 0
  buffer_load_dwordx4 v106, s[20:23], s72 offen lds
  s_add_u32 m0, s73, 87040
  s_nop 0
  buffer_load_dwordx4 v107, s[20:23], s72 offen lds
  s_add_u32 m0, s73, 88064
  s_nop 0
  buffer_load_dwordx4 v108, s[20:23], s72 offen lds
  s_add_u32 s72, s72, 393216
  v_add_u32 v105, 98304, v104
  ds_read_b64_tr_b16 a[64:65], v105 offset:0
  ds_read_b64_tr_b16 a[66:67], v105 offset:1536
  ds_read_b64_tr_b16 a[68:69], v105 offset:32
  ds_read_b64_tr_b16 a[70:71], v105 offset:1568
  ds_read_b64_tr_b16 v[50:51], v105 offset:64
  ds_read_b64_tr_b16 v[52:53], v105 offset:1600
  s_waitcnt lgkmcnt(0)
  s_waitcnt vmcnt(30)
  s_barrier
  v_add_u32 v105, 110592, v104
  ds_read_b64_tr_b16 a[72:73], v105 offset:0
  ds_read_b64_tr_b16 a[74:75], v105 offset:1536
  ds_read_b64_tr_b16 a[76:77], v105 offset:32
  ds_read_b64_tr_b16 a[78:79], v105 offset:1568
  ds_read_b64_tr_b16 v[54:55], v105 offset:64
  ds_read_b64_tr_b16 v[56:57], v105 offset:1600
  s_waitcnt lgkmcnt(0)
  s_waitcnt vmcnt(27)
  s_barrier
  v_add_u32 v105, 122880, v104
  ds_read_b64_tr_b16 a[80:81], v105 offset:0
  ds_read_b64_tr_b16 a[82:83], v105 offset:1536
  ds_read_b64_tr_b16 a[84:85], v105 offset:32
  ds_read_b64_tr_b16 a[86:87], v105 offset:1568
  ds_read_b64_tr_b16 v[58:59], v105 offset:64
  ds_read_b64_tr_b16 v[60:61], v105 offset:1600
  s_waitcnt lgkmcnt(0)
  s_waitcnt vmcnt(24)
  s_barrier
  v_add_u32 v105, 135168, v104
  ds_read_b64_tr_b16 a[88:89], v105 offset:0
  ds_read_b64_tr_b16 a[90:91], v105 offset:1536
  ds_read_b64_tr_b16 a[92:93], v105 offset:32
  ds_read_b64_tr_b16 a[94:95], v105 offset:1568
  ds_read_b64_tr_b16 v[62:63], v105 offset:64
  ds_read_b64_tr_b16 v[64:65], v105 offset:1600
  s_waitcnt lgkmcnt(0)
  s_waitcnt vmcnt(21)
  s_barrier
  v_add_u32 v105, 0, v104
  ds_read_b64_tr_b16 a[96:97], v105 offset:0
  ds_read_b64_tr_b16 a[98:99], v105 offset:1536
  ds_read_b64_tr_b16 a[100:101], v105 offset:32
  ds_read_b64_tr_b16 a[102:103], v105 offset:1568
  ds_read_b64_tr_b16 v[66:67], v105 offset:64
  ds_read_b64_tr_b16 v[68:69], v105 offset:1600
  s_waitcnt lgkmcnt(0)
  s_waitcnt vmcnt(18)
  s_barrier
  v_add_u32 v105, 12288, v104
  ds_read_b64_tr_b16 a[104:105], v105 offset:0
  ds_read_b64_tr_b16 a[106:107], v105 offset:1536
  ds_read_b64_tr_b16 a[108:109], v105 offset:32
  ds_read_b64_tr_b16 a[110:111], v105 offset:1568
  ds_read_b64_tr_b16 v[70:71], v105 offset:64
  ds_read_b64_tr_b16 v[72:73], v105 offset:1600
  s_waitcnt lgkmcnt(0)
  s_waitcnt vmcnt(15)
  s_barrier
  v_add_u32 v105, 24576, v104
  ds_read_b64_tr_b16 a[112:113], v105 offset:0
  ds_read_b64_tr_b16 a[114:115], v105 offset:1536
  ds_read_b64_tr_b16 a[116:117], v105 offset:32
  ds_read_b64_tr_b16 a[118:119], v105 offset:1568
  ds_read_b64_tr_b16 v[74:75], v105 offset:64
  ds_read_b64_tr_b16 v[76:77], v105 offset:1600
  s_waitcnt lgkmcnt(0)
  s_waitcnt vmcnt(12)
  s_barrier
  v_add_u32 v105, 36864, v104
  ds_read_b64_tr_b16 a[120:121], v105 offset:0
  ds_read_b64_tr_b16 a[122:123], v105 offset:1536
  ds_read_b64_tr_b16 a[124:125], v105 offset:32
  ds_read_b64_tr_b16 a[126:127], v105 offset:1568
  ds_read_b64_tr_b16 v[78:79], v105 offset:64
  ds_read_b64_tr_b16 v[80:81], v105 offset:1600
  s_waitcnt lgkmcnt(0)
  s_waitcnt vmcnt(9)
  s_barrier
  v_add_u32 v105, 49152, v104
  ds_read_b64_tr_b16 a[128:129], v105 offset:0
  ds_read_b64_tr_b16 a[130:131], v105 offset:1536
  ds_read_b64_tr_b16 a[132:133], v105 offset:32
  ds_read_b64_tr_b16 a[134:135], v105 offset:1568
  ds_read_b64_tr_b16 v[82:83], v105 offset:64
  ds_read_b64_tr_b16 v[84:85], v105 offset:1600
  s_waitcnt lgkmcnt(0)
  s_waitcnt vmcnt(6)
  s_barrier
  v_add_u32 v105, 61440, v104
  ds_read_b64_tr_b16 a[136:137], v105 offset:0
  ds_read_b64_tr_b16 a[138:139], v105 offset:1536
  ds_read_b64_tr_b16 a[140:141], v105 offset:32
  ds_read_b64_tr_b16 a[142:143], v105 offset:1568
  ds_read_b64_tr_b16 v[86:87], v105 offset:64
  ds_read_b64_tr_b16 v[88:89], v105 offset:1600
  s_waitcnt lgkmcnt(0)
  s_waitcnt vmcnt(3)
  s_barrier
  v_add_u32 v105, 73728, v104
  ds_read_b64_tr_b16 a[144:145], v105 offset:0
  ds_read_b64_tr_b16 a[146:147], v105 offset:1536
  ds_read_b64_tr_b16 a[148:149], v105 offset:32
  ds_read_b64_tr_b16 a[150:151], v105 offset:1568
  ds_read_b64_tr_b16 v[90:91], v105 offset:64
  ds_read_b64_tr_b16 v[92:93], v105 offset:1600
  s_waitcnt lgkmcnt(0)
  s_waitcnt vmcnt(0)
  s_barrier
  v_add_u32 v105, 86016, v104
  ds_read_b64_tr_b16 a[152:153], v105 offset:0
  ds_read_b64_tr_b16 a[154:155], v105 offset:1536
  ds_read_b64_tr_b16 a[156:157], v105 offset:32
  ds_read_b64_tr_b16 a[158:159], v105 offset:1568
  ds_read_b64_tr_b16 v[94:95], v105 offset:64
  ds_read_b64_tr_b16 v[96:97], v105 offset:1600
  s_waitcnt lgkmcnt(0)
  s_barrier
  s_mul_i32 s57, s56, 10240
  v_lshlrev_b32 v106, 4, v1
  v_add_u32 v106, s57, v106
  s_mul_i32 s72, s65, 245760
  s_mul_i32 s73, s56, 10240
  v_lshl_add_u32 v104, v98, 3, v99
  v_mul_u32_u24 v104, 1280, v104
  v_lshl_add_u32 v104, v100, 3, v104
  s_mul_i32 s57, s56, 320
  v_add_u32 v104, s57, v104
  s_add_u32 m0, s73, 0
  s_add_u32 s57, s72, 0
  buffer_load_dwordx4 v106, s[24:27], s57 offen lds
  s_add_u32 m0, s73, 1024
  s_add_u32 s57, s72, 1024
  buffer_load_dwordx4 v106, s[24:27], s57 offen lds
  s_add_u32 m0, s73, 2048
  s_add_u32 s57, s72, 2048
  buffer_load_dwordx4 v106, s[24:27], s57 offen lds
  s_add_u32 m0, s73, 3072
  s_add_u32 s57, s72, 3072
  buffer_load_dwordx4 v106, s[24:27], s57 offen lds
  s_add_u32 m0, s73, 4096
  s_add_u32 s57, s72, 4096
  buffer_load_dwordx4 v106, s[24:27], s57 offen lds
  s_add_u32 m0, s73, 5120
  s_add_u32 s57, s72, 5120
  buffer_load_dwordx4 v106, s[24:27], s57 offen lds
  s_add_u32 m0, s73, 6144
  s_add_u32 s57, s72, 6144
  buffer_load_dwordx4 v106, s[24:27], s57 offen lds
  s_add_u32 m0, s73, 7168
  s_add_u32 s57, s72, 7168
  buffer_load_dwordx4 v106, s[24:27], s57 offen lds
  s_add_u32 m0, s73, 8192
  s_add_u32 s57, s72, 8192
  buffer_load_dwordx4 v106, s[24:27], s57 offen lds
  s_add_u32 m0, s73, 9216
  s_add_u32 s57, s72, 9216
  buffer_load_dwordx4 v106, s[24:27], s57 offen lds
  s_add_u32 s72, s72, 40960
  s_add_u32 m0, s73, 40960
  s_add_u32 s57, s72, 0
  buffer_load_dwordx4 v106, s[24:27], s57 offen lds
  s_add_u32 m0, s73, 41984
  s_add_u32 s57, s72, 1024
  buffer_load_dwordx4 v106, s[24:27], s57 offen lds
  s_add_u32 m0, s73, 43008
  s_add_u32 s57, s72, 2048
  buffer_load_dwordx4 v106, s[24:27], s57 offen lds
  s_add_u32 m0, s73, 44032
  s_add_u32 s57, s72, 3072
  buffer_load_dwordx4 v106, s[24:27], s57 offen lds
  s_add_u32 m0, s73, 45056
  s_add_u32 s57, s72, 4096
  buffer_load_dwordx4 v106, s[24:27], s57 offen lds
  s_add_u32 m0, s73, 46080
  s_add_u32 s57, s72, 5120
  buffer_load_dwordx4 v106, s[24:27], s57 offen lds
  s_add_u32 m0, s73, 47104
  s_add_u32 s57, s72, 6144
  buffer_load_dwordx4 v106, s[24:27], s57 offen lds
  s_add_u32 m0, s73, 48128
  s_add_u32 s57, s72, 7168
  buffer_load_dwordx4 v106, s[24:27], s57 offen lds
  s_add_u32 m0, s73, 49152
  s_add_u32 s57, s72, 8192
  buffer_load_dwordx4 v106, s[24:27], s57 offen lds
  s_add_u32 m0, s73, 50176
  s_add_u32 s57, s72, 9216
  buffer_load_dwordx4 v106, s[24:27], s57 offen lds
  s_add_u32 s72, s72, 40960
  s_add_u32 m0, s73, 81920
  s_add_u32 s57, s72, 0
  buffer_load_dwordx4 v106, s[24:27], s57 offen lds
  s_add_u32 m0, s73, 82944
  s_add_u32 s57, s72, 1024
  buffer_load_dwordx4 v106, s[24:27], s57 offen lds
  s_add_u32 m0, s73, 83968
  s_add_u32 s57, s72, 2048
  buffer_load_dwordx4 v106, s[24:27], s57 offen lds
  s_add_u32 m0, s73, 84992
  s_add_u32 s57, s72, 3072
  buffer_load_dwordx4 v106, s[24:27], s57 offen lds
  s_add_u32 m0, s73, 86016
  s_add_u32 s57, s72, 4096
  buffer_load_dwordx4 v106, s[24:27], s57 offen lds
  s_add_u32 m0, s73, 87040
  s_add_u32 s57, s72, 5120
  buffer_load_dwordx4 v106, s[24:27], s57 offen lds
  s_add_u32 m0, s73, 88064
  s_add_u32 s57, s72, 6144
  buffer_load_dwordx4 v106, s[24:27], s57 offen lds
  s_add_u32 m0, s73, 89088
  s_add_u32 s57, s72, 7168
  buffer_load_dwordx4 v106, s[24:27], s57 offen lds
  s_add_u32 m0, s73, 90112
  s_add_u32 s57, s72, 8192
  buffer_load_dwordx4 v106, s[24:27], s57 offen lds
  s_add_u32 m0, s73, 91136
  s_add_u32 s57, s72, 9216
  buffer_load_dwordx4 v106, s[24:27], s57 offen lds
  s_add_u32 s72, s72, 40960
  s_waitcnt vmcnt(20)
  s_barrier
  s_add_u32 m0, s73, 122880
  s_add_u32 s57, s72, 0
  buffer_load_dwordx4 v106, s[24:27], s57 offen lds
  s_add_u32 m0, s73, 123904
  s_add_u32 s57, s72, 1024
  buffer_load_dwordx4 v106, s[24:27], s57 offen lds
  s_add_u32 m0, s73, 124928
  s_add_u32 s57, s72, 2048
  buffer_load_dwordx4 v106, s[24:27], s57 offen lds
  s_add_u32 m0, s73, 125952
  s_add_u32 s57, s72, 3072
  buffer_load_dwordx4 v106, s[24:27], s57 offen lds
  s_add_u32 m0, s73, 126976
  s_add_u32 s57, s72, 4096
  buffer_load_dwordx4 v106, s[24:27], s57 offen lds
  s_add_u32 m0, s73, 128000
  s_add_u32 s57, s72, 5120
  buffer_load_dwordx4 v106, s[24:27], s57 offen lds
  s_add_u32 m0, s73, 129024
  s_add_u32 s57, s72, 6144
  buffer_load_dwordx4 v106, s[24:27], s57 offen lds
  s_add_u32 m0, s73, 130048
  s_add_u32 s57, s72, 7168
  buffer_load_dwordx4 v106, s[24:27], s57 offen lds
  s_add_u32 m0, s73, 131072
  s_add_u32 s57, s72, 8192
  buffer_load_dwordx4 v106, s[24:27], s57 offen lds
  s_add_u32 m0, s73, 132096
  s_add_u32 s57, s72, 9216
  buffer_load_dwordx4 v106, s[24:27], s57 offen lds
  s_add_u32 s72, s72, 40960
  v_add_u32 v105, 0, v104
  ds_read_b64_tr_b16 a[160:161], v105 offset:0
  ds_read_b64_tr_b16 a[162:163], v105 offset:5120
  ds_read_b64_tr_b16 a[184:185], v105 offset:32
  ds_read_b64_tr_b16 a[186:187], v105 offset:5152
  ds_read_b64_tr_b16 a[208:209], v105 offset:64
  ds_read_b64_tr_b16 a[210:211], v105 offset:5184
  ds_read_b64_tr_b16 a[232:233], v105 offset:96
  ds_read_b64_tr_b16 a[234:235], v105 offset:5216
  ds_read_b64_tr_b16 v[112:113], v105 offset:128
  ds_read_b64_tr_b16 v[114:115], v105 offset:5248
  ds_read_b64_tr_b16 v[136:137], v105 offset:160
  ds_read_b64_tr_b16 v[138:139], v105 offset:5280
  ds_read_b64_tr_b16 v[160:161], v105 offset:192
  ds_read_b64_tr_b16 v[162:163], v105 offset:5312
  ds_read_b64_tr_b16 v[184:185], v105 offset:224
  ds_read_b64_tr_b16 v[186:187], v105 offset:5344
  ds_read_b64_tr_b16 v[208:209], v105 offset:256
  ds_read_b64_tr_b16 v[210:211], v105 offset:5376
  ds_read_b64_tr_b16 v[232:233], v105 offset:288
  ds_read_b64_tr_b16 v[234:235], v105 offset:5408
  s_waitcnt lgkmcnt(0)
  s_waitcnt vmcnt(20)
  s_barrier
  s_add_u32 m0, s73, 0
  s_add_u32 s57, s72, 0
  buffer_load_dwordx4 v106, s[24:27], s57 offen lds
  s_add_u32 m0, s73, 1024
  s_add_u32 s57, s72, 1024
  buffer_load_dwordx4 v106, s[24:27], s57 offen lds
  s_add_u32 m0, s73, 2048
  s_add_u32 s57, s72, 2048
  buffer_load_dwordx4 v106, s[24:27], s57 offen lds
  s_add_u32 m0, s73, 3072
  s_add_u32 s57, s72, 3072
  buffer_load_dwordx4 v106, s[24:27], s57 offen lds
  s_add_u32 m0, s73, 4096
  s_add_u32 s57, s72, 4096
  buffer_load_dwordx4 v106, s[24:27], s57 offen lds
  s_add_u32 m0, s73, 5120
  s_add_u32 s57, s72, 5120
  buffer_load_dwordx4 v106, s[24:27], s57 offen lds
  s_add_u32 m0, s73, 6144
  s_add_u32 s57, s72, 6144
  buffer_load_dwordx4 v106, s[24:27], s57 offen lds
  s_add_u32 m0, s73, 7168
  s_add_u32 s57, s72, 7168
  buffer_load_dwordx4 v106, s[24:27], s57 offen lds
  s_add_u32 m0, s73, 8192
  s_add_u32 s57, s72, 8192
  buffer_load_dwordx4 v106, s[24:27], s57 offen lds
  s_add_u32 m0, s73, 9216
  s_add_u32 s57, s72, 9216
  buffer_load_dwordx4 v106, s[24:27], s57 offen lds
  s_add_u32 s72, s72, 40960
  v_add_u32 v105, 40960, v104
  ds_read_b64_tr_b16 a[164:165], v105 offset:0
  ds_read_b64_tr_b16 a[166:167], v105 offset:5120
  ds_read_b64_tr_b16 a[188:189], v105 offset:32
  ds_read_b64_tr_b16 a[190:191], v105 offset:5152
  ds_read_b64_tr_b16 a[212:213], v105 offset:64
  ds_read_b64_tr_b16 a[214:215], v105 offset:5184
  ds_read_b64_tr_b16 a[236:237], v105 offset:96
  ds_read_b64_tr_b16 a[238:239], v105 offset:5216
  ds_read_b64_tr_b16 v[116:117], v105 offset:128
  ds_read_b64_tr_b16 v[118:119], v105 offset:5248
  ds_read_b64_tr_b16 v[140:141], v105 offset:160
  ds_read_b64_tr_b16 v[142:143], v105 offset:5280
  ds_read_b64_tr_b16 v[164:165], v105 offset:192
  ds_read_b64_tr_b16 v[166:167], v105 offset:5312
  ds_read_b64_tr_b16 v[188:189], v105 offset:224
  ds_read_b64_tr_b16 v[190:191], v105 offset:5344
  ds_read_b64_tr_b16 v[212:213], v105 offset:256
  ds_read_b64_tr_b16 v[214:215], v105 offset:5376
  ds_read_b64_tr_b16 v[236:237], v105 offset:288
  ds_read_b64_tr_b16 v[238:239], v105 offset:5408
  s_waitcnt lgkmcnt(0)
  s_waitcnt vmcnt(20)
  s_barrier
  s_add_u32 m0, s73, 40960
  s_add_u32 s57, s72, 0
  buffer_load_dwordx4 v106, s[24:27], s57 offen lds
  s_add_u32 m0, s73, 41984
  s_add_u32 s57, s72, 1024
  buffer_load_dwordx4 v106, s[24:27], s57 offen lds
  s_add_u32 m0, s73, 43008
  s_add_u32 s57, s72, 2048
  buffer_load_dwordx4 v106, s[24:27], s57 offen lds
  s_add_u32 m0, s73, 44032
  s_add_u32 s57, s72, 3072
  buffer_load_dwordx4 v106, s[24:27], s57 offen lds
  s_add_u32 m0, s73, 45056
  s_add_u32 s57, s72, 4096
  buffer_load_dwordx4 v106, s[24:27], s57 offen lds
  s_add_u32 m0, s73, 46080
  s_add_u32 s57, s72, 5120
  buffer_load_dwordx4 v106, s[24:27], s57 offen lds
  s_add_u32 m0, s73, 47104
  s_add_u32 s57, s72, 6144
  buffer_load_dwordx4 v106, s[24:27], s57 offen lds
  s_add_u32 m0, s73, 48128
  s_add_u32 s57, s72, 7168
  buffer_load_dwordx4 v106, s[24:27], s57 offen lds
  s_add_u32 m0, s73, 49152
  s_add_u32 s57, s72, 8192
  buffer_load_dwordx4 v106, s[24:27], s57 offen lds
  s_add_u32 m0, s73, 50176
  s_add_u32 s57, s72, 9216
  buffer_load_dwordx4 v106, s[24:27], s57 offen lds
  s_add_u32 s72, s72, 40960
  v_add_u32 v105, 81920, v104
  ds_read_b64_tr_b16 a[168:169], v105 offset:0
  ds_read_b64_tr_b16 a[170:171], v105 offset:5120
  ds_read_b64_tr_b16 a[192:193], v105 offset:32
  ds_read_b64_tr_b16 a[194:195], v105 offset:5152
  ds_read_b64_tr_b16 a[216:217], v105 offset:64
  ds_read_b64_tr_b16 a[218:219], v105 offset:5184
  ds_read_b64_tr_b16 a[240:241], v105 offset:96
  ds_read_b64_tr_b16 a[242:243], v105 offset:5216
  ds_read_b64_tr_b16 v[120:121], v105 offset:128
  ds_read_b64_tr_b16 v[122:123], v105 offset:5248
  ds_read_b64_tr_b16 v[144:145], v105 offset:160
  ds_read_b64_tr_b16 v[146:147], v105 offset:5280
  ds_read_b64_tr_b16 v[168:169], v105 offset:192
  ds_read_b64_tr_b16 v[170:171], v105 offset:5312
  ds_read_b64_tr_b16 v[192:193], v105 offset:224
  ds_read_b64_tr_b16 v[194:195], v105 offset:5344
  ds_read_b64_tr_b16 v[216:217], v105 offset:256
  ds_read_b64_tr_b16 v[218:219], v105 offset:5376
  ds_read_b64_tr_b16 v[240:241], v105 offset:288
  ds_read_b64_tr_b16 v[242:243], v105 offset:5408
  s_waitcnt lgkmcnt(0)
  s_waitcnt vmcnt(20)
  s_barrier
  v_add_u32 v105, 122880, v104
  ds_read_b64_tr_b16 a[172:173], v105 offset:0
  ds_read_b64_tr_b16 a[174:175], v105 offset:5120
  ds_read_b64_tr_b16 a[196:197], v105 offset:32
  ds_read_b64_tr_b16 a[198:199], v105 offset:5152
  ds_read_b64_tr_b16 a[220:221], v105 offset:64
  ds_read_b64_tr_b16 a[222:223], v105 offset:5184
  ds_read_b64_tr_b16 a[244:245], v105 offset:96
  ds_read_b64_tr_b16 a[246:247], v105 offset:5216
  ds_read_b64_tr_b16 v[124:125], v105 offset:128
  ds_read_b64_tr_b16 v[126:127], v105 offset:5248
  ds_read_b64_tr_b16 v[148:149], v105 offset:160
  ds_read_b64_tr_b16 v[150:151], v105 offset:5280
  ds_read_b64_tr_b16 v[172:173], v105 offset:192
  ds_read_b64_tr_b16 v[174:175], v105 offset:5312
  ds_read_b64_tr_b16 v[196:197], v105 offset:224
  ds_read_b64_tr_b16 v[198:199], v105 offset:5344
  ds_read_b64_tr_b16 v[220:221], v105 offset:256
  ds_read_b64_tr_b16 v[222:223], v105 offset:5376
  ds_read_b64_tr_b16 v[244:245], v105 offset:288
  ds_read_b64_tr_b16 v[246:247], v105 offset:5408
  s_waitcnt lgkmcnt(0)
  s_waitcnt vmcnt(10)
  s_barrier
  v_add_u32 v105, 0, v104
  ds_read_b64_tr_b16 a[176:177], v105 offset:0
  ds_read_b64_tr_b16 a[178:179], v105 offset:5120
  ds_read_b64_tr_b16 a[200:201], v105 offset:32
  ds_read_b64_tr_b16 a[202:203], v105 offset:5152
  ds_read_b64_tr_b16 a[224:225], v105 offset:64
  ds_read_b64_tr_b16 a[226:227], v105 offset:5184
  ds_read_b64_tr_b16 a[248:249], v105 offset:96
  ds_read_b64_tr_b16 a[250:251], v105 offset:5216
  ds_read_b64_tr_b16 v[128:129], v105 offset:128
  ds_read_b64_tr_b16 v[130:131], v105 offset:5248
  ds_read_b64_tr_b16 v[152:153], v105 offset:160
  ds_read_b64_tr_b16 v[154:155], v105 offset:5280
  ds_read_b64_tr_b16 v[176:177], v105 offset:192
  ds_read_b64_tr_b16 v[178:179], v105 offset:5312
  ds_read_b64_tr_b16 v[200:201], v105 offset:224
  ds_read_b64_tr_b16 v[202:203], v105 offset:5344
  ds_read_b64_tr_b16 v[224:225], v105 offset:256
  ds_read_b64_tr_b16 v[226:227], v105 offset:5376
  ds_read_b64_tr_b16 v[248:249], v105 offset:288
  ds_read_b64_tr_b16 v[250:251], v105 offset:5408
  s_waitcnt lgkmcnt(0)
  s_waitcnt vmcnt(0)
  s_barrier
  v_add_u32 v105, 40960, v104
  ds_read_b64_tr_b16 a[180:181], v105 offset:0
  ds_read_b64_tr_b16 a[182:183], v105 offset:5120
  ds_read_b64_tr_b16 a[204:205], v105 offset:32
  ds_read_b64_tr_b16 a[206:207], v105 offset:5152
  ds_read_b64_tr_b16 a[228:229], v105 offset:64
  ds_read_b64_tr_b16 a[230:231], v105 offset:5184
  ds_read_b64_tr_b16 a[252:253], v105 offset:96
  ds_read_b64_tr_b16 a[254:255], v105 offset:5216
  ds_read_b64_tr_b16 v[132:133], v105 offset:128
  ds_read_b64_tr_b16 v[134:135], v105 offset:5248
  ds_read_b64_tr_b16 v[156:157], v105 offset:160
  ds_read_b64_tr_b16 v[158:159], v105 offset:5280
  ds_read_b64_tr_b16 v[180:181], v105 offset:192
  ds_read_b64_tr_b16 v[182:183], v105 offset:5312
  ds_read_b64_tr_b16 v[204:205], v105 offset:224
  ds_read_b64_tr_b16 v[206:207], v105 offset:5344
  ds_read_b64_tr_b16 v[228:229], v105 offset:256
  ds_read_b64_tr_b16 v[230:231], v105 offset:5376
  ds_read_b64_tr_b16 v[252:253], v105 offset:288
  ds_read_b64_tr_b16 v[254:255], v105 offset:5408
  s_waitcnt lgkmcnt(0)
  s_barrier
  ds_write_b128 v5, v[18:21] offset:0
  ds_write_b128 v5, v[22:25] offset:1024
  ds_write_b128 v5, v[26:29] offset:2048
  ds_write_b128 v5, v[30:33] offset:3072
  ds_write_b128 v5, v[34:37] offset:4096
  ds_write_b128 v5, v[38:41] offset:5120
  ds_write_b128 v5, v[42:45] offset:6144
  ds_write_b128 v5, v[46:49] offset:7168
  ds_write_b128 v5, v[50:53] offset:8192
  ds_write_b128 v5, v[54:57] offset:9216
  ds_write_b128 v5, v[58:61] offset:10240
  ds_write_b128 v5, v[62:65] offset:11264
  ds_write_b128 v5, v[66:69] offset:12288
  ds_write_b128 v5, v[70:73] offset:13312
  ds_write_b128 v5, v[74:77] offset:14336
  ds_write_b128 v5, v[78:81] offset:15360
  ds_write_b128 v5, v[82:85] offset:16384
  ds_write_b128 v5, v[86:89] offset:17408
  ds_write_b128 v5, v[90:93] offset:18432
  ds_write_b128 v5, v[94:97] offset:19456
  s_waitcnt lgkmcnt(0)
  v_lshrrev_b32 v98, 4, v1
  v_and_b32 v100, 15, v1
  v_mul_u32_u24 v12, 400, v100
  v_lshl_add_u32 v12, v98, 3, v12
  s_mul_i32 s57, s56, 96
  s_add_u32 s57, s57, 10240
  v_add_u32 v12, s57, v12
  v_mul_u32_u24 v13, 400, v100
  v_lshl_add_u32 v13, v98, 4, v13
  v_add_u32 v13, 10240, v13
  s_mul_i32 s57, s56, 20
  v_lshrrev_b32 v101, 3, v1
  v_add_u32 v101, s57, v101
  v_lshlrev_b32 v10, 12, v101
  v_and_b32 v101, 7, v1
  v_lshl_add_u32 v10, v101, 4, v10
  v_mov_b32 v11, 0
  v_mov_b32 v14, 0
  s_mov_b32 s82, -1
  s_mov_b32 s83, 0
  s_lshl_b32 s87, s65, 7
  s_add_u32 s87, s87, 2568192
  s_mov_b32 s64, 0
  s_mov_b32 s70, 7
  s_mov_b32 s71, 6
  s_mov_b32 s3, 0
  s_mov_b32 s77, 0
  s_mov_b32 s72, 0
  s_cmp_lg_u32 s56, 0
  s_cbranch_scc1 mai_spindkz0v_22
  s_mov_b32 s58, 0
mai_spinkz0v_21:
  buffer_load_dword v18, off, s[48:51], s72 sc1
  s_waitcnt vmcnt(0)
  v_readfirstlane_b32 s57, v18
  s_cmp_ge_u32 s57, 320
  s_cbranch_scc1 mai_spindkz0v_22
  s_sleep 10
  s_add_u32 s58, s58, 1
  s_cmp_lt_u32 s58, 4194304
  s_cbranch_scc1 mai_spinkz0v_21
mai_spindkz0v_22:
  s_barrier
mai_r_loopv:
  s_mov_b32 s57, s70
mai_dl_25:
  s_cmp_eq_u32 s57, 0
  s_cbranch_scc1 mai_dld_26
  s_sleep 1
  s_sub_u32 s57, s57, 1
  s_branch mai_dl_25
mai_dld_26:
  buffer_load_dwordx4 v[20:23], v2, s[48:51], s84 offen sc1
  buffer_load_dwordx4 v[24:27], v2, s[48:51], s85 offen sc1
  buffer_load_dwordx4 v[28:31], v3, s[48:51], s84 offen sc1
  s_mov_b32 s78, 0
  s_waitcnt vmcnt(0)
  v_max3_u32 v18, v20, v21, v22
  v_max3_u32 v18, v18, v23, v24
  v_max3_u32 v18, v18, v25, v26
  v_max3_u32 v18, v18, v27, v28
  v_max3_u32 v18, v18, v29, v30
  v_max_u32 v18, v18, v31
  v_cmp_eq_u32 vcc, -1, v18
  s_cbranch_vccz mai_gmd_24
mai_gm_23:
  buffer_load_dwordx4 v[20:23], v2, s[48:51], s84 offen sc1
  buffer_load_dwordx4 v[24:27], v2, s[48:51], s85 offen sc1
  buffer_load_dwordx4 v[28:31], v3, s[48:51], s84 offen sc1
  s_add_u32 s78, s78, 1
  s_waitcnt vmcnt(0)
  v_max3_u32 v18, v20, v21, v22
  v_max3_u32 v18, v18, v23, v24
  v_max3_u32 v18, v18, v25, v26
  v_max3_u32 v18, v18, v27, v28
  v_max3_u32 v18, v18, v29, v30
  v_max_u32 v18, v18, v31
  v_cmp_eq_u32 vcc, -1, v18
  s_cbranch_vccz mai_gmd_24
  s_cmp_lt_u32 s78, 1048576
  s_cbranch_scc1 mai_gm_23
mai_gmd_24:
  ds_write_b128 v2, v[20:23] offset:0
  ds_write_b128 v2, v[24:27] offset:4096
  ds_write_b128 v3, v[28:31] offset:0
  s_cmp_eq_u32 s78, 0
  s_cbranch_scc1 mai_ad_27
  s_add_u32 s70, s70, 2
  s_min_u32 s70, s70, 30
  s_mov_b32 s3, 0
  s_branch mai_ad_28
mai_ad_27:
  s_add_u32 s3, s3, 1
  s_cmp_lt_u32 s3, 4
  s_cbranch_scc1 mai_ad_28
  s_mov_b32 s3, 0
  s_max_u32 s70, s70, 1
  s_sub_u32 s70, s70, 1
mai_ad_28:
  s_waitcnt lgkmcnt(0)
  s_barrier
  ds_read_b128 v[20:23], v4 offset:0
  ds_read_b128 v[32:35], v5 offset:0
  ds_read_b128 v[24:27], v4 offset:512
  ds_read_b128 v[36:39], v5 offset:1024
  s_lshl_b32 s75, s56, 13
  s_add_u32 s75, s75, 32768
  s_add_u32 s72, s96, 16384
  s_cmp_lt_u32 s101, 2
  s_cselect_b32 s76, s96, s72
  s_add_u32 s72, s96, 0
  s_add_u32 m0, s75, 0
  s_nop 0
  buffer_load_dwordx4 v9, s[48:51], s72 offen sc1 lds
  s_add_u32 s72, s96, 1024
  s_add_u32 m0, s75, 1024
  s_nop 0
  buffer_load_dwordx4 v9, s[48:51], s72 offen sc1 lds
  s_waitcnt lgkmcnt(2)
  v_mfma_f32_16x16x32_bf16 v[44:47], a[0:3], v[20:23], 0
  ds_read_b128 v[28:31], v4 offset:1024
  ds_read_b128 v[40:43], v5 offset:2048
  v_mfma_f32_16x16x32_bf16 v[48:51], a[4:7], v[20:23], 0
  s_add_u32 s72, s96, 2048
  s_add_u32 m0, s75, 2048
  s_nop 0
  buffer_load_dwordx4 v9, s[48:51], s72 offen sc1 lds
  v_mfma_f32_16x16x32_bf16 v[52:55], v[32:35], v[20:23], 0
  s_waitcnt lgkmcnt(2)
  v_mfma_f32_16x16x32_bf16 v[44:47], a[8:11], v[24:27], v[44:47]
  ds_read_b128 v[20:23], v4 offset:1536
  ds_read_b128 v[32:35], v5 offset:3072
  v_mfma_f32_16x16x32_bf16 v[48:51], a[12:15], v[24:27], v[48:51]
  s_add_u32 s72, s96, 3072
  s_add_u32 m0, s75, 3072
  s_nop 0
  buffer_load_dwordx4 v9, s[48:51], s72 offen sc1 lds
  v_mfma_f32_16x16x32_bf16 v[52:55], v[36:39], v[24:27], v[52:55]
  s_waitcnt lgkmcnt(2)
  v_mfma_f32_16x16x32_bf16 v[44:47], a[16:19], v[28:31], v[44:47]
  ds_read_b128 v[24:27], v4 offset:2048
  ds_read_b128 v[36:39], v5 offset:4096
  v_mfma_f32_16x16x32_bf16 v[48:51], a[20:23], v[28:31], v[48:51]
  s_add_u32 s72, s76, 0
  s_add_u32 m0, s75, 4096
  s_nop 0
  buffer_load_dwordx4 v9, s[48:51], s72 offen sc1 lds
  v_mfma_f32_16x16x32_bf16 v[52:55], v[40:43], v[28:31], v[52:55]
  s_waitcnt lgkmcnt(2)
  v_mfma_f32_16x16x32_bf16 v[44:47], a[24:27], v[20:23], v[44:47]
  ds_read_b128 v[28:31], v4 offset:2560
  ds_read_b128 v[40:43], v5 offset:5120
  v_mfma_f32_16x16x32_bf16 v[48:51], a[28:31], v[20:23], v[48:51]
  s_add_u32 s72, s76, 1024
  s_add_u32 m0, s75, 5120
  s_nop 0
  buffer_load_dwordx4 v9, s[48:51], s72 offen sc1 lds
  v_mfma_f32_16x16x32_bf16 v[52:55], v[32:35], v[20:23], v[52:55]
  s_waitcnt lgkmcnt(2)
  v_mfma_f32_16x16x32_bf16 v[44:47], a[32:35], v[24:27], v[44:47]
  ds_read_b128 v[20:23], v4 offset:3072
  ds_read_b128 v[32:35], v5 offset:6144
  v_mfma_f32_16x16x32_bf16 v[48:51], a[36:39], v[24:27], v[48:51]
  s_add_u32 s72, s76, 2048
  s_add_u32 m0, s75, 6144
  s_nop 0
  buffer_load_dwordx4 v9, s[48:51], s72 offen sc1 lds
  v_mfma_f32_16x16x32_bf16 v[52:55], v[36:39], v[24:27], v[52:55]
  s_waitcnt lgkmcnt(2)
  v_mfma_f32_16x16x32_bf16 v[44:47], a[40:43], v[28:31], v[44:47]
  ds_read_b128 v[24:27], v4 offset:3584
  ds_read_b128 v[36:39], v5 offset:7168
  v_mfma_f32_16x16x32_bf16 v[48:51], a[44:47], v[28:31], v[48:51]
  s_add_u32 s72, s76, 3072
  s_add_u32 m0, s75, 7168
  s_nop 0
  buffer_load_dwordx4 v9, s[48:51], s72 offen sc1 lds
  v_mfma_f32_16x16x32_bf16 v[52:55], v[40:43], v[28:31], v[52:55]
  s_waitcnt lgkmcnt(2)
  v_mfma_f32_16x16x32_bf16 v[44:47], a[48:51], v[20:23], v[44:47]
  ds_read_b128 v[28:31], v4 offset:4096
  ds_read_b128 v[40:43], v5 offset:8192
  v_mfma_f32_16x16x32_bf16 v[48:51], a[52:55], v[20:23], v[48:51]
  s_cmp_lg_u32 s56, 0
  s_cbranch_scc1 mai_rs_29
  s_cmp_eq_u32 s64, 0
  s_cbranch_scc1 mai_rs_29
  v_mov_b32 v19, 1
  s_sub_u32 s57, s98, 8192
  s_mov_b64 exec, 1
  buffer_store_dword v19, off, s[48:51], s57 sc1
  s_mov_b64 exec, -1
mai_rs_29:
  v_mfma_f32_16x16x32_bf16 v[52:55], v[32:35], v[20:23], v[52:55]
  s_waitcnt lgkmcnt(2)
  v_mfma_f32_16x16x32_bf16 v[44:47], a[56:59], v[24:27], v[44:47]
  ds_read_b128 v[20:23], v4 offset:4608
  ds_read_b128 v[32:35], v5 offset:9216
  v_mfma_f32_16x16x32_bf16 v[48:51], a[60:63], v[24:27], v[48:51]
  v_mfma_f32_16x16x32_bf16 v[52:55], v[36:39], v[24:27], v[52:55]
  s_waitcnt lgkmcnt(2)
  v_mfma_f32_16x16x32_bf16 v[44:47], a[64:67], v[28:31], v[44:47]
  ds_read_b128 v[24:27], v4 offset:5120
  ds_read_b128 v[36:39], v5 offset:10240
  v_mfma_f32_16x16x32_bf16 v[48:51], a[68:71], v[28:31], v[48:51]
  v_mfma_f32_16x16x32_bf16 v[52:55], v[40:43], v[28:31], v[52:55]
  s_waitcnt lgkmcnt(2)
  v_mfma_f32_16x16x32_bf16 v[44:47], a[72:75], v[20:23], v[44:47]
  ds_read_b128 v[28:31], v4 offset:5632
  ds_read_b128 v[40:43], v5 offset:11264
  v_mfma_f32_16x16x32_bf16 v[48:51], a[76:79], v[20:23], v[48:51]
  v_mfma_f32_16x16x32_bf16 v[52:55], v[32:35], v[20:23], v[52:55]
  s_waitcnt lgkmcnt(2)
  v_mfma_f32_16x16x32_bf16 v[44:47], a[80:83], v[24:27], v[44:47]
  ds_read_b128 v[20:23], v4 offset:6144
  ds_read_b128 v[32:35], v5 offset:12288
  v_mfma_f32_16x16x32_bf16 v[48:51], a[84:87], v[24:27], v[48:51]
  v_mfma_f32_16x16x32_bf16 v[52:55], v[36:39], v[24:27], v[52:55]
  s_waitcnt lgkmcnt(2)
  v_mfma_f32_16x16x32_bf16 v[44:47], a[88:91], v[28:31], v[44:47]
  ds_read_b128 v[24:27], v4 offset:6656
  ds_read_b128 v[36:39], v5 offset:13312
  v_mfma_f32_16x16x32_bf16 v[48:51], a[92:95], v[28:31], v[48:51]
  v_mfma_f32_16x16x32_bf16 v[52:55], v[40:43], v[28:31], v[52:55]
  s_waitcnt lgkmcnt(2)
  v_mfma_f32_16x16x32_bf16 v[44:47], a[96:99], v[20:23], v[44:47]
  ds_read_b128 v[28:31], v4 offset:7168
  ds_read_b128 v[40:43], v5 offset:14336
  v_mfma_f32_16x16x32_bf16 v[48:51], a[100:103], v[20:23], v[48:51]
  v_mfma_f32_16x16x32_bf16 v[52:55], v[32:35], v[20:23], v[52:55]
  s_waitcnt lgkmcnt(2)
  v_mfma_f32_16x16x32_bf16 v[44:47], a[104:107], v[24:27], v[44:47]
  ds_read_b128 v[20:23], v4 offset:7680
  ds_read_b128 v[32:35], v5 offset:15360
  v_mfma_f32_16x16x32_bf16 v[48:51], a[108:111], v[24:27], v[48:51]
  v_mfma_f32_16x16x32_bf16 v[52:55], v[36:39], v[24:27], v[52:55]
  s_waitcnt lgkmcnt(2)
  v_mfma_f32_16x16x32_bf16 v[44:47], a[112:115], v[28:31], v[44:47]
  ds_read_b128 v[24:27], v4 offset:8192
  ds_read_b128 v[36:39], v5 offset:16384
  v_mfma_f32_16x16x32_bf16 v[48:51], a[116:119], v[28:31], v[48:51]
  v_mfma_f32_16x16x32_bf16 v[52:55], v[40:43], v[28:31], v[52:55]
  s_waitcnt lgkmcnt(2)
  v_mfma_f32_16x16x32_bf16 v[44:47], a[120:123], v[20:23], v[44:47]
  ds_read_b128 v[28:31], v4 offset:8704
  ds_read_b128 v[40:43], v5 offset:17408
  v_mfma_f32_16x16x32_bf16 v[48:51], a[124:127], v[20:23], v[48:51]
  v_mfma_f32_16x16x32_bf16 v[52:55], v[32:35], v[20:23], v[52:55]
  s_waitcnt lgkmcnt(2)
  v_mfma_f32_16x16x32_bf16 v[44:47], a[128:131], v[24:27], v[44:47]
  ds_read_b128 v[20:23], v4 offset:9216
  ds_read_b128 v[32:35], v5 offset:18432
  v_mfma_f32_16x16x32_bf16 v[48:51], a[132:135], v[24:27], v[48:51]
  v_mfma_f32_16x16x32_bf16 v[52:55], v[36:39], v[24:27], v[52:55]
  s_waitcnt lgkmcnt(2)
  v_mfma_f32_16x16x32_bf16 v[44:47], a[136:139], v[28:31], v[44:47]
  ds_read_b128 v[24:27], v4 offset:9728
  ds_read_b128 v[36:39], v5 offset:19456
  v_mfma_f32_16x16x32_bf16 v[48:51], a[140:143], v[28:31], v[48:51]
  v_mfma_f32_16x16x32_bf16 v[52:55], v[40:43], v[28:31], v[52:55]
  s_waitcnt lgkmcnt(2)
  v_mfma_f32_16x16x32_bf16 v[44:47], a[144:147], v[20:23], v[44:47]
  v_mfma_f32_16x16x32_bf16 v[48:51], a[148:151], v[20:23], v[48:51]
  v_mfma_f32_16x16x32_bf16 v[52:55], v[32:35], v[20:23], v[52:55]
  s_waitcnt lgkmcnt(0)
  v_mfma_f32_16x16x32_bf16 v[44:47], a[152:155], v[24:27], v[44:47]
  v_mfma_f32_16x16x32_bf16 v[48:51], a[156:159], v[24:27], v[48:51]
  v_mfma_f32_16x16x32_bf16 v[52:55], v[36:39], v[24:27], v[52:55]
  s_nop 5
  v_cvt_pk_bf16_f32 v56, v44, v45
  v_cvt_pk_bf16_f32 v57, v46, v47
  ds_write_b64 v12, v[56:57] offset:0
  v_cvt_pk_bf16_f32 v58, v48, v49
  v_cvt_pk_bf16_f32 v59, v50, v51
  ds_write_b64 v12, v[58:59] offset:32
  v_cvt_pk_bf16_f32 v60, v52, v53
  v_cvt_pk_bf16_f32 v61, v54, v55
  ds_write_b64 v12, v[60:61] offset:64
  s_waitcnt lgkmcnt(0)
  s_barrier
  ds_read_b128 v[84:87], v13 offset:0
  ds_read_b128 v[88:91], v13 offset:64
  ds_read_b128 v[92:95], v13 offset:128
  ds_read_b128 v[96:99], v13 offset:192
  ds_read_b128 v[100:103], v13 offset:256
  ds_read_b128 v[104:107], v13 offset:320
  s_waitcnt vmcnt(0) lgkmcnt(0)
  v_mfma_f32_16x16x32_bf16 v[44:47], v[84:87], a[160:163], 0
  v_mfma_f32_16x16x32_bf16 v[48:51], v[84:87], a[184:187], 0
  v_mfma_f32_16x16x32_bf16 v[44:47], v[88:91], a[164:167], v[44:47]
  v_mfma_f32_16x16x32_bf16 v[48:51], v[88:91], a[188:191], v[48:51]
  v_mfma_f32_16x16x32_bf16 v[44:47], v[92:95], a[168:171], v[44:47]
  v_mfma_f32_16x16x32_bf16 v[48:51], v[92:95], a[192:195], v[48:51]
  v_mfma_f32_16x16x32_bf16 v[44:47], v[96:99], a[172:175], v[44:47]
  v_mfma_f32_16x16x32_bf16 v[48:51], v[96:99], a[196:199], v[48:51]
  v_mfma_f32_16x16x32_bf16 v[44:47], v[100:103], a[176:179], v[44:47]
  v_mfma_f32_16x16x32_bf16 v[48:51], v[100:103], a[200:203], v[48:51]
  v_mfma_f32_16x16x32_bf16 v[44:47], v[104:107], a[180:183], v[44:47]
  v_mfma_f32_16x16x32_bf16 v[48:51], v[104:107], a[204:207], v[48:51]
  v_mfma_f32_16x16x32_bf16 v[52:55], v[84:87], a[208:211], 0
  v_mfma_f32_16x16x32_bf16 v[56:59], v[84:87], a[232:235], 0
  v_mfma_f32_16x16x32_bf16 v[52:55], v[88:91], a[212:215], v[52:55]
  v_mfma_f32_16x16x32_bf16 v[56:59], v[88:91], a[236:239], v[56:59]
  v_mfma_f32_16x16x32_bf16 v[52:55], v[92:95], a[216:219], v[52:55]
  v_mfma_f32_16x16x32_bf16 v[56:59], v[92:95], a[240:243], v[56:59]
  v_mfma_f32_16x16x32_bf16 v[52:55], v[96:99], a[220:223], v[52:55]
  v_mfma_f32_16x16x32_bf16 v[56:59], v[96:99], a[244:247], v[56:59]
  v_cvt_pk_bf16_f32 v20, v44, v45
  v_cvt_pk_bf16_f32 v21, v46, v47
  v_cvt_pk_bf16_f32 v22, v48, v49
  v_cvt_pk_bf16_f32 v23, v50, v51
  v_min_u32 v20, s100, v20
  v_min_u32 v21, s100, v21
  v_min_u32 v22, s100, v22
  v_min_u32 v23, s100, v23
  s_nop 0
  v_permlane16_swap_b32 v20, v22
  v_permlane16_swap_b32 v21, v23
  s_add_u32 s73, s87, 0
  s_mov_b64 exec, s[82:83]
  buffer_store_dwordx4 v[20:23], v10, s[48:51], s73 offen sc1
  s_mov_b64 exec, -1
  v_mfma_f32_16x16x32_bf16 v[52:55], v[100:103], a[224:227], v[52:55]
  v_mfma_f32_16x16x32_bf16 v[56:59], v[100:103], a[248:251], v[56:59]
  v_mfma_f32_16x16x32_bf16 v[52:55], v[104:107], a[228:231], v[52:55]
  v_mfma_f32_16x16x32_bf16 v[56:59], v[104:107], a[252:255], v[56:59]
  v_mfma_f32_16x16x32_bf16 v[60:63], v[84:87], v[112:115], 0
  v_mfma_f32_16x16x32_bf16 v[64:67], v[84:87], v[136:139], 0
  v_mfma_f32_16x16x32_bf16 v[60:63], v[88:91], v[116:119], v[60:63]
  v_mfma_f32_16x16x32_bf16 v[64:67], v[88:91], v[140:143], v[64:67]
  v_mfma_f32_16x16x32_bf16 v[60:63], v[92:95], v[120:123], v[60:63]
  v_mfma_f32_16x16x32_bf16 v[64:67], v[92:95], v[144:147], v[64:67]
  v_mfma_f32_16x16x32_bf16 v[60:63], v[96:99], v[124:127], v[60:63]
  v_mfma_f32_16x16x32_bf16 v[64:67], v[96:99], v[148:151], v[64:67]
  v_cvt_pk_bf16_f32 v24, v52, v53
  v_cvt_pk_bf16_f32 v25, v54, v55
  v_cvt_pk_bf16_f32 v26, v56, v57
  v_cvt_pk_bf16_f32 v27, v58, v59
  v_min_u32 v24, s100, v24
  v_min_u32 v25, s100, v25
  v_min_u32 v26, s100, v26
  v_min_u32 v27, s100, v27
  s_nop 0
  v_permlane16_swap_b32 v24, v26
  v_permlane16_swap_b32 v25, v27
  s_add_u32 s73, s87, 16384
  s_mov_b64 exec, s[82:83]
  buffer_store_dwordx4 v[24:27], v10, s[48:51], s73 offen sc1
  s_mov_b64 exec, -1
  v_mfma_f32_16x16x32_bf16 v[60:63], v[100:103], v[128:131], v[60:63]
  v_mfma_f32_16x16x32_bf16 v[64:67], v[100:103], v[152:155], v[64:67]
  v_mfma_f32_16x16x32_bf16 v[60:63], v[104:107], v[132:135], v[60:63]
  v_mfma_f32_16x16x32_bf16 v[64:67], v[104:107], v[156:159], v[64:67]
  v_mfma_f32_16x16x32_bf16 v[68:71], v[84:87], v[160:163], 0
  v_mfma_f32_16x16x32_bf16 v[72:75], v[84:87], v[184:187], 0
  v_mfma_f32_16x16x32_bf16 v[68:71], v[88:91], v[164:167], v[68:71]
  v_mfma_f32_16x16x32_bf16 v[72:75], v[88:91], v[188:191], v[72:75]
  v_mfma_f32_16x16x32_bf16 v[68:71], v[92:95], v[168:171], v[68:71]
  v_mfma_f32_16x16x32_bf16 v[72:75], v[92:95], v[192:195], v[72:75]
  v_mfma_f32_16x16x32_bf16 v[68:71], v[96:99], v[172:175], v[68:71]
  v_mfma_f32_16x16x32_bf16 v[72:75], v[96:99], v[196:199], v[72:75]
  v_cvt_pk_bf16_f32 v28, v60, v61
  v_cvt_pk_bf16_f32 v29, v62, v63
  v_cvt_pk_bf16_f32 v30, v64, v65
  v_cvt_pk_bf16_f32 v31, v66, v67
  v_min_u32 v28, s100, v28
  v_min_u32 v29, s100, v29
  v_min_u32 v30, s100, v30
  v_min_u32 v31, s100, v31
  s_nop 0
  v_permlane16_swap_b32 v28, v30
  v_permlane16_swap_b32 v29, v31
  s_add_u32 s73, s87, 32768
  s_mov_b64 exec, s[82:83]
  buffer_store_dwordx4 v[28:31], v10, s[48:51], s73 offen sc1
  s_mov_b64 exec, -1
  v_mfma_f32_16x16x32_bf16 v[68:71], v[100:103], v[176:179], v[68:71]
  v_mfma_f32_16x16x32_bf16 v[72:75], v[100:103], v[200:203], v[72:75]
  v_mfma_f32_16x16x32_bf16 v[68:71], v[104:107], v[180:183], v[68:71]
  v_mfma_f32_16x16x32_bf16 v[72:75], v[104:107], v[204:207], v[72:75]
  v_mfma_f32_16x16x32_bf16 v[76:79], v[84:87], v[208:211], 0
  v_mfma_f32_16x16x32_bf16 v[80:83], v[84:87], v[232:235], 0
  v_mfma_f32_16x16x32_bf16 v[76:79], v[88:91], v[212:215], v[76:79]
  v_mfma_f32_16x16x32_bf16 v[80:83], v[88:91], v[236:239], v[80:83]
  v_mfma_f32_16x16x32_bf16 v[76:79], v[92:95], v[216:219], v[76:79]
  v_mfma_f32_16x16x32_bf16 v[80:83], v[92:95], v[240:243], v[80:83]
  v_mfma_f32_16x16x32_bf16 v[76:79], v[96:99], v[220:223], v[76:79]
  v_mfma_f32_16x16x32_bf16 v[80:83], v[96:99], v[244:247], v[80:83]
  v_cvt_pk_bf16_f32 v32, v68, v69
  v_cvt_pk_bf16_f32 v33, v70, v71
  v_cvt_pk_bf16_f32 v34, v72, v73
  v_cvt_pk_bf16_f32 v35, v74, v75
  v_min_u32 v32, s100, v32
  v_min_u32 v33, s100, v33
  v_min_u32 v34, s100, v34
  v_min_u32 v35, s100, v35
  s_nop 0
  v_permlane16_swap_b32 v32, v34
  v_permlane16_swap_b32 v33, v35
  s_add_u32 s73, s87, 49152
  s_mov_b64 exec, s[82:83]
  buffer_store_dwordx4 v[32:35], v10, s[48:51], s73 offen sc1
  s_mov_b64 exec, -1
  v_mfma_f32_16x16x32_bf16 v[76:79], v[100:103], v[224:227], v[76:79]
  v_mfma_f32_16x16x32_bf16 v[80:83], v[100:103], v[248:251], v[80:83]
  v_mfma_f32_16x16x32_bf16 v[76:79], v[104:107], v[228:231], v[76:79]
  v_mfma_f32_16x16x32_bf16 v[80:83], v[104:107], v[252:255], v[80:83]
  s_nop 6
  v_cvt_pk_bf16_f32 v36, v76, v77
  v_cvt_pk_bf16_f32 v37, v78, v79
  v_cvt_pk_bf16_f32 v38, v80, v81
  v_cvt_pk_bf16_f32 v39, v82, v83
  v_min_u32 v36, s100, v36
  v_min_u32 v37, s100, v37
  v_min_u32 v38, s100, v38
  v_min_u32 v39, s100, v39
  s_nop 0
  v_permlane16_swap_b32 v36, v38
  v_permlane16_swap_b32 v37, v39
  s_add_u32 s73, s87, 65536
  s_mov_b64 exec, s[82:83]
  buffer_store_dwordx4 v[36:39], v10, s[48:51], s73 offen sc1
  s_mov_b64 exec, -1
  s_cmp_eq_u32 s64, 63
  s_cbranch_scc1 mai_r_finv
  s_add_u32 s97, s64, 1
  s_lshr_b32 s97, s97, 2
  s_min_u32 s97, s97, 15
  s_lshl_b32 s97, s97, 7
  s_add_u32 s97, s97, 0
  s_cmp_eq_u32 s64, 14
  s_cselect_b32 s97, 24576, s97
  s_cselect_b32 s79, 3, 1
  s_mul_i32 s79, s79, 320
  ds_read_b128 v[52:55], v17 offset:32768
  ds_read_b128 v[56:59], v17 offset:33792
  ds_read_b128 v[60:63], v17 offset:34816
  ds_read_b128 v[64:67], v17 offset:35840
  ds_read_b128 v[68:71], v17 offset:36864
  ds_read_b128 v[72:75], v17 offset:37888
  ds_read_b128 v[76:79], v17 offset:38912
  ds_read_b128 v[80:83], v17 offset:39936
  s_cmp_lt_u32 s101, 2
  s_cselect_b32 s74, s88, s89
  s_mov_b32 s57, s71
mai_dl_32:
  s_cmp_eq_u32 s57, 0
  s_cbranch_scc1 mai_dld_33
  s_sleep 1
  s_sub_u32 s57, s57, 1
  s_branch mai_dl_32
mai_dld_33:
  buffer_load_dwordx4 v[20:23], v6, s[48:51], s86 offen offset:0 sc1
  buffer_load_dwordx4 v[24:27], v6, s[48:51], s86 offen offset:1024 sc1
  buffer_load_dwordx4 v[28:31], v6, s[48:51], s86 offen offset:2048 sc1
  buffer_load_dwordx4 v[32:35], v6, s[48:51], s86 offen offset:3072 sc1
  buffer_load_dwordx4 v[36:39], v7, s[48:51], s86 offen sc1
  buffer_load_dwordx4 v[40:43], v8, s[48:51], s88 offen sc1
  buffer_load_dwordx4 v[44:47], v8, s[48:51], s74 offen sc1
  buffer_load_dword v48, off, s[48:51], s97 sc1
  s_mov_b32 s78, 0
  s_waitcnt lgkmcnt(0)
  s_waitcnt vmcnt(0)
  v_max3_u32 v18, v20, v21, v22
  v_max3_u32 v18, v18, v23, v24
  v_max3_u32 v18, v18, v25, v26
  v_max3_u32 v18, v18, v27, v28
  v_max3_u32 v18, v18, v29, v30
  v_max3_u32 v18, v18, v31, v32
  v_max3_u32 v18, v18, v33, v34
  v_max3_u32 v18, v18, v35, v36
  v_max3_u32 v18, v18, v37, v38
  v_max3_u32 v18, v18, v39, v40
  v_max3_u32 v18, v18, v41, v42
  v_max3_u32 v18, v18, v43, v44
  v_max3_u32 v18, v18, v45, v46
  v_max_u32 v18, v18, v47
  v_cmp_eq_u32 vcc, -1, v18
  v_cmp_gt_u32 s[80:81], s79, v48
  s_or_b64 vcc, vcc, s[80:81]
  s_cbranch_vccz mai_gbd_31
mai_gb_30:
  buffer_load_dwordx4 v[20:23], v6, s[48:51], s86 offen offset:0 sc1
  buffer_load_dwordx4 v[24:27], v6, s[48:51], s86 offen offset:1024 sc1
  buffer_load_dwordx4 v[28:31], v6, s[48:51], s86 offen offset:2048 sc1
  buffer_load_dwordx4 v[32:35], v6, s[48:51], s86 offen offset:3072 sc1
  buffer_load_dwordx4 v[36:39], v7, s[48:51], s86 offen sc1
  buffer_load_dwordx4 v[40:43], v8, s[48:51], s88 offen sc1
  buffer_load_dwordx4 v[44:47], v8, s[48:51], s74 offen sc1
  buffer_load_dword v48, off, s[48:51], s97 sc1
  s_add_u32 s78, s78, 1
  s_waitcnt vmcnt(0)
  v_max3_u32 v18, v20, v21, v22
  v_max3_u32 v18, v18, v23, v24
  v_max3_u32 v18, v18, v25, v26
  v_max3_u32 v18, v18, v27, v28
  v_max3_u32 v18, v18, v29, v30
  v_max3_u32 v18, v18, v31, v32
  v_max3_u32 v18, v18, v33, v34
  v_max3_u32 v18, v18, v35, v36
  v_max3_u32 v18, v18, v37, v38
  v_max3_u32 v18, v18, v39, v40
  v_max3_u32 v18, v18, v41, v42
  v_max3_u32 v18, v18, v43, v44
  v_max3_u32 v18, v18, v45, v46
  v_max_u32 v18, v18, v47
  v_cmp_eq_u32 vcc, -1, v18
  v_cmp_gt_u32 s[80:81], s79, v48
  s_or_b64 vcc, vcc, s[80:81]
  s_cbranch_vccz mai_gbd_31
  s_cmp_lt_u32 s78, 1048576
  s_cbranch_scc1 mai_gb_30
mai_gbd_31:
  v_mfma_f32_16x16x32_bf16 v[84:87], v[40:43], v[36:39], 0
  v_mfma_f32_16x16x32_bf16 v[88:91], v[44:47], v[36:39], 0
  v_mfma_f32_16x16x32_bf16 v[84:87], v[52:55], v[20:23], v[84:87]
  v_mfma_f32_16x16x32_bf16 v[88:91], v[68:71], v[20:23], v[88:91]
  v_mfma_f32_16x16x32_bf16 v[84:87], v[56:59], v[24:27], v[84:87]
  v_mfma_f32_16x16x32_bf16 v[88:91], v[72:75], v[24:27], v[88:91]
  v_mfma_f32_16x16x32_bf16 v[84:87], v[60:63], v[28:31], v[84:87]
  v_mfma_f32_16x16x32_bf16 v[88:91], v[76:79], v[28:31], v[88:91]
  v_mfma_f32_16x16x32_bf16 v[84:87], v[64:67], v[32:35], v[84:87]
  v_mfma_f32_16x16x32_bf16 v[88:91], v[80:83], v[32:35], v[88:91]
  s_cmp_eq_u32 s78, 0
  s_cbranch_scc1 mai_ad_34
  s_add_u32 s71, s71, 2
  s_min_u32 s71, s71, 30
  s_mov_b32 s77, 0
  s_branch mai_ad_35
mai_ad_34:
  s_add_u32 s77, s77, 1
  s_cmp_lt_u32 s77, 4
  s_cbranch_scc1 mai_ad_35
  s_mov_b32 s77, 0
  s_max_u32 s71, s71, 1
  s_sub_u32 s71, s71, 1
mai_ad_35:
  s_lshl_b32 s57, s56, 10
  v_add_u32 v18, s57, v16
  ds_write_b128 v18, v[84:87] offset:23552
  ds_write_b128 v18, v[88:91] offset:27648
  s_lshl_b32 s57, s56, 12
  v_add_u32 v19, s57, v16
  s_lshl_b32 s58, s56, 7
  s_add_u32 s58, s58, s90
  s_waitcnt lgkmcnt(0)
  s_barrier
  s_cmp_ge_u32 s56, s101
  s_cbranch_scc1 mai_cbsk_36
  ds_read_b128 v[20:23], v19 offset:23552
  ds_read_b128 v[24:27], v19 offset:24192
  ds_read_b128 v[28:31], v19 offset:24576
  ds_read_b128 v[32:35], v19 offset:25216
  ds_read_b128 v[36:39], v19 offset:25600
  ds_read_b128 v[40:43], v19 offset:26240
  ds_read_b128 v[44:47], v19 offset:26624
  ds_read_b128 v[48:51], v19 offset:27264
  s_waitcnt lgkmcnt(4)
  v_pk_add_f32 v[20:21], v[20:21], v[24:25]
  v_pk_add_f32 v[28:29], v[28:29], v[32:33]
  v_pk_add_f32 v[22:23], v[22:23], v[26:27]
  v_pk_add_f32 v[30:31], v[30:31], v[34:35]
  s_waitcnt lgkmcnt(0)
  v_pk_add_f32 v[36:37], v[36:37], v[40:41]
  v_pk_add_f32 v[44:45], v[44:45], v[48:49]
  v_pk_add_f32 v[38:39], v[38:39], v[42:43]
  v_pk_add_f32 v[46:47], v[46:47], v[50:51]
  v_pk_add_f32 v[20:21], v[20:21], v[28:29]
  v_pk_add_f32 v[36:37], v[36:37], v[44:45]
  v_pk_add_f32 v[22:23], v[22:23], v[30:31]
  v_pk_add_f32 v[38:39], v[38:39], v[46:47]
  v_pk_add_f32 v[20:21], v[20:21], v[36:37]
  v_pk_add_f32 v[22:23], v[22:23], v[38:39]
  v_cvt_pk_bf16_f32 v52, v20, v21
  v_cvt_pk_bf16_f32 v53, v22, v23
  v_min_u32 v52, s100, v52
  v_min_u32 v53, s100, v53
  s_mov_b64 exec, s[68:69]
  buffer_store_dwordx2 v[52:53], v15, s[48:51], s58 offen sc1
mai_cbsk_36:
  s_mov_b64 exec, -1
  s_barrier
  s_add_u32 s64, s64, 1
  s_add_u32 s84, s84, 10240
  s_add_u32 s85, s85, 10240
  s_add_u32 s86, s86, 20480
  s_add_u32 s88, s88, 327680
  s_add_u32 s89, s89, 327680
  s_add_u32 s90, s90, 10240
  s_add_u32 s91, s91, 196608
  s_add_u32 s94, s94, 393216
  s_add_u32 s96, s96, 1310720
  s_add_u32 s98, s98, 8192
  s_add_u32 s87, s87, 327680
  s_branch mai_r_loopv
mai_r_finv:
  s_waitcnt vmcnt(0)
  s_barrier
  s_add_u32 s64, s64, 1
  s_add_u32 s98, s98, 8192
  s_cmp_lg_u32 s56, 0
  s_cbranch_scc1 mai_rs_37
  s_cmp_eq_u32 s64, 0
  s_cbranch_scc1 mai_rs_37
  v_mov_b32 v19, 1
  s_sub_u32 s57, s98, 8192
  s_mov_b64 exec, 1
  buffer_store_dword v19, off, s[48:51], s57 sc1
  s_mov_b64 exec, -1
mai_rs_37:
  s_branch mai_k_exit
mai_k_worker:
  s_sub_u32 s95, s2, 64
  s_mul_hi_u32 s96, s95, 715827883
  s_mul_i32 s57, s96, 6
  s_sub_u32 s91, s95, s57
  s_mov_b32 s97, 8
  s_cmp_lt_u32 s95, 64
  s_cbranch_scc1 mai_w_hl1
  s_and_b32 s57, s95, 7
  s_sub_u32 s58, s95, 64
  s_lshr_b32 s58, s58, 3
  s_add_u32 s100, s58, 16
  s_sub_u32 s57, s57, 4
  s_branch mai_w_hl2
mai_w_hl1:
  s_and_b32 s57, s95, 3
  s_lshr_b32 s100, s95, 2
mai_w_hl2:
  s_lshl_b32 s98, s57, 3
  s_lshl_b32 s99, s100, 2
  s_add_u32 s99, s99, s57
  s_cmp_lt_u32 s57, 4
  s_cselect_b32 s99, s99, -1
  s_mov_b32 s101, 0
  s_mov_b32 s90, 0
  s_mov_b32 s92, 0
  s_mov_b32 s93, 5
  s_mov_b32 s94, 5
  s_mov_b32 s64, s96
  s_cmp_eq_u32 s91, 5
  s_cbranch_scc1 mai_w_t0k
  s_mov_b32 s92, s91
  s_mov_b32 s93, 1
  s_mov_b32 s94, 1
  s_branch mai_w_t9
mai_w_t0k:
  s_add_u32 s64, s64, 32
  s_branch mai_w_t9
mai_w_next:
  s_mov_b32 s92, 0
  s_mov_b32 s93, 5
  s_mov_b32 s94, 5
  s_cmp_eq_u32 s101, 6
  s_cbranch_scc1 mai_w_n6
  s_cmp_eq_u32 s101, 5
  s_cbranch_scc1 mai_w_n5
  s_cmp_eq_u32 s101, 4
  s_cbranch_scc1 mai_w_n4
  s_cmp_eq_u32 s101, 1
  s_cbranch_scc1 mai_w_n1
  s_cmp_eq_u32 s101, 0
  s_cbranch_scc1 mai_w_n0
  s_cmp_eq_u32 s99, -1
  s_cbranch_scc1 mai_w_to6
  s_mov_b32 s101, 3
  s_add_u32 s90, s90, 32
  s_branch mai_w_d1
mai_w_n0:
  s_cmp_eq_u32 s99, -1
  s_cbranch_scc1 mai_w_n1
  s_mov_b32 s101, 1
  s_mov_b32 s90, s100
  s_branch mai_w_d1
mai_w_n1:
  s_mov_b32 s101, 2
  s_branch mai_w_fill
mai_w_d1:
  s_cmp_lt_u32 s90, 240
  s_cbranch_scc1 mai_w_d1b
  s_mov_b32 s101, 4
  s_mov_b32 s90, s100
  s_branch mai_w_d2
mai_w_d1b:
  s_lshr_b32 s57, s90, 4
  s_and_b32 s58, s90, 15
  s_add_u32 s64, s57, 1
  s_lshl_b32 s64, s64, 6
  s_lshr_b32 s57, s58, 1
  s_add_u32 s64, s64, s57
  s_add_u32 s64, s64, s98
  s_lshr_b32 s57, s90, 5
  s_xor_b32 s57, s57, s58
  s_and_b32 s57, s57, 1
  s_lshl_b32 s57, s57, 5
  s_add_u32 s64, s64, s57
  s_branch mai_w_t9
mai_w_n4:
  s_add_u32 s90, s90, 32
mai_w_d2:
  s_mov_b32 s94, 1
  s_cmp_lt_u32 s90, 128
  s_cbranch_scc1 mai_w_d2b
  s_mov_b32 s101, 5
  s_mov_b32 s90, s99
  s_branch mai_w_d5
mai_w_d2b:
  s_lshr_b32 s57, s90, 3
  s_and_b32 s58, s90, 7
  s_lshl_b32 s64, s57, 5
  s_add_u32 s64, s64, s58
  s_add_u32 s64, s64, s98
  s_add_u32 s64, s64, 1024
  s_branch mai_w_t9
mai_w_n5:
  s_add_u32 s90, s90, 128
mai_w_d5:
  s_mov_b32 s94, 1
  s_cmp_ge_u32 s90, 208
  s_cbranch_scc1 mai_w_to6
  s_add_u32 s64, s90, 1536
  s_branch mai_w_t9
mai_w_to6:
  s_mov_b32 s101, 6
  s_mov_b32 s90, s95
  s_branch mai_w_d6
mai_w_n6:
  s_add_u32 s90, s90, 192
mai_w_d6:
  s_mov_b32 s94, 1
  s_cmp_ge_u32 s90, 1152
  s_cbranch_scc1 mai_w_fin
  s_add_u32 s64, s90, 1744
mai_w_t9:
  s_barrier
  s_cmp_ge_u32 s64, 1744
  s_cbranch_scc1 mai_w_ph3
  s_cmp_ge_u32 s64, 1664
  s_cbranch_scc1 mai_w_ffn2
  s_mov_b32 s68, 40960
  s_mov_b32 s67, 36122624
  s_mov_b32 s69, 10
  s_cmp_ge_u32 s64, 1536
  s_cbranch_scc1 mai_w_ffn1
  s_mov_b32 s65, 12288
  s_cmp_ge_u32 s64, 1024
  s_cbranch_scc1 mai_w_q
  s_lshr_b32 s57, s64, 6
  s_lshl_b32 s73, s57, 7
  s_lshl_b32 s76, s57, 7
  s_add_u32 s76, s76, 0
  s_and_b32 s77, s64, 31
  s_mul_i32 s74, s77, 192
  s_bitcmp1_b32 s64, 5
  s_cbranch_scc1 mai_w_k
  s_mov_b32 s72, 2
  s_mov_b32 s52, s20
  s_mov_b32 s53, s21
  s_mov_b32 s54, s22
  s_mov_b32 s55, s23
  s_branch mai_w_g12
mai_w_k:
  s_mov_b32 s72, 0
  s_mov_b32 s75, 38744064
  s_mov_b32 s52, s16
  s_mov_b32 s53, s17
  s_mov_b32 s54, s18
  s_mov_b32 s55, s19
  s_branch mai_w_g12
mai_w_q:
  s_sub_u32 s58, s64, 1024
  s_lshr_b32 s57, s58, 5
  s_lshl_b32 s73, s57, 7
  s_lshl_b32 s76, s57, 7
  s_add_u32 s76, s76, 2048
  s_and_b32 s77, s58, 31
  s_mul_i32 s74, s77, 192
  s_mov_b32 s72, 0
  s_mov_b32 s75, 63909888
  s_mov_b32 s52, s12
  s_mov_b32 s53, s13
  s_mov_b32 s54, s14
  s_mov_b32 s55, s15
  s_branch mai_w_g12
mai_w_ffn1:
  s_sub_u32 s58, s64, 1536
  s_lshr_b32 s57, s58, 3
  s_lshl_b32 s73, s57, 7
  s_lshl_b32 s76, s57, 7
  s_add_u32 s76, s76, 4096
  s_and_b32 s77, s58, 7
  s_mul_i32 s74, s77, 192
  s_mov_b32 s72, 1
  s_mov_b32 s75, 172961792
  s_mov_b32 s65, 3072
  s_mov_b32 s52, s28
  s_mov_b32 s53, s29
  s_mov_b32 s54, s30
  s_mov_b32 s55, s31
mai_w_g12:
  s_cmp_ge_u32 s64, 1536
  s_cbranch_scc1 mai_w_g12z
mai_w_g12z:
  s_lshl_b32 s66, s74, 1
  v_lshlrev_b32 v60, 4, v1
  s_lshr_b32 s89, s73, 5
  s_add_u32 s89, s89, s56
  s_mul_i32 s57, s89, s68
  s_add_u32 s67, s67, s57
  s_cmp_lg_u32 s72, 2
  s_cbranch_scc1 mai_w_g12b
  s_mul_i32 s57, s56, 768
  s_mov_b32 s59, 1280
  v_add_u32 v2, s57, v1
  v_lshrrev_b32 v3, 4, v2
  v_and_b32 v4, 15, v2
  v_lshrrev_b32 v2, 1, v3
  v_xor_b32 v2, v2, v3
  v_and_b32 v2, 4, v2
  v_and_b32 v5, 3, v3
  v_or_b32 v5, v5, v2
  v_lshlrev_b32 v5, 1, v5
  v_xor_b32 v4, v4, v5
  v_mul_lo_u32 v48, v3, s59
  v_lshl_add_u32 v48, v4, 4, v48
  v_add_u32 v2, s57, v1
  v_add_u32 v2, 64, v2
  v_lshrrev_b32 v3, 4, v2
  v_and_b32 v4, 15, v2
  v_lshrrev_b32 v2, 1, v3
  v_xor_b32 v2, v2, v3
  v_and_b32 v2, 4, v2
  v_and_b32 v5, 3, v3
  v_or_b32 v5, v5, v2
  v_lshlrev_b32 v5, 1, v5
  v_xor_b32 v4, v4, v5
  v_mul_lo_u32 v49, v3, s59
  v_lshl_add_u32 v49, v4, 4, v49
  v_add_u32 v2, s57, v1
  v_add_u32 v2, 128, v2
  v_lshrrev_b32 v3, 4, v2
  v_and_b32 v4, 15, v2
  v_lshrrev_b32 v2, 1, v3
  v_xor_b32 v2, v2, v3
  v_and_b32 v2, 4, v2
  v_and_b32 v5, 3, v3
  v_or_b32 v5, v5, v2
  v_lshlrev_b32 v5, 1, v5
  v_xor_b32 v4, v4, v5
  v_mul_lo_u32 v50, v3, s59
  v_lshl_add_u32 v50, v4, 4, v50
  v_add_u32 v2, s57, v1
  v_add_u32 v2, 192, v2
  v_lshrrev_b32 v3, 4, v2
  v_and_b32 v4, 15, v2
  v_lshrrev_b32 v2, 1, v3
  v_xor_b32 v2, v2, v3
  v_and_b32 v2, 4, v2
  v_and_b32 v5, 3, v3
  v_or_b32 v5, v5, v2
  v_lshlrev_b32 v5, 1, v5
  v_xor_b32 v4, v4, v5
  v_mul_lo_u32 v51, v3, s59
  v_lshl_add_u32 v51, v4, 4, v51
  v_add_u32 v2, s57, v1
  v_add_u32 v2, 256, v2
  v_lshrrev_b32 v3, 4, v2
  v_and_b32 v4, 15, v2
  v_lshrrev_b32 v2, 1, v3
  v_xor_b32 v2, v2, v3
  v_and_b32 v2, 4, v2
  v_and_b32 v5, 3, v3
  v_or_b32 v5, v5, v2
  v_lshlrev_b32 v5, 1, v5
  v_xor_b32 v4, v4, v5
  v_mul_lo_u32 v52, v3, s59
  v_lshl_add_u32 v52, v4, 4, v52
  v_add_u32 v2, s57, v1
  v_add_u32 v2, 320, v2
  v_lshrrev_b32 v3, 4, v2
  v_and_b32 v4, 15, v2
  v_lshrrev_b32 v2, 1, v3
  v_xor_b32 v2, v2, v3
  v_and_b32 v2, 4, v2
  v_and_b32 v5, 3, v3
  v_or_b32 v5, v5, v2
  v_lshlrev_b32 v5, 1, v5
  v_xor_b32 v4, v4, v5
  v_mul_lo_u32 v53, v3, s59
  v_lshl_add_u32 v53, v4, 4, v53
  v_add_u32 v2, s57, v1
  v_add_u32 v2, 384, v2
  v_lshrrev_b32 v3, 4, v2
  v_and_b32 v4, 15, v2
  v_lshrrev_b32 v2, 1, v3
  v_xor_b32 v2, v2, v3
  v_and_b32 v2, 4, v2
  v_and_b32 v5, 3, v3
  v_or_b32 v5, v5, v2
  v_lshlrev_b32 v5, 1, v5
  v_xor_b32 v4, v4, v5
  v_mul_lo_u32 v54, v3, s59
  v_lshl_add_u32 v54, v4, 4, v54
  v_add_u32 v2, s57, v1
  v_add_u32 v2, 448, v2
  v_lshrrev_b32 v3, 4, v2
  v_and_b32 v4, 15, v2
  v_lshrrev_b32 v2, 1, v3
  v_xor_b32 v2, v2, v3
  v_and_b32 v2, 4, v2
  v_and_b32 v5, 3, v3
  v_or_b32 v5, v5, v2
  v_lshlrev_b32 v5, 1, v5
  v_xor_b32 v4, v4, v5
  v_mul_lo_u32 v55, v3, s59
  v_lshl_add_u32 v55, v4, 4, v55
  v_add_u32 v2, s57, v1
  v_add_u32 v2, 512, v2
  v_lshrrev_b32 v3, 4, v2
  v_and_b32 v4, 15, v2
  v_lshrrev_b32 v2, 1, v3
  v_xor_b32 v2, v2, v3
  v_and_b32 v2, 4, v2
  v_and_b32 v5, 3, v3
  v_or_b32 v5, v5, v2
  v_lshlrev_b32 v5, 1, v5
  v_xor_b32 v4, v4, v5
  v_mul_lo_u32 v56, v3, s59
  v_lshl_add_u32 v56, v4, 4, v56
  v_add_u32 v2, s57, v1
  v_add_u32 v2, 576, v2
  v_lshrrev_b32 v3, 4, v2
  v_and_b32 v4, 15, v2
  v_lshrrev_b32 v2, 1, v3
  v_xor_b32 v2, v2, v3
  v_and_b32 v2, 4, v2
  v_and_b32 v5, 3, v3
  v_or_b32 v5, v5, v2
  v_lshlrev_b32 v5, 1, v5
  v_xor_b32 v4, v4, v5
  v_mul_lo_u32 v57, v3, s59
  v_lshl_add_u32 v57, v4, 4, v57
  v_add_u32 v2, s57, v1
  v_add_u32 v2, 640, v2
  v_lshrrev_b32 v3, 4, v2
  v_and_b32 v4, 15, v2
  v_lshrrev_b32 v2, 1, v3
  v_xor_b32 v2, v2, v3
  v_and_b32 v2, 4, v2
  v_and_b32 v5, 3, v3
  v_or_b32 v5, v5, v2
  v_lshlrev_b32 v5, 1, v5
  v_xor_b32 v4, v4, v5
  v_mul_lo_u32 v58, v3, s59
  v_lshl_add_u32 v58, v4, 4, v58
  v_add_u32 v2, s57, v1
  v_add_u32 v2, 704, v2
  v_lshrrev_b32 v3, 4, v2
  v_and_b32 v4, 15, v2
  v_lshrrev_b32 v2, 1, v3
  v_xor_b32 v2, v2, v3
  v_and_b32 v2, 4, v2
  v_and_b32 v5, 3, v3
  v_or_b32 v5, v5, v2
  v_lshlrev_b32 v5, 1, v5
  v_xor_b32 v4, v4, v5
  v_mul_lo_u32 v59, v3, s59
  v_lshl_add_u32 v59, v4, 4, v59
  v_accvgpr_write_b32 a128, v48
  v_accvgpr_write_b32 a129, v49
  v_accvgpr_write_b32 a130, v50
  v_accvgpr_write_b32 a131, v51
  v_accvgpr_write_b32 a132, v52
  v_accvgpr_write_b32 a133, v53
  v_accvgpr_write_b32 a134, v54
  v_accvgpr_write_b32 a135, v55
  v_accvgpr_write_b32 a136, v56
  v_accvgpr_write_b32 a137, v57
  v_accvgpr_write_b32 a138, v58
  v_accvgpr_write_b32 a139, v59
  s_mul_i32 s88, s77, 245760
  s_lshl_b32 s57, s92, 8
  s_add_u32 s88, s88, s57
  s_mul_i32 s57, s56, 12288
  s_add_u32 s57, s57, 98304
  s_add_u32 m0, s57, 0
  s_nop 0
  buffer_load_dwordx4 v48, s[24:27], s88 offen lds
  s_add_u32 m0, s57, 1024
  s_nop 0
  buffer_load_dwordx4 v49, s[24:27], s88 offen lds
  s_add_u32 m0, s57, 2048
  s_nop 0
  buffer_load_dwordx4 v50, s[24:27], s88 offen lds
  s_add_u32 m0, s57, 3072
  s_nop 0
  buffer_load_dwordx4 v51, s[24:27], s88 offen lds
  s_add_u32 m0, s57, 4096
  s_nop 0
  buffer_load_dwordx4 v52, s[24:27], s88 offen lds
  s_add_u32 m0, s57, 5120
  s_nop 0
  buffer_load_dwordx4 v53, s[24:27], s88 offen lds
  s_add_u32 m0, s57, 6144
  s_nop 0
  buffer_load_dwordx4 v54, s[24:27], s88 offen lds
  s_add_u32 m0, s57, 7168
  s_nop 0
  buffer_load_dwordx4 v55, s[24:27], s88 offen lds
  s_add_u32 m0, s57, 8192
  s_nop 0
  buffer_load_dwordx4 v56, s[24:27], s88 offen lds
  s_add_u32 m0, s57, 9216
  s_nop 0
  buffer_load_dwordx4 v57, s[24:27], s88 offen lds
  s_add_u32 m0, s57, 10240
  s_nop 0
  buffer_load_dwordx4 v58, s[24:27], s88 offen lds
  s_add_u32 m0, s57, 11264
  s_nop 0
  buffer_load_dwordx4 v59, s[24:27], s88 offen lds
  s_add_u32 s88, s88, 256
mai_w_g12b:
  s_mul_i32 s57, s56, 384
  v_add_u32 v2, s57, v1
  v_mul_u32_u24 v3, 2731, v2
  v_lshrrev_b32 v3, 16, v3
  v_mul_u32_u24 v4, 24, v3
  v_sub_u32 v4, v2, v4
  v_lshrrev_b32 v2, 1, v3
  v_xor_b32 v2, v2, v3
  v_and_b32 v2, 4, v2
  v_and_b32 v5, 2, v3
  v_or_b32 v5, v5, v2
  v_xor_b32 v4, v4, v5
  v_mul_lo_u32 v48, v3, s65
  v_lshl_add_u32 v48, v4, 4, v48
  v_add_u32 v2, s57, v1
  v_add_u32 v2, 64, v2
  v_mul_u32_u24 v3, 2731, v2
  v_lshrrev_b32 v3, 16, v3
  v_mul_u32_u24 v4, 24, v3
  v_sub_u32 v4, v2, v4
  v_lshrrev_b32 v2, 1, v3
  v_xor_b32 v2, v2, v3
  v_and_b32 v2, 4, v2
  v_and_b32 v5, 2, v3
  v_or_b32 v5, v5, v2
  v_xor_b32 v4, v4, v5
  v_mul_lo_u32 v49, v3, s65
  v_lshl_add_u32 v49, v4, 4, v49
  v_add_u32 v2, s57, v1
  v_add_u32 v2, 128, v2
  v_mul_u32_u24 v3, 2731, v2
  v_lshrrev_b32 v3, 16, v3
  v_mul_u32_u24 v4, 24, v3
  v_sub_u32 v4, v2, v4
  v_lshrrev_b32 v2, 1, v3
  v_xor_b32 v2, v2, v3
  v_and_b32 v2, 4, v2
  v_and_b32 v5, 2, v3
  v_or_b32 v5, v5, v2
  v_xor_b32 v4, v4, v5
  v_mul_lo_u32 v50, v3, s65
  v_lshl_add_u32 v50, v4, 4, v50
  v_add_u32 v2, s57, v1
  v_add_u32 v2, 192, v2
  v_mul_u32_u24 v3, 2731, v2
  v_lshrrev_b32 v3, 16, v3
  v_mul_u32_u24 v4, 24, v3
  v_sub_u32 v4, v2, v4
  v_lshrrev_b32 v2, 1, v3
  v_xor_b32 v2, v2, v3
  v_and_b32 v2, 4, v2
  v_and_b32 v5, 2, v3
  v_or_b32 v5, v5, v2
  v_xor_b32 v4, v4, v5
  v_mul_lo_u32 v51, v3, s65
  v_lshl_add_u32 v51, v4, 4, v51
  v_add_u32 v2, s57, v1
  v_add_u32 v2, 256, v2
  v_mul_u32_u24 v3, 2731, v2
  v_lshrrev_b32 v3, 16, v3
  v_mul_u32_u24 v4, 24, v3
  v_sub_u32 v4, v2, v4
  v_lshrrev_b32 v2, 1, v3
  v_xor_b32 v2, v2, v3
  v_and_b32 v2, 4, v2
  v_and_b32 v5, 2, v3
  v_or_b32 v5, v5, v2
  v_xor_b32 v4, v4, v5
  v_mul_lo_u32 v52, v3, s65
  v_lshl_add_u32 v52, v4, 4, v52
  v_add_u32 v2, s57, v1
  v_add_u32 v2, 320, v2
  v_mul_u32_u24 v3, 2731, v2
  v_lshrrev_b32 v3, 16, v3
  v_mul_u32_u24 v4, 24, v3
  v_sub_u32 v4, v2, v4
  v_lshrrev_b32 v2, 1, v3
  v_xor_b32 v2, v2, v3
  v_and_b32 v2, 4, v2
  v_and_b32 v5, 2, v3
  v_or_b32 v5, v5, v2
  v_xor_b32 v4, v4, v5
  v_mul_lo_u32 v53, v3, s65
  v_lshl_add_u32 v53, v4, 4, v53
  v_lshrrev_b32 v2, 4, v1
  v_bfe_u32 v3, v1, 2, 2
  v_and_b32 v4, 3, v1
  v_lshl_add_u32 v5, v2, 3, v3
  v_lshrrev_b32 v7, 1, v5
  v_xor_b32 v7, v7, v5
  v_and_b32 v7, 4, v7
  v_and_b32 v6, 2, v5
  v_or_b32 v6, v6, v7
  v_lshrrev_b32 v7, 1, v4
  v_add_u32 v7, 0, v7
  v_xor_b32 v7, v7, v6
  v_mul_u32_u24 v8, 24, v5
  v_add_u32 v7, v7, v8
  v_and_b32 v8, 1, v4
  v_lshlrev_b32 v8, 3, v8
  v_lshl_add_u32 v32, v7, 4, v8
  v_lshrrev_b32 v7, 1, v4
  v_add_u32 v7, 2, v7
  v_xor_b32 v7, v7, v6
  v_mul_u32_u24 v8, 24, v5
  v_add_u32 v7, v7, v8
  v_and_b32 v8, 1, v4
  v_lshlrev_b32 v8, 3, v8
  v_lshl_add_u32 v33, v7, 4, v8
  v_lshrrev_b32 v7, 1, v4
  v_add_u32 v7, 4, v7
  v_xor_b32 v7, v7, v6
  v_mul_u32_u24 v8, 24, v5
  v_add_u32 v7, v7, v8
  v_and_b32 v8, 1, v4
  v_lshlrev_b32 v8, 3, v8
  v_lshl_add_u32 v34, v7, 4, v8
  v_lshrrev_b32 v7, 1, v4
  v_add_u32 v7, 6, v7
  v_xor_b32 v7, v7, v6
  v_mul_u32_u24 v8, 24, v5
  v_add_u32 v7, v7, v8
  v_and_b32 v8, 1, v4
  v_lshlrev_b32 v8, 3, v8
  v_lshl_add_u32 v35, v7, 4, v8
  v_lshl_add_u32 v5, v2, 3, v3
  v_add_u32 v5, 4, v5
  v_lshrrev_b32 v7, 1, v5
  v_xor_b32 v7, v7, v5
  v_and_b32 v7, 4, v7
  v_and_b32 v6, 2, v5
  v_or_b32 v6, v6, v7
  v_lshrrev_b32 v7, 1, v4
  v_add_u32 v7, 0, v7
  v_xor_b32 v7, v7, v6
  v_mul_u32_u24 v8, 24, v5
  v_add_u32 v7, v7, v8
  v_and_b32 v8, 1, v4
  v_lshlrev_b32 v8, 3, v8
  v_lshl_add_u32 v36, v7, 4, v8
  v_lshrrev_b32 v7, 1, v4
  v_add_u32 v7, 2, v7
  v_xor_b32 v7, v7, v6
  v_mul_u32_u24 v8, 24, v5
  v_add_u32 v7, v7, v8
  v_and_b32 v8, 1, v4
  v_lshlrev_b32 v8, 3, v8
  v_lshl_add_u32 v37, v7, 4, v8
  v_lshrrev_b32 v7, 1, v4
  v_add_u32 v7, 4, v7
  v_xor_b32 v7, v7, v6
  v_mul_u32_u24 v8, 24, v5
  v_add_u32 v7, v7, v8
  v_and_b32 v8, 1, v4
  v_lshlrev_b32 v8, 3, v8
  v_lshl_add_u32 v38, v7, 4, v8
  v_lshrrev_b32 v7, 1, v4
  v_add_u32 v7, 6, v7
  v_xor_b32 v7, v7, v6
  v_mul_u32_u24 v8, 24, v5
  v_add_u32 v7, v7, v8
  v_and_b32 v8, 1, v4
  v_lshlrev_b32 v8, 3, v8
  v_lshl_add_u32 v39, v7, 4, v8
  v_mov_b32 v160, 0
  v_mov_b32 v161, 0
  v_mov_b32 v162, 0
  v_mov_b32 v163, 0
  v_mov_b32 v164, 0
  v_mov_b32 v165, 0
  v_mov_b32 v166, 0
  v_mov_b32 v167, 0
  v_mov_b32 v168, 0
  v_mov_b32 v169, 0
  v_mov_b32 v170, 0
  v_mov_b32 v171, 0
  v_mov_b32 v172, 0
  v_mov_b32 v173, 0
  v_mov_b32 v174, 0
  v_mov_b32 v175, 0
  v_mov_b32 v176, 0
  v_mov_b32 v177, 0
  v_mov_b32 v178, 0
  v_mov_b32 v179, 0
  v_mov_b32 v180, 0
  v_mov_b32 v181, 0
  v_mov_b32 v182, 0
  v_mov_b32 v183, 0
  v_mov_b32 v184, 0
  v_mov_b32 v185, 0
  v_mov_b32 v186, 0
  v_mov_b32 v187, 0
  v_mov_b32 v188, 0
  v_mov_b32 v189, 0
  v_mov_b32 v190, 0
  v_mov_b32 v191, 0
  v_mov_b32 v192, 0
  v_mov_b32 v193, 0
  v_mov_b32 v194, 0
  v_mov_b32 v195, 0
  v_mov_b32 v196, 0
  v_mov_b32 v197, 0
  v_mov_b32 v198, 0
  v_mov_b32 v199, 0
  v_mov_b32 v200, 0
  v_mov_b32 v201, 0
  v_mov_b32 v202, 0
  v_mov_b32 v203, 0
  v_mov_b32 v204, 0
  v_mov_b32 v205, 0
  v_mov_b32 v206, 0
  v_mov_b32 v207, 0
  v_mov_b32 v208, 0
  v_mov_b32 v209, 0
  v_mov_b32 v210, 0
  v_mov_b32 v211, 0
  v_mov_b32 v212, 0
  v_mov_b32 v213, 0
  v_mov_b32 v214, 0
  v_mov_b32 v215, 0
  v_mov_b32 v216, 0
  v_mov_b32 v217, 0
  v_mov_b32 v218, 0
  v_mov_b32 v219, 0
  v_mov_b32 v220, 0
  v_mov_b32 v221, 0
  v_mov_b32 v222, 0
  v_mov_b32 v223, 0
  v_mov_b32 v224, 0
  v_mov_b32 v225, 0
  v_mov_b32 v226, 0
  v_mov_b32 v227, 0
  v_mov_b32 v228, 0
  v_mov_b32 v229, 0
  v_mov_b32 v230, 0
  v_mov_b32 v231, 0
  v_mov_b32 v232, 0
  v_mov_b32 v233, 0
  v_mov_b32 v234, 0
  v_mov_b32 v235, 0
  v_mov_b32 v236, 0
  v_mov_b32 v237, 0
  v_mov_b32 v238, 0
  v_mov_b32 v239, 0
  v_mov_b32 v240, 0
  v_mov_b32 v241, 0
  v_mov_b32 v242, 0
  v_mov_b32 v243, 0
  v_mov_b32 v244, 0
  v_mov_b32 v245, 0
  v_mov_b32 v246, 0
  v_mov_b32 v247, 0
  v_mov_b32 v248, 0
  v_mov_b32 v249, 0
  v_mov_b32 v250, 0
  v_mov_b32 v251, 0
  v_mov_b32 v252, 0
  v_mov_b32 v253, 0
  v_mov_b32 v254, 0
  v_mov_b32 v255, 0
  s_mul_i32 s87, s56, 6144
  s_mov_b32 s85, s66
  s_mov_b32 s86, s67
  s_add_u32 m0, s87, 0
  s_nop 0
  buffer_load_dwordx4 v48, s[52:55], s85 offen lds
  s_add_u32 m0, s87, 1024
  s_nop 0
  buffer_load_dwordx4 v49, s[52:55], s85 offen lds
  s_add_u32 m0, s87, 2048
  s_nop 0
  buffer_load_dwordx4 v50, s[52:55], s85 offen lds
  s_add_u32 m0, s87, 3072
  s_nop 0
  buffer_load_dwordx4 v51, s[52:55], s85 offen lds
  s_add_u32 m0, s87, 4096
  s_nop 0
  buffer_load_dwordx4 v52, s[52:55], s85 offen lds
  s_add_u32 m0, s87, 5120
  s_nop 0
  buffer_load_dwordx4 v53, s[52:55], s85 offen lds
  buffer_load_dwordx4 a[0:3], v60, s[48:51], s86 offen offset:0 sc1
  buffer_load_dwordx4 a[4:7], v60, s[48:51], s86 offen offset:1024 sc1
  buffer_load_dwordx4 a[8:11], v60, s[48:51], s86 offen offset:2048 sc1
  buffer_load_dwordx4 a[12:15], v60, s[48:51], s86 offen offset:3072 sc1
  s_lshl_b32 s57, s65, 6
  s_add_u32 s66, s66, s57
  s_add_u32 s67, s67, 4096
  s_mov_b32 s85, s66
  s_mov_b32 s86, s67
  s_add_u32 m0, s87, 24576
  s_nop 0
  buffer_load_dwordx4 v48, s[52:55], s85 offen lds
  s_add_u32 m0, s87, 25600
  s_nop 0
  buffer_load_dwordx4 v49, s[52:55], s85 offen lds
  s_add_u32 m0, s87, 26624
  s_nop 0
  buffer_load_dwordx4 v50, s[52:55], s85 offen lds
  s_add_u32 m0, s87, 27648
  s_nop 0
  buffer_load_dwordx4 v51, s[52:55], s85 offen lds
  s_add_u32 m0, s87, 28672
  s_nop 0
  buffer_load_dwordx4 v52, s[52:55], s85 offen lds
  s_add_u32 m0, s87, 29696
  s_nop 0
  buffer_load_dwordx4 v53, s[52:55], s85 offen lds
  buffer_load_dwordx4 a[16:19], v60, s[48:51], s86 offen offset:0 sc1
  buffer_load_dwordx4 a[20:23], v60, s[48:51], s86 offen offset:1024 sc1
  buffer_load_dwordx4 a[24:27], v60, s[48:51], s86 offen offset:2048 sc1
  buffer_load_dwordx4 a[28:31], v60, s[48:51], s86 offen offset:3072 sc1
  s_lshl_b32 s57, s65, 6
  s_add_u32 s66, s66, s57
  s_add_u32 s67, s67, 4096
  s_mov_b32 s85, s66
  s_mov_b32 s86, s67
  s_add_u32 m0, s87, 49152
  s_nop 0
  buffer_load_dwordx4 v48, s[52:55], s85 offen lds
  s_add_u32 m0, s87, 50176
  s_nop 0
  buffer_load_dwordx4 v49, s[52:55], s85 offen lds
  s_add_u32 m0, s87, 51200
  s_nop 0
  buffer_load_dwordx4 v50, s[52:55], s85 offen lds
  s_add_u32 m0, s87, 52224
  s_nop 0
  buffer_load_dwordx4 v51, s[52:55], s85 offen lds
  s_add_u32 m0, s87, 53248
  s_nop 0
  buffer_load_dwordx4 v52, s[52:55], s85 offen lds
  s_add_u32 m0, s87, 54272
  s_nop 0
  buffer_load_dwordx4 v53, s[52:55], s85 offen lds
  buffer_load_dwordx4 a[32:35], v60, s[48:51], s86 offen offset:0 sc1
  buffer_load_dwordx4 a[36:39], v60, s[48:51], s86 offen offset:1024 sc1
  buffer_load_dwordx4 a[40:43], v60, s[48:51], s86 offen offset:2048 sc1
  buffer_load_dwordx4 a[44:47], v60, s[48:51], s86 offen offset:3072 sc1
  s_lshl_b32 s57, s65, 6
  s_add_u32 s66, s66, s57
  s_add_u32 s67, s67, 4096
  s_waitcnt vmcnt(20)
  s_barrier
  v_add_u32 v16, 0, v32
  v_add_u32 v17, 0, v33
  v_add_u32 v18, 0, v34
  v_add_u32 v19, 0, v35
  v_add_u32 v20, 0, v36
  v_add_u32 v21, 0, v37
  v_add_u32 v22, 0, v38
  v_add_u32 v23, 0, v39
  ds_read_b64_tr_b16 v[64:65], v16 offset:0
  ds_read_b64_tr_b16 v[66:67], v20 offset:0
  ds_read_b64_tr_b16 v[68:69], v17 offset:0
  ds_read_b64_tr_b16 v[70:71], v21 offset:0
  ds_read_b64_tr_b16 v[72:73], v18 offset:0
  ds_read_b64_tr_b16 v[74:75], v22 offset:0
  ds_read_b64_tr_b16 v[76:77], v19 offset:0
  ds_read_b64_tr_b16 v[78:79], v23 offset:0
  ds_read_b64_tr_b16 v[80:81], v16 offset:128
  ds_read_b64_tr_b16 v[82:83], v20 offset:128
  ds_read_b64_tr_b16 v[84:85], v17 offset:128
  ds_read_b64_tr_b16 v[86:87], v21 offset:128
  ds_read_b64_tr_b16 v[88:89], v18 offset:128
  ds_read_b64_tr_b16 v[90:91], v22 offset:128
  ds_read_b64_tr_b16 v[92:93], v19 offset:128
  ds_read_b64_tr_b16 v[94:95], v23 offset:128
  ds_read_b64_tr_b16 v[96:97], v16 offset:256
  ds_read_b64_tr_b16 v[98:99], v20 offset:256
  ds_read_b64_tr_b16 v[100:101], v17 offset:256
  ds_read_b64_tr_b16 v[102:103], v21 offset:256
  ds_read_b64_tr_b16 v[104:105], v18 offset:256
  ds_read_b64_tr_b16 v[106:107], v22 offset:256
  ds_read_b64_tr_b16 v[108:109], v19 offset:256
  ds_read_b64_tr_b16 v[110:111], v23 offset:256
  s_waitcnt lgkmcnt(0)
  s_mov_b32 s70, 0
mai_g1loopa:
  s_add_u32 s58, s70, 3
  s_cmp_lt_u32 s58, s69
  s_cselect_b32 s85, s66, 1073741824
  s_cselect_b32 s86, s67, 1073741824
  s_lshl_b32 s57, s65, 6
  s_add_u32 s66, s66, s57
  s_add_u32 s67, s67, 4096
  s_waitcnt vmcnt(10)
  s_barrier
  v_mfma_f32_16x16x32_bf16 v[160:163], v[64:67], a[0:3], v[160:163]
  ds_read_b64_tr_b16 v[112:113], v16 offset:12288
  ds_read_b64_tr_b16 v[114:115], v20 offset:12288
  v_mfma_f32_16x16x32_bf16 v[164:167], v[64:67], a[4:7], v[164:167]
  ds_read_b64_tr_b16 v[116:117], v17 offset:12288
  ds_read_b64_tr_b16 v[118:119], v21 offset:12288
  v_mfma_f32_16x16x32_bf16 v[168:171], v[68:71], a[0:3], v[168:171]
  ds_read_b64_tr_b16 v[120:121], v18 offset:12288
  ds_read_b64_tr_b16 v[122:123], v22 offset:12288
  v_mfma_f32_16x16x32_bf16 v[172:175], v[68:71], a[4:7], v[172:175]
  ds_read_b64_tr_b16 v[124:125], v19 offset:12288
  ds_read_b64_tr_b16 v[126:127], v23 offset:12288
  v_mfma_f32_16x16x32_bf16 v[176:179], v[72:75], a[0:3], v[176:179]
  ds_read_b64_tr_b16 v[128:129], v16 offset:12416
  ds_read_b64_tr_b16 v[130:131], v20 offset:12416
  v_mfma_f32_16x16x32_bf16 v[180:183], v[72:75], a[4:7], v[180:183]
  ds_read_b64_tr_b16 v[132:133], v17 offset:12416
  ds_read_b64_tr_b16 v[134:135], v21 offset:12416
  v_mfma_f32_16x16x32_bf16 v[184:187], v[76:79], a[0:3], v[184:187]
  ds_read_b64_tr_b16 v[136:137], v18 offset:12416
  ds_read_b64_tr_b16 v[138:139], v22 offset:12416
  v_mfma_f32_16x16x32_bf16 v[188:191], v[76:79], a[4:7], v[188:191]
  ds_read_b64_tr_b16 v[140:141], v19 offset:12416
  ds_read_b64_tr_b16 v[142:143], v23 offset:12416
  v_mfma_f32_16x16x32_bf16 v[192:195], v[80:83], a[0:3], v[192:195]
  ds_read_b64_tr_b16 v[144:145], v16 offset:12544
  ds_read_b64_tr_b16 v[146:147], v20 offset:12544
  v_mfma_f32_16x16x32_bf16 v[196:199], v[80:83], a[4:7], v[196:199]
  ds_read_b64_tr_b16 v[148:149], v17 offset:12544
  ds_read_b64_tr_b16 v[150:151], v21 offset:12544
  v_mfma_f32_16x16x32_bf16 v[200:203], v[84:87], a[0:3], v[200:203]
  ds_read_b64_tr_b16 v[152:153], v18 offset:12544
  ds_read_b64_tr_b16 v[154:155], v22 offset:12544
  v_mfma_f32_16x16x32_bf16 v[204:207], v[84:87], a[4:7], v[204:207]
  ds_read_b64_tr_b16 v[156:157], v19 offset:12544
  ds_read_b64_tr_b16 v[158:159], v23 offset:12544
  v_mfma_f32_16x16x32_bf16 v[208:211], v[88:91], a[0:3], v[208:211]
  s_add_u32 m0, s87, 73728
  v_mfma_f32_16x16x32_bf16 v[212:215], v[88:91], a[4:7], v[212:215]
  buffer_load_dwordx4 v48, s[52:55], s85 offen lds
  v_mfma_f32_16x16x32_bf16 v[216:219], v[92:95], a[0:3], v[216:219]
  s_add_u32 m0, s87, 74752
  v_mfma_f32_16x16x32_bf16 v[220:223], v[92:95], a[4:7], v[220:223]
  buffer_load_dwordx4 v49, s[52:55], s85 offen lds
  v_mfma_f32_16x16x32_bf16 v[224:227], v[96:99], a[0:3], v[224:227]
  s_add_u32 m0, s87, 75776
  v_mfma_f32_16x16x32_bf16 v[228:231], v[96:99], a[4:7], v[228:231]
  buffer_load_dwordx4 v50, s[52:55], s85 offen lds
  v_mfma_f32_16x16x32_bf16 v[232:235], v[100:103], a[0:3], v[232:235]
  s_add_u32 m0, s87, 76800
  v_mfma_f32_16x16x32_bf16 v[236:239], v[100:103], a[4:7], v[236:239]
  buffer_load_dwordx4 v51, s[52:55], s85 offen lds
  v_add_u32 v16, 24576, v32
  v_add_u32 v17, 24576, v33
  v_mfma_f32_16x16x32_bf16 v[240:243], v[104:107], a[0:3], v[240:243]
  v_add_u32 v18, 24576, v34
  v_add_u32 v19, 24576, v35
  v_mfma_f32_16x16x32_bf16 v[244:247], v[104:107], a[4:7], v[244:247]
  v_add_u32 v20, 24576, v36
  v_add_u32 v21, 24576, v37
  v_mfma_f32_16x16x32_bf16 v[248:251], v[108:111], a[0:3], v[248:251]
  v_add_u32 v22, 24576, v38
  v_add_u32 v23, 24576, v39
  v_mfma_f32_16x16x32_bf16 v[252:255], v[108:111], a[4:7], v[252:255]
  s_waitcnt lgkmcnt(0)
  v_mfma_f32_16x16x32_bf16 v[160:163], v[112:115], a[8:11], v[160:163]
  ds_read_b64_tr_b16 v[64:65], v16 offset:0
  ds_read_b64_tr_b16 v[66:67], v20 offset:0
  v_mfma_f32_16x16x32_bf16 v[164:167], v[112:115], a[12:15], v[164:167]
  ds_read_b64_tr_b16 v[68:69], v17 offset:0
  ds_read_b64_tr_b16 v[70:71], v21 offset:0
  v_mfma_f32_16x16x32_bf16 v[168:171], v[116:119], a[8:11], v[168:171]
  ds_read_b64_tr_b16 v[72:73], v18 offset:0
  ds_read_b64_tr_b16 v[74:75], v22 offset:0
  v_mfma_f32_16x16x32_bf16 v[172:175], v[116:119], a[12:15], v[172:175]
  ds_read_b64_tr_b16 v[76:77], v19 offset:0
  ds_read_b64_tr_b16 v[78:79], v23 offset:0
  v_mfma_f32_16x16x32_bf16 v[176:179], v[120:123], a[8:11], v[176:179]
  ds_read_b64_tr_b16 v[80:81], v16 offset:128
  ds_read_b64_tr_b16 v[82:83], v20 offset:128
  v_mfma_f32_16x16x32_bf16 v[180:183], v[120:123], a[12:15], v[180:183]
  ds_read_b64_tr_b16 v[84:85], v17 offset:128
  ds_read_b64_tr_b16 v[86:87], v21 offset:128
  v_mfma_f32_16x16x32_bf16 v[184:187], v[124:127], a[8:11], v[184:187]
  ds_read_b64_tr_b16 v[88:89], v18 offset:128
  ds_read_b64_tr_b16 v[90:91], v22 offset:128
  v_mfma_f32_16x16x32_bf16 v[188:191], v[124:127], a[12:15], v[188:191]
  ds_read_b64_tr_b16 v[92:93], v19 offset:128
  ds_read_b64_tr_b16 v[94:95], v23 offset:128
  v_mfma_f32_16x16x32_bf16 v[192:195], v[128:131], a[8:11], v[192:195]
  ds_read_b64_tr_b16 v[96:97], v16 offset:256
  ds_read_b64_tr_b16 v[98:99], v20 offset:256
  v_mfma_f32_16x16x32_bf16 v[196:199], v[128:131], a[12:15], v[196:199]
  ds_read_b64_tr_b16 v[100:101], v17 offset:256
  ds_read_b64_tr_b16 v[102:103], v21 offset:256
  v_mfma_f32_16x16x32_bf16 v[200:203], v[132:135], a[8:11], v[200:203]
  ds_read_b64_tr_b16 v[104:105], v18 offset:256
  ds_read_b64_tr_b16 v[106:107], v22 offset:256
  v_mfma_f32_16x16x32_bf16 v[204:207], v[132:135], a[12:15], v[204:207]
  ds_read_b64_tr_b16 v[108:109], v19 offset:256
  ds_read_b64_tr_b16 v[110:111], v23 offset:256
  v_mfma_f32_16x16x32_bf16 v[208:211], v[136:139], a[8:11], v[208:211]
  s_add_u32 m0, s87, 77824
  v_mfma_f32_16x16x32_bf16 v[212:215], v[136:139], a[12:15], v[212:215]
  buffer_load_dwordx4 v52, s[52:55], s85 offen lds
  v_mfma_f32_16x16x32_bf16 v[216:219], v[140:143], a[8:11], v[216:219]
  s_add_u32 m0, s87, 78848
  v_mfma_f32_16x16x32_bf16 v[220:223], v[140:143], a[12:15], v[220:223]
  buffer_load_dwordx4 v53, s[52:55], s85 offen lds
  v_mfma_f32_16x16x32_bf16 v[224:227], v[144:147], a[8:11], v[224:227]
  buffer_load_dwordx4 a[48:51], v60, s[48:51], s86 offen offset:0 sc1
  v_mfma_f32_16x16x32_bf16 v[228:231], v[144:147], a[12:15], v[228:231]
  buffer_load_dwordx4 a[52:55], v60, s[48:51], s86 offen offset:1024 sc1
  v_mfma_f32_16x16x32_bf16 v[232:235], v[148:151], a[8:11], v[232:235]
  buffer_load_dwordx4 a[56:59], v60, s[48:51], s86 offen offset:2048 sc1
  v_mfma_f32_16x16x32_bf16 v[236:239], v[148:151], a[12:15], v[236:239]
  buffer_load_dwordx4 a[60:63], v60, s[48:51], s86 offen offset:3072 sc1
  v_mfma_f32_16x16x32_bf16 v[240:243], v[152:155], a[8:11], v[240:243]
  v_mfma_f32_16x16x32_bf16 v[244:247], v[152:155], a[12:15], v[244:247]
  v_mfma_f32_16x16x32_bf16 v[248:251], v[156:159], a[8:11], v[248:251]
  v_mfma_f32_16x16x32_bf16 v[252:255], v[156:159], a[12:15], v[252:255]
  s_waitcnt lgkmcnt(0)
  s_add_u32 s70, s70, 1
  s_cmp_ge_u32 s70, s69
  s_cbranch_scc1 mai_g1enda
  s_add_u32 s58, s70, 3
  s_cmp_lt_u32 s58, s69
  s_cselect_b32 s85, s66, 1073741824
  s_cselect_b32 s86, s67, 1073741824
  s_lshl_b32 s57, s65, 6
  s_add_u32 s66, s66, s57
  s_add_u32 s67, s67, 4096
  s_waitcnt vmcnt(10)
  s_barrier
  v_mfma_f32_16x16x32_bf16 v[160:163], v[64:67], a[16:19], v[160:163]
  ds_read_b64_tr_b16 v[112:113], v16 offset:12288
  ds_read_b64_tr_b16 v[114:115], v20 offset:12288
  v_mfma_f32_16x16x32_bf16 v[164:167], v[64:67], a[20:23], v[164:167]
  ds_read_b64_tr_b16 v[116:117], v17 offset:12288
  ds_read_b64_tr_b16 v[118:119], v21 offset:12288
  v_mfma_f32_16x16x32_bf16 v[168:171], v[68:71], a[16:19], v[168:171]
  ds_read_b64_tr_b16 v[120:121], v18 offset:12288
  ds_read_b64_tr_b16 v[122:123], v22 offset:12288
  v_mfma_f32_16x16x32_bf16 v[172:175], v[68:71], a[20:23], v[172:175]
  ds_read_b64_tr_b16 v[124:125], v19 offset:12288
  ds_read_b64_tr_b16 v[126:127], v23 offset:12288
  v_mfma_f32_16x16x32_bf16 v[176:179], v[72:75], a[16:19], v[176:179]
  ds_read_b64_tr_b16 v[128:129], v16 offset:12416
  ds_read_b64_tr_b16 v[130:131], v20 offset:12416
  v_mfma_f32_16x16x32_bf16 v[180:183], v[72:75], a[20:23], v[180:183]
  ds_read_b64_tr_b16 v[132:133], v17 offset:12416
  ds_read_b64_tr_b16 v[134:135], v21 offset:12416
  v_mfma_f32_16x16x32_bf16 v[184:187], v[76:79], a[16:19], v[184:187]
  ds_read_b64_tr_b16 v[136:137], v18 offset:12416
  ds_read_b64_tr_b16 v[138:139], v22 offset:12416
  v_mfma_f32_16x16x32_bf16 v[188:191], v[76:79], a[20:23], v[188:191]
  ds_read_b64_tr_b16 v[140:141], v19 offset:12416
  ds_read_b64_tr_b16 v[142:143], v23 offset:12416
  v_mfma_f32_16x16x32_bf16 v[192:195], v[80:83], a[16:19], v[192:195]
  ds_read_b64_tr_b16 v[144:145], v16 offset:12544
  ds_read_b64_tr_b16 v[146:147], v20 offset:12544
  v_mfma_f32_16x16x32_bf16 v[196:199], v[80:83], a[20:23], v[196:199]
  ds_read_b64_tr_b16 v[148:149], v17 offset:12544
  ds_read_b64_tr_b16 v[150:151], v21 offset:12544
  v_mfma_f32_16x16x32_bf16 v[200:203], v[84:87], a[16:19], v[200:203]
  ds_read_b64_tr_b16 v[152:153], v18 offset:12544
  ds_read_b64_tr_b16 v[154:155], v22 offset:12544
  v_mfma_f32_16x16x32_bf16 v[204:207], v[84:87], a[20:23], v[204:207]
  ds_read_b64_tr_b16 v[156:157], v19 offset:12544
  ds_read_b64_tr_b16 v[158:159], v23 offset:12544
  v_mfma_f32_16x16x32_bf16 v[208:211], v[88:91], a[16:19], v[208:211]
  s_add_u32 m0, s87, 0
  v_mfma_f32_16x16x32_bf16 v[212:215], v[88:91], a[20:23], v[212:215]
  buffer_load_dwordx4 v48, s[52:55], s85 offen lds
  v_mfma_f32_16x16x32_bf16 v[216:219], v[92:95], a[16:19], v[216:219]
  s_add_u32 m0, s87, 1024
  v_mfma_f32_16x16x32_bf16 v[220:223], v[92:95], a[20:23], v[220:223]
  buffer_load_dwordx4 v49, s[52:55], s85 offen lds
  v_mfma_f32_16x16x32_bf16 v[224:227], v[96:99], a[16:19], v[224:227]
  s_add_u32 m0, s87, 2048
  v_mfma_f32_16x16x32_bf16 v[228:231], v[96:99], a[20:23], v[228:231]
  buffer_load_dwordx4 v50, s[52:55], s85 offen lds
  v_mfma_f32_16x16x32_bf16 v[232:235], v[100:103], a[16:19], v[232:235]
  s_add_u32 m0, s87, 3072
  v_mfma_f32_16x16x32_bf16 v[236:239], v[100:103], a[20:23], v[236:239]
  buffer_load_dwordx4 v51, s[52:55], s85 offen lds
  v_add_u32 v16, 49152, v32
  v_add_u32 v17, 49152, v33
  v_mfma_f32_16x16x32_bf16 v[240:243], v[104:107], a[16:19], v[240:243]
  v_add_u32 v18, 49152, v34
  v_add_u32 v19, 49152, v35
  v_mfma_f32_16x16x32_bf16 v[244:247], v[104:107], a[20:23], v[244:247]
  v_add_u32 v20, 49152, v36
  v_add_u32 v21, 49152, v37
  v_mfma_f32_16x16x32_bf16 v[248:251], v[108:111], a[16:19], v[248:251]
  v_add_u32 v22, 49152, v38
  v_add_u32 v23, 49152, v39
  v_mfma_f32_16x16x32_bf16 v[252:255], v[108:111], a[20:23], v[252:255]
  s_waitcnt lgkmcnt(0)
  v_mfma_f32_16x16x32_bf16 v[160:163], v[112:115], a[24:27], v[160:163]
  ds_read_b64_tr_b16 v[64:65], v16 offset:0
  ds_read_b64_tr_b16 v[66:67], v20 offset:0
  v_mfma_f32_16x16x32_bf16 v[164:167], v[112:115], a[28:31], v[164:167]
  ds_read_b64_tr_b16 v[68:69], v17 offset:0
  ds_read_b64_tr_b16 v[70:71], v21 offset:0
  v_mfma_f32_16x16x32_bf16 v[168:171], v[116:119], a[24:27], v[168:171]
  ds_read_b64_tr_b16 v[72:73], v18 offset:0
  ds_read_b64_tr_b16 v[74:75], v22 offset:0
  v_mfma_f32_16x16x32_bf16 v[172:175], v[116:119], a[28:31], v[172:175]
  ds_read_b64_tr_b16 v[76:77], v19 offset:0
  ds_read_b64_tr_b16 v[78:79], v23 offset:0
  v_mfma_f32_16x16x32_bf16 v[176:179], v[120:123], a[24:27], v[176:179]
  ds_read_b64_tr_b16 v[80:81], v16 offset:128
  ds_read_b64_tr_b16 v[82:83], v20 offset:128
  v_mfma_f32_16x16x32_bf16 v[180:183], v[120:123], a[28:31], v[180:183]
  ds_read_b64_tr_b16 v[84:85], v17 offset:128
  ds_read_b64_tr_b16 v[86:87], v21 offset:128
  v_mfma_f32_16x16x32_bf16 v[184:187], v[124:127], a[24:27], v[184:187]
  ds_read_b64_tr_b16 v[88:89], v18 offset:128
  ds_read_b64_tr_b16 v[90:91], v22 offset:128
  v_mfma_f32_16x16x32_bf16 v[188:191], v[124:127], a[28:31], v[188:191]
  ds_read_b64_tr_b16 v[92:93], v19 offset:128
  ds_read_b64_tr_b16 v[94:95], v23 offset:128
  v_mfma_f32_16x16x32_bf16 v[192:195], v[128:131], a[24:27], v[192:195]
  ds_read_b64_tr_b16 v[96:97], v16 offset:256
  ds_read_b64_tr_b16 v[98:99], v20 offset:256
  v_mfma_f32_16x16x32_bf16 v[196:199], v[128:131], a[28:31], v[196:199]
  ds_read_b64_tr_b16 v[100:101], v17 offset:256
  ds_read_b64_tr_b16 v[102:103], v21 offset:256
  v_mfma_f32_16x16x32_bf16 v[200:203], v[132:135], a[24:27], v[200:203]
  ds_read_b64_tr_b16 v[104:105], v18 offset:256
  ds_read_b64_tr_b16 v[106:107], v22 offset:256
  v_mfma_f32_16x16x32_bf16 v[204:207], v[132:135], a[28:31], v[204:207]
  ds_read_b64_tr_b16 v[108:109], v19 offset:256
  ds_read_b64_tr_b16 v[110:111], v23 offset:256
  v_mfma_f32_16x16x32_bf16 v[208:211], v[136:139], a[24:27], v[208:211]
  s_add_u32 m0, s87, 4096
  v_mfma_f32_16x16x32_bf16 v[212:215], v[136:139], a[28:31], v[212:215]
  buffer_load_dwordx4 v52, s[52:55], s85 offen lds
  v_mfma_f32_16x16x32_bf16 v[216:219], v[140:143], a[24:27], v[216:219]
  s_add_u32 m0, s87, 5120
  v_mfma_f32_16x16x32_bf16 v[220:223], v[140:143], a[28:31], v[220:223]
  buffer_load_dwordx4 v53, s[52:55], s85 offen lds
  v_mfma_f32_16x16x32_bf16 v[224:227], v[144:147], a[24:27], v[224:227]
  buffer_load_dwordx4 a[0:3], v60, s[48:51], s86 offen offset:0 sc1
  v_mfma_f32_16x16x32_bf16 v[228:231], v[144:147], a[28:31], v[228:231]
  buffer_load_dwordx4 a[4:7], v60, s[48:51], s86 offen offset:1024 sc1
  v_mfma_f32_16x16x32_bf16 v[232:235], v[148:151], a[24:27], v[232:235]
  buffer_load_dwordx4 a[8:11], v60, s[48:51], s86 offen offset:2048 sc1
  v_mfma_f32_16x16x32_bf16 v[236:239], v[148:151], a[28:31], v[236:239]
  buffer_load_dwordx4 a[12:15], v60, s[48:51], s86 offen offset:3072 sc1
  v_mfma_f32_16x16x32_bf16 v[240:243], v[152:155], a[24:27], v[240:243]
  v_mfma_f32_16x16x32_bf16 v[244:247], v[152:155], a[28:31], v[244:247]
  v_mfma_f32_16x16x32_bf16 v[248:251], v[156:159], a[24:27], v[248:251]
  v_mfma_f32_16x16x32_bf16 v[252:255], v[156:159], a[28:31], v[252:255]
  s_waitcnt lgkmcnt(0)
  s_add_u32 s70, s70, 1
  s_cmp_ge_u32 s70, s69
  s_cbranch_scc1 mai_g1enda
  s_add_u32 s58, s70, 3
  s_cmp_lt_u32 s58, s69
  s_cselect_b32 s85, s66, 1073741824
  s_cselect_b32 s86, s67, 1073741824
  s_lshl_b32 s57, s65, 6
  s_add_u32 s66, s66, s57
  s_add_u32 s67, s67, 4096
  s_waitcnt vmcnt(10)
  s_barrier
  v_mfma_f32_16x16x32_bf16 v[160:163], v[64:67], a[32:35], v[160:163]
  ds_read_b64_tr_b16 v[112:113], v16 offset:12288
  ds_read_b64_tr_b16 v[114:115], v20 offset:12288
  v_mfma_f32_16x16x32_bf16 v[164:167], v[64:67], a[36:39], v[164:167]
  ds_read_b64_tr_b16 v[116:117], v17 offset:12288
  ds_read_b64_tr_b16 v[118:119], v21 offset:12288
  v_mfma_f32_16x16x32_bf16 v[168:171], v[68:71], a[32:35], v[168:171]
  ds_read_b64_tr_b16 v[120:121], v18 offset:12288
  ds_read_b64_tr_b16 v[122:123], v22 offset:12288
  v_mfma_f32_16x16x32_bf16 v[172:175], v[68:71], a[36:39], v[172:175]
  ds_read_b64_tr_b16 v[124:125], v19 offset:12288
  ds_read_b64_tr_b16 v[126:127], v23 offset:12288
  v_mfma_f32_16x16x32_bf16 v[176:179], v[72:75], a[32:35], v[176:179]
  ds_read_b64_tr_b16 v[128:129], v16 offset:12416
  ds_read_b64_tr_b16 v[130:131], v20 offset:12416
  v_mfma_f32_16x16x32_bf16 v[180:183], v[72:75], a[36:39], v[180:183]
  ds_read_b64_tr_b16 v[132:133], v17 offset:12416
  ds_read_b64_tr_b16 v[134:135], v21 offset:12416
  v_mfma_f32_16x16x32_bf16 v[184:187], v[76:79], a[32:35], v[184:187]
  ds_read_b64_tr_b16 v[136:137], v18 offset:12416
  ds_read_b64_tr_b16 v[138:139], v22 offset:12416
  v_mfma_f32_16x16x32_bf16 v[188:191], v[76:79], a[36:39], v[188:191]
  ds_read_b64_tr_b16 v[140:141], v19 offset:12416
  ds_read_b64_tr_b16 v[142:143], v23 offset:12416
  v_mfma_f32_16x16x32_bf16 v[192:195], v[80:83], a[32:35], v[192:195]
  ds_read_b64_tr_b16 v[144:145], v16 offset:12544
  ds_read_b64_tr_b16 v[146:147], v20 offset:12544
  v_mfma_f32_16x16x32_bf16 v[196:199], v[80:83], a[36:39], v[196:199]
  ds_read_b64_tr_b16 v[148:149], v17 offset:12544
  ds_read_b64_tr_b16 v[150:151], v21 offset:12544
  v_mfma_f32_16x16x32_bf16 v[200:203], v[84:87], a[32:35], v[200:203]
  ds_read_b64_tr_b16 v[152:153], v18 offset:12544
  ds_read_b64_tr_b16 v[154:155], v22 offset:12544
  v_mfma_f32_16x16x32_bf16 v[204:207], v[84:87], a[36:39], v[204:207]
  ds_read_b64_tr_b16 v[156:157], v19 offset:12544
  ds_read_b64_tr_b16 v[158:159], v23 offset:12544
  v_mfma_f32_16x16x32_bf16 v[208:211], v[88:91], a[32:35], v[208:211]
  s_add_u32 m0, s87, 24576
  v_mfma_f32_16x16x32_bf16 v[212:215], v[88:91], a[36:39], v[212:215]
  buffer_load_dwordx4 v48, s[52:55], s85 offen lds
  v_mfma_f32_16x16x32_bf16 v[216:219], v[92:95], a[32:35], v[216:219]
  s_add_u32 m0, s87, 25600
  v_mfma_f32_16x16x32_bf16 v[220:223], v[92:95], a[36:39], v[220:223]
  buffer_load_dwordx4 v49, s[52:55], s85 offen lds
  v_mfma_f32_16x16x32_bf16 v[224:227], v[96:99], a[32:35], v[224:227]
  s_add_u32 m0, s87, 26624
  v_mfma_f32_16x16x32_bf16 v[228:231], v[96:99], a[36:39], v[228:231]
  buffer_load_dwordx4 v50, s[52:55], s85 offen lds
  v_mfma_f32_16x16x32_bf16 v[232:235], v[100:103], a[32:35], v[232:235]
  s_add_u32 m0, s87, 27648
  v_mfma_f32_16x16x32_bf16 v[236:239], v[100:103], a[36:39], v[236:239]
  buffer_load_dwordx4 v51, s[52:55], s85 offen lds
  v_add_u32 v16, 73728, v32
  v_add_u32 v17, 73728, v33
  v_mfma_f32_16x16x32_bf16 v[240:243], v[104:107], a[32:35], v[240:243]
  v_add_u32 v18, 73728, v34
  v_add_u32 v19, 73728, v35
  v_mfma_f32_16x16x32_bf16 v[244:247], v[104:107], a[36:39], v[244:247]
  v_add_u32 v20, 73728, v36
  v_add_u32 v21, 73728, v37
  v_mfma_f32_16x16x32_bf16 v[248:251], v[108:111], a[32:35], v[248:251]
  v_add_u32 v22, 73728, v38
  v_add_u32 v23, 73728, v39
  v_mfma_f32_16x16x32_bf16 v[252:255], v[108:111], a[36:39], v[252:255]
  s_waitcnt lgkmcnt(0)
  v_mfma_f32_16x16x32_bf16 v[160:163], v[112:115], a[40:43], v[160:163]
  ds_read_b64_tr_b16 v[64:65], v16 offset:0
  ds_read_b64_tr_b16 v[66:67], v20 offset:0
  v_mfma_f32_16x16x32_bf16 v[164:167], v[112:115], a[44:47], v[164:167]
  ds_read_b64_tr_b16 v[68:69], v17 offset:0
  ds_read_b64_tr_b16 v[70:71], v21 offset:0
  v_mfma_f32_16x16x32_bf16 v[168:171], v[116:119], a[40:43], v[168:171]
  ds_read_b64_tr_b16 v[72:73], v18 offset:0
  ds_read_b64_tr_b16 v[74:75], v22 offset:0
  v_mfma_f32_16x16x32_bf16 v[172:175], v[116:119], a[44:47], v[172:175]
  ds_read_b64_tr_b16 v[76:77], v19 offset:0
  ds_read_b64_tr_b16 v[78:79], v23 offset:0
  v_mfma_f32_16x16x32_bf16 v[176:179], v[120:123], a[40:43], v[176:179]
  ds_read_b64_tr_b16 v[80:81], v16 offset:128
  ds_read_b64_tr_b16 v[82:83], v20 offset:128
  v_mfma_f32_16x16x32_bf16 v[180:183], v[120:123], a[44:47], v[180:183]
  ds_read_b64_tr_b16 v[84:85], v17 offset:128
  ds_read_b64_tr_b16 v[86:87], v21 offset:128
  v_mfma_f32_16x16x32_bf16 v[184:187], v[124:127], a[40:43], v[184:187]
  ds_read_b64_tr_b16 v[88:89], v18 offset:128
  ds_read_b64_tr_b16 v[90:91], v22 offset:128
  v_mfma_f32_16x16x32_bf16 v[188:191], v[124:127], a[44:47], v[188:191]
  ds_read_b64_tr_b16 v[92:93], v19 offset:128
  ds_read_b64_tr_b16 v[94:95], v23 offset:128
  v_mfma_f32_16x16x32_bf16 v[192:195], v[128:131], a[40:43], v[192:195]
  ds_read_b64_tr_b16 v[96:97], v16 offset:256
  ds_read_b64_tr_b16 v[98:99], v20 offset:256
  v_mfma_f32_16x16x32_bf16 v[196:199], v[128:131], a[44:47], v[196:199]
  ds_read_b64_tr_b16 v[100:101], v17 offset:256
  ds_read_b64_tr_b16 v[102:103], v21 offset:256
  v_mfma_f32_16x16x32_bf16 v[200:203], v[132:135], a[40:43], v[200:203]
  ds_read_b64_tr_b16 v[104:105], v18 offset:256
  ds_read_b64_tr_b16 v[106:107], v22 offset:256
  v_mfma_f32_16x16x32_bf16 v[204:207], v[132:135], a[44:47], v[204:207]
  ds_read_b64_tr_b16 v[108:109], v19 offset:256
  ds_read_b64_tr_b16 v[110:111], v23 offset:256
  v_mfma_f32_16x16x32_bf16 v[208:211], v[136:139], a[40:43], v[208:211]
  s_add_u32 m0, s87, 28672
  v_mfma_f32_16x16x32_bf16 v[212:215], v[136:139], a[44:47], v[212:215]
  buffer_load_dwordx4 v52, s[52:55], s85 offen lds
  v_mfma_f32_16x16x32_bf16 v[216:219], v[140:143], a[40:43], v[216:219]
  s_add_u32 m0, s87, 29696
  v_mfma_f32_16x16x32_bf16 v[220:223], v[140:143], a[44:47], v[220:223]
  buffer_load_dwordx4 v53, s[52:55], s85 offen lds
  v_mfma_f32_16x16x32_bf16 v[224:227], v[144:147], a[40:43], v[224:227]
  buffer_load_dwordx4 a[16:19], v60, s[48:51], s86 offen offset:0 sc1
  v_mfma_f32_16x16x32_bf16 v[228:231], v[144:147], a[44:47], v[228:231]
  buffer_load_dwordx4 a[20:23], v60, s[48:51], s86 offen offset:1024 sc1
  v_mfma_f32_16x16x32_bf16 v[232:235], v[148:151], a[40:43], v[232:235]
  buffer_load_dwordx4 a[24:27], v60, s[48:51], s86 offen offset:2048 sc1
  v_mfma_f32_16x16x32_bf16 v[236:239], v[148:151], a[44:47], v[236:239]
  buffer_load_dwordx4 a[28:31], v60, s[48:51], s86 offen offset:3072 sc1
  v_mfma_f32_16x16x32_bf16 v[240:243], v[152:155], a[40:43], v[240:243]
  v_mfma_f32_16x16x32_bf16 v[244:247], v[152:155], a[44:47], v[244:247]
  v_mfma_f32_16x16x32_bf16 v[248:251], v[156:159], a[40:43], v[248:251]
  v_mfma_f32_16x16x32_bf16 v[252:255], v[156:159], a[44:47], v[252:255]
  s_waitcnt lgkmcnt(0)
  s_add_u32 s70, s70, 1
  s_cmp_ge_u32 s70, s69
  s_cbranch_scc1 mai_g1enda
  s_add_u32 s58, s70, 3
  s_cmp_lt_u32 s58, s69
  s_cselect_b32 s85, s66, 1073741824
  s_cselect_b32 s86, s67, 1073741824
  s_lshl_b32 s57, s65, 6
  s_add_u32 s66, s66, s57
  s_add_u32 s67, s67, 4096
  s_waitcnt vmcnt(10)
  s_barrier
  v_mfma_f32_16x16x32_bf16 v[160:163], v[64:67], a[48:51], v[160:163]
  ds_read_b64_tr_b16 v[112:113], v16 offset:12288
  ds_read_b64_tr_b16 v[114:115], v20 offset:12288
  v_mfma_f32_16x16x32_bf16 v[164:167], v[64:67], a[52:55], v[164:167]
  ds_read_b64_tr_b16 v[116:117], v17 offset:12288
  ds_read_b64_tr_b16 v[118:119], v21 offset:12288
  v_mfma_f32_16x16x32_bf16 v[168:171], v[68:71], a[48:51], v[168:171]
  ds_read_b64_tr_b16 v[120:121], v18 offset:12288
  ds_read_b64_tr_b16 v[122:123], v22 offset:12288
  v_mfma_f32_16x16x32_bf16 v[172:175], v[68:71], a[52:55], v[172:175]
  ds_read_b64_tr_b16 v[124:125], v19 offset:12288
  ds_read_b64_tr_b16 v[126:127], v23 offset:12288
  v_mfma_f32_16x16x32_bf16 v[176:179], v[72:75], a[48:51], v[176:179]
  ds_read_b64_tr_b16 v[128:129], v16 offset:12416
  ds_read_b64_tr_b16 v[130:131], v20 offset:12416
  v_mfma_f32_16x16x32_bf16 v[180:183], v[72:75], a[52:55], v[180:183]
  ds_read_b64_tr_b16 v[132:133], v17 offset:12416
  ds_read_b64_tr_b16 v[134:135], v21 offset:12416
  v_mfma_f32_16x16x32_bf16 v[184:187], v[76:79], a[48:51], v[184:187]
  ds_read_b64_tr_b16 v[136:137], v18 offset:12416
  ds_read_b64_tr_b16 v[138:139], v22 offset:12416
  v_mfma_f32_16x16x32_bf16 v[188:191], v[76:79], a[52:55], v[188:191]
  ds_read_b64_tr_b16 v[140:141], v19 offset:12416
  ds_read_b64_tr_b16 v[142:143], v23 offset:12416
  v_mfma_f32_16x16x32_bf16 v[192:195], v[80:83], a[48:51], v[192:195]
  ds_read_b64_tr_b16 v[144:145], v16 offset:12544
  ds_read_b64_tr_b16 v[146:147], v20 offset:12544
  v_mfma_f32_16x16x32_bf16 v[196:199], v[80:83], a[52:55], v[196:199]
  ds_read_b64_tr_b16 v[148:149], v17 offset:12544
  ds_read_b64_tr_b16 v[150:151], v21 offset:12544
  v_mfma_f32_16x16x32_bf16 v[200:203], v[84:87], a[48:51], v[200:203]
  ds_read_b64_tr_b16 v[152:153], v18 offset:12544
  ds_read_b64_tr_b16 v[154:155], v22 offset:12544
  v_mfma_f32_16x16x32_bf16 v[204:207], v[84:87], a[52:55], v[204:207]
  ds_read_b64_tr_b16 v[156:157], v19 offset:12544
  ds_read_b64_tr_b16 v[158:159], v23 offset:12544
  v_mfma_f32_16x16x32_bf16 v[208:211], v[88:91], a[48:51], v[208:211]
  s_add_u32 m0, s87, 49152
  v_mfma_f32_16x16x32_bf16 v[212:215], v[88:91], a[52:55], v[212:215]
  buffer_load_dwordx4 v48, s[52:55], s85 offen lds
  v_mfma_f32_16x16x32_bf16 v[216:219], v[92:95], a[48:51], v[216:219]
  s_add_u32 m0, s87, 50176
  v_mfma_f32_16x16x32_bf16 v[220:223], v[92:95], a[52:55], v[220:223]
  buffer_load_dwordx4 v49, s[52:55], s85 offen lds
  v_mfma_f32_16x16x32_bf16 v[224:227], v[96:99], a[48:51], v[224:227]
  s_add_u32 m0, s87, 51200
  v_mfma_f32_16x16x32_bf16 v[228:231], v[96:99], a[52:55], v[228:231]
  buffer_load_dwordx4 v50, s[52:55], s85 offen lds
  v_mfma_f32_16x16x32_bf16 v[232:235], v[100:103], a[48:51], v[232:235]
  s_add_u32 m0, s87, 52224
  v_mfma_f32_16x16x32_bf16 v[236:239], v[100:103], a[52:55], v[236:239]
  buffer_load_dwordx4 v51, s[52:55], s85 offen lds
  v_add_u32 v16, 0, v32
  v_add_u32 v17, 0, v33
  v_mfma_f32_16x16x32_bf16 v[240:243], v[104:107], a[48:51], v[240:243]
  v_add_u32 v18, 0, v34
  v_add_u32 v19, 0, v35
  v_mfma_f32_16x16x32_bf16 v[244:247], v[104:107], a[52:55], v[244:247]
  v_add_u32 v20, 0, v36
  v_add_u32 v21, 0, v37
  v_mfma_f32_16x16x32_bf16 v[248:251], v[108:111], a[48:51], v[248:251]
  v_add_u32 v22, 0, v38
  v_add_u32 v23, 0, v39
  v_mfma_f32_16x16x32_bf16 v[252:255], v[108:111], a[52:55], v[252:255]
  s_waitcnt lgkmcnt(0)
  v_mfma_f32_16x16x32_bf16 v[160:163], v[112:115], a[56:59], v[160:163]
  ds_read_b64_tr_b16 v[64:65], v16 offset:0
  ds_read_b64_tr_b16 v[66:67], v20 offset:0
  v_mfma_f32_16x16x32_bf16 v[164:167], v[112:115], a[60:63], v[164:167]
  ds_read_b64_tr_b16 v[68:69], v17 offset:0
  ds_read_b64_tr_b16 v[70:71], v21 offset:0
  v_mfma_f32_16x16x32_bf16 v[168:171], v[116:119], a[56:59], v[168:171]
  ds_read_b64_tr_b16 v[72:73], v18 offset:0
  ds_read_b64_tr_b16 v[74:75], v22 offset:0
  v_mfma_f32_16x16x32_bf16 v[172:175], v[116:119], a[60:63], v[172:175]
  ds_read_b64_tr_b16 v[76:77], v19 offset:0
  ds_read_b64_tr_b16 v[78:79], v23 offset:0
  v_mfma_f32_16x16x32_bf16 v[176:179], v[120:123], a[56:59], v[176:179]
  ds_read_b64_tr_b16 v[80:81], v16 offset:128
  ds_read_b64_tr_b16 v[82:83], v20 offset:128
  v_mfma_f32_16x16x32_bf16 v[180:183], v[120:123], a[60:63], v[180:183]
  ds_read_b64_tr_b16 v[84:85], v17 offset:128
  ds_read_b64_tr_b16 v[86:87], v21 offset:128
  v_mfma_f32_16x16x32_bf16 v[184:187], v[124:127], a[56:59], v[184:187]
  ds_read_b64_tr_b16 v[88:89], v18 offset:128
  ds_read_b64_tr_b16 v[90:91], v22 offset:128
  v_mfma_f32_16x16x32_bf16 v[188:191], v[124:127], a[60:63], v[188:191]
  ds_read_b64_tr_b16 v[92:93], v19 offset:128
  ds_read_b64_tr_b16 v[94:95], v23 offset:128
  v_mfma_f32_16x16x32_bf16 v[192:195], v[128:131], a[56:59], v[192:195]
  ds_read_b64_tr_b16 v[96:97], v16 offset:256
  ds_read_b64_tr_b16 v[98:99], v20 offset:256
  v_mfma_f32_16x16x32_bf16 v[196:199], v[128:131], a[60:63], v[196:199]
  ds_read_b64_tr_b16 v[100:101], v17 offset:256
  ds_read_b64_tr_b16 v[102:103], v21 offset:256
  v_mfma_f32_16x16x32_bf16 v[200:203], v[132:135], a[56:59], v[200:203]
  ds_read_b64_tr_b16 v[104:105], v18 offset:256
  ds_read_b64_tr_b16 v[106:107], v22 offset:256
  v_mfma_f32_16x16x32_bf16 v[204:207], v[132:135], a[60:63], v[204:207]
  ds_read_b64_tr_b16 v[108:109], v19 offset:256
  ds_read_b64_tr_b16 v[110:111], v23 offset:256
  v_mfma_f32_16x16x32_bf16 v[208:211], v[136:139], a[56:59], v[208:211]
  s_add_u32 m0, s87, 53248
  v_mfma_f32_16x16x32_bf16 v[212:215], v[136:139], a[60:63], v[212:215]
  buffer_load_dwordx4 v52, s[52:55], s85 offen lds
  v_mfma_f32_16x16x32_bf16 v[216:219], v[140:143], a[56:59], v[216:219]
  s_add_u32 m0, s87, 54272
  v_mfma_f32_16x16x32_bf16 v[220:223], v[140:143], a[60:63], v[220:223]
  buffer_load_dwordx4 v53, s[52:55], s85 offen lds
  v_mfma_f32_16x16x32_bf16 v[224:227], v[144:147], a[56:59], v[224:227]
  buffer_load_dwordx4 a[32:35], v60, s[48:51], s86 offen offset:0 sc1
  v_mfma_f32_16x16x32_bf16 v[228:231], v[144:147], a[60:63], v[228:231]
  buffer_load_dwordx4 a[36:39], v60, s[48:51], s86 offen offset:1024 sc1
  v_mfma_f32_16x16x32_bf16 v[232:235], v[148:151], a[56:59], v[232:235]
  buffer_load_dwordx4 a[40:43], v60, s[48:51], s86 offen offset:2048 sc1
  v_mfma_f32_16x16x32_bf16 v[236:239], v[148:151], a[60:63], v[236:239]
  buffer_load_dwordx4 a[44:47], v60, s[48:51], s86 offen offset:3072 sc1
  v_mfma_f32_16x16x32_bf16 v[240:243], v[152:155], a[56:59], v[240:243]
  v_mfma_f32_16x16x32_bf16 v[244:247], v[152:155], a[60:63], v[244:247]
  v_mfma_f32_16x16x32_bf16 v[248:251], v[156:159], a[56:59], v[248:251]
  v_mfma_f32_16x16x32_bf16 v[252:255], v[156:159], a[60:63], v[252:255]
  s_waitcnt lgkmcnt(0)
  s_add_u32 s70, s70, 1
  s_cmp_ge_u32 s70, s69
  s_cbranch_scc1 mai_g1enda
  s_branch mai_g1loopa
mai_g1enda:
  s_cmp_eq_u32 s72, 2
  s_cbranch_scc1 mai_w_vz2
  s_cmp_eq_u32 s72, 1
  s_cbranch_scc1 mai_w_epi_ffn1
  s_mul_i32 s57, s89, 393216
  s_mul_i32 s58, s77, 12288
  s_add_u32 s75, s75, s57
  s_add_u32 s75, s75, s58
  v_cvt_pk_bf16_f32 v64, v160, v161
  v_cvt_pk_bf16_f32 v65, v162, v163
  v_cvt_pk_bf16_f32 v66, v168, v169
  v_cvt_pk_bf16_f32 v67, v170, v171
  buffer_store_dwordx4 v[64:67], v60, s[48:51], s75 offen offset:0 sc1
  v_cvt_pk_bf16_f32 v68, v164, v165
  v_cvt_pk_bf16_f32 v69, v166, v167
  v_cvt_pk_bf16_f32 v70, v172, v173
  v_cvt_pk_bf16_f32 v71, v174, v175
  buffer_store_dwordx4 v[68:71], v60, s[48:51], s75 offen offset:1024 sc1
  v_cvt_pk_bf16_f32 v72, v176, v177
  v_cvt_pk_bf16_f32 v73, v178, v179
  v_cvt_pk_bf16_f32 v74, v184, v185
  v_cvt_pk_bf16_f32 v75, v186, v187
  buffer_store_dwordx4 v[72:75], v60, s[48:51], s75 offen offset:2048 sc1
  v_cvt_pk_bf16_f32 v76, v180, v181
  v_cvt_pk_bf16_f32 v77, v182, v183
  v_cvt_pk_bf16_f32 v78, v188, v189
  v_cvt_pk_bf16_f32 v79, v190, v191
  buffer_store_dwordx4 v[76:79], v60, s[48:51], s75 offen offset:3072 sc1
  v_cvt_pk_bf16_f32 v64, v192, v193
  v_cvt_pk_bf16_f32 v65, v194, v195
  v_cvt_pk_bf16_f32 v66, v200, v201
  v_cvt_pk_bf16_f32 v67, v202, v203
  s_add_u32 s75, s75, 4096
  buffer_store_dwordx4 v[64:67], v60, s[48:51], s75 offen offset:0 sc1
  v_cvt_pk_bf16_f32 v68, v196, v197
  v_cvt_pk_bf16_f32 v69, v198, v199
  v_cvt_pk_bf16_f32 v70, v204, v205
  v_cvt_pk_bf16_f32 v71, v206, v207
  buffer_store_dwordx4 v[68:71], v60, s[48:51], s75 offen offset:1024 sc1
  v_cvt_pk_bf16_f32 v72, v208, v209
  v_cvt_pk_bf16_f32 v73, v210, v211
  v_cvt_pk_bf16_f32 v74, v216, v217
  v_cvt_pk_bf16_f32 v75, v218, v219
  buffer_store_dwordx4 v[72:75], v60, s[48:51], s75 offen offset:2048 sc1
  v_cvt_pk_bf16_f32 v76, v212, v213
  v_cvt_pk_bf16_f32 v77, v214, v215
  v_cvt_pk_bf16_f32 v78, v220, v221
  v_cvt_pk_bf16_f32 v79, v222, v223
  buffer_store_dwordx4 v[76:79], v60, s[48:51], s75 offen offset:3072 sc1
  v_cvt_pk_bf16_f32 v64, v224, v225
  v_cvt_pk_bf16_f32 v65, v226, v227
  v_cvt_pk_bf16_f32 v66, v232, v233
  v_cvt_pk_bf16_f32 v67, v234, v235
  s_add_u32 s75, s75, 4096
  buffer_store_dwordx4 v[64:67], v60, s[48:51], s75 offen offset:0 sc1
  v_cvt_pk_bf16_f32 v68, v228, v229
  v_cvt_pk_bf16_f32 v69, v230, v231
  v_cvt_pk_bf16_f32 v70, v236, v237
  v_cvt_pk_bf16_f32 v71, v238, v239
  buffer_store_dwordx4 v[68:71], v60, s[48:51], s75 offen offset:1024 sc1
  v_cvt_pk_bf16_f32 v72, v240, v241
  v_cvt_pk_bf16_f32 v73, v242, v243
  v_cvt_pk_bf16_f32 v74, v248, v249
  v_cvt_pk_bf16_f32 v75, v250, v251
  buffer_store_dwordx4 v[72:75], v60, s[48:51], s75 offen offset:2048 sc1
  v_cvt_pk_bf16_f32 v76, v244, v245
  v_cvt_pk_bf16_f32 v77, v246, v247
  v_cvt_pk_bf16_f32 v78, v252, v253
  v_cvt_pk_bf16_f32 v79, v254, v255
  buffer_store_dwordx4 v[76:79], v60, s[48:51], s75 offen offset:3072 sc1
  s_branch mai_w_signal
mai_w_epi_ffn1:
  v_lshrrev_b32 v5, 4, v1
  v_lshlrev_b32 v5, 3, v5
  s_lshl_b32 s58, s74, 1
  buffer_load_dwordx2 v[128:129], v5, s[32:35], s58 offen offset:0
  buffer_load_dwordx2 v[130:131], v5, s[32:35], s58 offen offset:32
  buffer_load_dwordx2 v[132:133], v5, s[32:35], s58 offen offset:64
  buffer_load_dwordx2 v[134:135], v5, s[32:35], s58 offen offset:96
  buffer_load_dwordx2 v[136:137], v5, s[32:35], s58 offen offset:128
  buffer_load_dwordx2 v[138:139], v5, s[32:35], s58 offen offset:160
  buffer_load_dwordx2 v[140:141], v5, s[32:35], s58 offen offset:192
  buffer_load_dwordx2 v[142:143], v5, s[32:35], s58 offen offset:224
  buffer_load_dwordx2 v[144:145], v5, s[32:35], s58 offen offset:256
  buffer_load_dwordx2 v[146:147], v5, s[32:35], s58 offen offset:288
  buffer_load_dwordx2 v[148:149], v5, s[32:35], s58 offen offset:320
  buffer_load_dwordx2 v[150:151], v5, s[32:35], s58 offen offset:352
  s_waitcnt vmcnt(0)
  v_lshlrev_b32 v80, 16, v128
  v_and_b32 v81, 4294901760, v128
  v_lshlrev_b32 v82, 16, v129
  v_and_b32 v83, 4294901760, v129
  v_lshlrev_b32 v84, 16, v130
  v_and_b32 v85, 4294901760, v130
  v_lshlrev_b32 v86, 16, v131
  v_and_b32 v87, 4294901760, v131
  v_lshlrev_b32 v88, 16, v132
  v_and_b32 v89, 4294901760, v132
  v_lshlrev_b32 v90, 16, v133
  v_and_b32 v91, 4294901760, v133
  v_lshlrev_b32 v92, 16, v134
  v_and_b32 v93, 4294901760, v134
  v_lshlrev_b32 v94, 16, v135
  v_and_b32 v95, 4294901760, v135
  v_lshlrev_b32 v96, 16, v136
  v_and_b32 v97, 4294901760, v136
  v_lshlrev_b32 v98, 16, v137
  v_and_b32 v99, 4294901760, v137
  v_lshlrev_b32 v100, 16, v138
  v_and_b32 v101, 4294901760, v138
  v_lshlrev_b32 v102, 16, v139
  v_and_b32 v103, 4294901760, v139
  v_lshlrev_b32 v104, 16, v140
  v_and_b32 v105, 4294901760, v140
  v_lshlrev_b32 v106, 16, v141
  v_and_b32 v107, 4294901760, v141
  v_lshlrev_b32 v108, 16, v142
  v_and_b32 v109, 4294901760, v142
  v_lshlrev_b32 v110, 16, v143
  v_and_b32 v111, 4294901760, v143
  v_lshlrev_b32 v112, 16, v144
  v_and_b32 v113, 4294901760, v144
  v_lshlrev_b32 v114, 16, v145
  v_and_b32 v115, 4294901760, v145
  v_lshlrev_b32 v116, 16, v146
  v_and_b32 v117, 4294901760, v146
  v_lshlrev_b32 v118, 16, v147
  v_and_b32 v119, 4294901760, v147
  v_lshlrev_b32 v120, 16, v148
  v_and_b32 v121, 4294901760, v148
  v_lshlrev_b32 v122, 16, v149
  v_and_b32 v123, 4294901760, v149
  v_lshlrev_b32 v124, 16, v150
  v_and_b32 v125, 4294901760, v150
  v_lshlrev_b32 v126, 16, v151
  v_and_b32 v127, 4294901760, v151
  s_mov_b32 s78, 1027024659
  s_mov_b32 s79, 3222493025
  s_mul_i32 s57, s89, 98304
  s_mul_i32 s58, s77, 12288
  s_add_u32 s75, s75, s57
  s_add_u32 s75, s75, s58
  v_cvt_pk_bf16_f32 v160, v160, v160
  v_lshlrev_b32 v160, 16, v160
  v_add_f32 v160, v160, v80
  v_cvt_pk_bf16_f32 v160, v160, v160
  v_lshlrev_b32 v160, 16, v160
  v_mul_f32 v6, v160, v160
  v_mul_f32 v6, s78, v6
  v_fma_f32 v6, v6, v160, v160
  v_mul_f32 v6, s79, v6
  v_exp_f32 v6, v6
  s_nop 0
  v_add_f32 v6, 1.0, v6
  v_rcp_f32 v6, v6
  s_nop 0
  v_mul_f32 v160, v160, v6
  v_cvt_pk_bf16_f32 v161, v161, v161
  v_lshlrev_b32 v161, 16, v161
  v_add_f32 v161, v161, v81
  v_cvt_pk_bf16_f32 v161, v161, v161
  v_lshlrev_b32 v161, 16, v161
  v_mul_f32 v6, v161, v161
  v_mul_f32 v6, s78, v6
  v_fma_f32 v6, v6, v161, v161
  v_mul_f32 v6, s79, v6
  v_exp_f32 v6, v6
  s_nop 0
  v_add_f32 v6, 1.0, v6
  v_rcp_f32 v6, v6
  s_nop 0
  v_mul_f32 v161, v161, v6
  v_cvt_pk_bf16_f32 v162, v162, v162
  v_lshlrev_b32 v162, 16, v162
  v_add_f32 v162, v162, v82
  v_cvt_pk_bf16_f32 v162, v162, v162
  v_lshlrev_b32 v162, 16, v162
  v_mul_f32 v6, v162, v162
  v_mul_f32 v6, s78, v6
  v_fma_f32 v6, v6, v162, v162
  v_mul_f32 v6, s79, v6
  v_exp_f32 v6, v6
  s_nop 0
  v_add_f32 v6, 1.0, v6
  v_rcp_f32 v6, v6
  s_nop 0
  v_mul_f32 v162, v162, v6
  v_cvt_pk_bf16_f32 v163, v163, v163
  v_lshlrev_b32 v163, 16, v163
  v_add_f32 v163, v163, v83
  v_cvt_pk_bf16_f32 v163, v163, v163
  v_lshlrev_b32 v163, 16, v163
  v_mul_f32 v6, v163, v163
  v_mul_f32 v6, s78, v6
  v_fma_f32 v6, v6, v163, v163
  v_mul_f32 v6, s79, v6
  v_exp_f32 v6, v6
  s_nop 0
  v_add_f32 v6, 1.0, v6
  v_rcp_f32 v6, v6
  s_nop 0
  v_mul_f32 v163, v163, v6
  v_cvt_pk_bf16_f32 v64, v160, v161
  v_cvt_pk_bf16_f32 v65, v162, v163
  v_cvt_pk_bf16_f32 v168, v168, v168
  v_lshlrev_b32 v168, 16, v168
  v_add_f32 v168, v168, v84
  v_cvt_pk_bf16_f32 v168, v168, v168
  v_lshlrev_b32 v168, 16, v168
  v_mul_f32 v6, v168, v168
  v_mul_f32 v6, s78, v6
  v_fma_f32 v6, v6, v168, v168
  v_mul_f32 v6, s79, v6
  v_exp_f32 v6, v6
  s_nop 0
  v_add_f32 v6, 1.0, v6
  v_rcp_f32 v6, v6
  s_nop 0
  v_mul_f32 v168, v168, v6
  v_cvt_pk_bf16_f32 v169, v169, v169
  v_lshlrev_b32 v169, 16, v169
  v_add_f32 v169, v169, v85
  v_cvt_pk_bf16_f32 v169, v169, v169
  v_lshlrev_b32 v169, 16, v169
  v_mul_f32 v6, v169, v169
  v_mul_f32 v6, s78, v6
  v_fma_f32 v6, v6, v169, v169
  v_mul_f32 v6, s79, v6
  v_exp_f32 v6, v6
  s_nop 0
  v_add_f32 v6, 1.0, v6
  v_rcp_f32 v6, v6
  s_nop 0
  v_mul_f32 v169, v169, v6
  v_cvt_pk_bf16_f32 v170, v170, v170
  v_lshlrev_b32 v170, 16, v170
  v_add_f32 v170, v170, v86
  v_cvt_pk_bf16_f32 v170, v170, v170
  v_lshlrev_b32 v170, 16, v170
  v_mul_f32 v6, v170, v170
  v_mul_f32 v6, s78, v6
  v_fma_f32 v6, v6, v170, v170
  v_mul_f32 v6, s79, v6
  v_exp_f32 v6, v6
  s_nop 0
  v_add_f32 v6, 1.0, v6
  v_rcp_f32 v6, v6
  s_nop 0
  v_mul_f32 v170, v170, v6
  v_cvt_pk_bf16_f32 v171, v171, v171
  v_lshlrev_b32 v171, 16, v171
  v_add_f32 v171, v171, v87
  v_cvt_pk_bf16_f32 v171, v171, v171
  v_lshlrev_b32 v171, 16, v171
  v_mul_f32 v6, v171, v171
  v_mul_f32 v6, s78, v6
  v_fma_f32 v6, v6, v171, v171
  v_mul_f32 v6, s79, v6
  v_exp_f32 v6, v6
  s_nop 0
  v_add_f32 v6, 1.0, v6
  v_rcp_f32 v6, v6
  s_nop 0
  v_mul_f32 v171, v171, v6
  v_cvt_pk_bf16_f32 v66, v168, v169
  v_cvt_pk_bf16_f32 v67, v170, v171
  buffer_store_dwordx4 v[64:67], v60, s[48:51], s75 offen offset:0 sc1
  v_cvt_pk_bf16_f32 v164, v164, v164
  v_lshlrev_b32 v164, 16, v164
  v_add_f32 v164, v164, v80
  v_cvt_pk_bf16_f32 v164, v164, v164
  v_lshlrev_b32 v164, 16, v164
  v_mul_f32 v6, v164, v164
  v_mul_f32 v6, s78, v6
  v_fma_f32 v6, v6, v164, v164
  v_mul_f32 v6, s79, v6
  v_exp_f32 v6, v6
  s_nop 0
  v_add_f32 v6, 1.0, v6
  v_rcp_f32 v6, v6
  s_nop 0
  v_mul_f32 v164, v164, v6
  v_cvt_pk_bf16_f32 v165, v165, v165
  v_lshlrev_b32 v165, 16, v165
  v_add_f32 v165, v165, v81
  v_cvt_pk_bf16_f32 v165, v165, v165
  v_lshlrev_b32 v165, 16, v165
  v_mul_f32 v6, v165, v165
  v_mul_f32 v6, s78, v6
  v_fma_f32 v6, v6, v165, v165
  v_mul_f32 v6, s79, v6
  v_exp_f32 v6, v6
  s_nop 0
  v_add_f32 v6, 1.0, v6
  v_rcp_f32 v6, v6
  s_nop 0
  v_mul_f32 v165, v165, v6
  v_cvt_pk_bf16_f32 v166, v166, v166
  v_lshlrev_b32 v166, 16, v166
  v_add_f32 v166, v166, v82
  v_cvt_pk_bf16_f32 v166, v166, v166
  v_lshlrev_b32 v166, 16, v166
  v_mul_f32 v6, v166, v166
  v_mul_f32 v6, s78, v6
  v_fma_f32 v6, v6, v166, v166
  v_mul_f32 v6, s79, v6
  v_exp_f32 v6, v6
  s_nop 0
  v_add_f32 v6, 1.0, v6
  v_rcp_f32 v6, v6
  s_nop 0
  v_mul_f32 v166, v166, v6
  v_cvt_pk_bf16_f32 v167, v167, v167
  v_lshlrev_b32 v167, 16, v167
  v_add_f32 v167, v167, v83
  v_cvt_pk_bf16_f32 v167, v167, v167
  v_lshlrev_b32 v167, 16, v167
  v_mul_f32 v6, v167, v167
  v_mul_f32 v6, s78, v6
  v_fma_f32 v6, v6, v167, v167
  v_mul_f32 v6, s79, v6
  v_exp_f32 v6, v6
  s_nop 0
  v_add_f32 v6, 1.0, v6
  v_rcp_f32 v6, v6
  s_nop 0
  v_mul_f32 v167, v167, v6
  v_cvt_pk_bf16_f32 v68, v164, v165
  v_cvt_pk_bf16_f32 v69, v166, v167
  v_cvt_pk_bf16_f32 v172, v172, v172
  v_lshlrev_b32 v172, 16, v172
  v_add_f32 v172, v172, v84
  v_cvt_pk_bf16_f32 v172, v172, v172
  v_lshlrev_b32 v172, 16, v172
  v_mul_f32 v6, v172, v172
  v_mul_f32 v6, s78, v6
  v_fma_f32 v6, v6, v172, v172
  v_mul_f32 v6, s79, v6
  v_exp_f32 v6, v6
  s_nop 0
  v_add_f32 v6, 1.0, v6
  v_rcp_f32 v6, v6
  s_nop 0
  v_mul_f32 v172, v172, v6
  v_cvt_pk_bf16_f32 v173, v173, v173
  v_lshlrev_b32 v173, 16, v173
  v_add_f32 v173, v173, v85
  v_cvt_pk_bf16_f32 v173, v173, v173
  v_lshlrev_b32 v173, 16, v173
  v_mul_f32 v6, v173, v173
  v_mul_f32 v6, s78, v6
  v_fma_f32 v6, v6, v173, v173
  v_mul_f32 v6, s79, v6
  v_exp_f32 v6, v6
  s_nop 0
  v_add_f32 v6, 1.0, v6
  v_rcp_f32 v6, v6
  s_nop 0
  v_mul_f32 v173, v173, v6
  v_cvt_pk_bf16_f32 v174, v174, v174
  v_lshlrev_b32 v174, 16, v174
  v_add_f32 v174, v174, v86
  v_cvt_pk_bf16_f32 v174, v174, v174
  v_lshlrev_b32 v174, 16, v174
  v_mul_f32 v6, v174, v174
  v_mul_f32 v6, s78, v6
  v_fma_f32 v6, v6, v174, v174
  v_mul_f32 v6, s79, v6
  v_exp_f32 v6, v6
  s_nop 0
  v_add_f32 v6, 1.0, v6
  v_rcp_f32 v6, v6
  s_nop 0
  v_mul_f32 v174, v174, v6
  v_cvt_pk_bf16_f32 v175, v175, v175
  v_lshlrev_b32 v175, 16, v175
  v_add_f32 v175, v175, v87
  v_cvt_pk_bf16_f32 v175, v175, v175
  v_lshlrev_b32 v175, 16, v175
  v_mul_f32 v6, v175, v175
  v_mul_f32 v6, s78, v6
  v_fma_f32 v6, v6, v175, v175
  v_mul_f32 v6, s79, v6
  v_exp_f32 v6, v6
  s_nop 0
  v_add_f32 v6, 1.0, v6
  v_rcp_f32 v6, v6
  s_nop 0
  v_mul_f32 v175, v175, v6
  v_cvt_pk_bf16_f32 v70, v172, v173
  v_cvt_pk_bf16_f32 v71, v174, v175
  buffer_store_dwordx4 v[68:71], v60, s[48:51], s75 offen offset:1024 sc1
  v_cvt_pk_bf16_f32 v176, v176, v176
  v_lshlrev_b32 v176, 16, v176
  v_add_f32 v176, v176, v88
  v_cvt_pk_bf16_f32 v176, v176, v176
  v_lshlrev_b32 v176, 16, v176
  v_mul_f32 v6, v176, v176
  v_mul_f32 v6, s78, v6
  v_fma_f32 v6, v6, v176, v176
  v_mul_f32 v6, s79, v6
  v_exp_f32 v6, v6
  s_nop 0
  v_add_f32 v6, 1.0, v6
  v_rcp_f32 v6, v6
  s_nop 0
  v_mul_f32 v176, v176, v6
  v_cvt_pk_bf16_f32 v177, v177, v177
  v_lshlrev_b32 v177, 16, v177
  v_add_f32 v177, v177, v89
  v_cvt_pk_bf16_f32 v177, v177, v177
  v_lshlrev_b32 v177, 16, v177
  v_mul_f32 v6, v177, v177
  v_mul_f32 v6, s78, v6
  v_fma_f32 v6, v6, v177, v177
  v_mul_f32 v6, s79, v6
  v_exp_f32 v6, v6
  s_nop 0
  v_add_f32 v6, 1.0, v6
  v_rcp_f32 v6, v6
  s_nop 0
  v_mul_f32 v177, v177, v6
  v_cvt_pk_bf16_f32 v178, v178, v178
  v_lshlrev_b32 v178, 16, v178
  v_add_f32 v178, v178, v90
  v_cvt_pk_bf16_f32 v178, v178, v178
  v_lshlrev_b32 v178, 16, v178
  v_mul_f32 v6, v178, v178
  v_mul_f32 v6, s78, v6
  v_fma_f32 v6, v6, v178, v178
  v_mul_f32 v6, s79, v6
  v_exp_f32 v6, v6
  s_nop 0
  v_add_f32 v6, 1.0, v6
  v_rcp_f32 v6, v6
  s_nop 0
  v_mul_f32 v178, v178, v6
  v_cvt_pk_bf16_f32 v179, v179, v179
  v_lshlrev_b32 v179, 16, v179
  v_add_f32 v179, v179, v91
  v_cvt_pk_bf16_f32 v179, v179, v179
  v_lshlrev_b32 v179, 16, v179
  v_mul_f32 v6, v179, v179
  v_mul_f32 v6, s78, v6
  v_fma_f32 v6, v6, v179, v179
  v_mul_f32 v6, s79, v6
  v_exp_f32 v6, v6
  s_nop 0
  v_add_f32 v6, 1.0, v6
  v_rcp_f32 v6, v6
  s_nop 0
  v_mul_f32 v179, v179, v6
  v_cvt_pk_bf16_f32 v72, v176, v177
  v_cvt_pk_bf16_f32 v73, v178, v179
  v_cvt_pk_bf16_f32 v184, v184, v184
  v_lshlrev_b32 v184, 16, v184
  v_add_f32 v184, v184, v92
  v_cvt_pk_bf16_f32 v184, v184, v184
  v_lshlrev_b32 v184, 16, v184
  v_mul_f32 v6, v184, v184
  v_mul_f32 v6, s78, v6
  v_fma_f32 v6, v6, v184, v184
  v_mul_f32 v6, s79, v6
  v_exp_f32 v6, v6
  s_nop 0
  v_add_f32 v6, 1.0, v6
  v_rcp_f32 v6, v6
  s_nop 0
  v_mul_f32 v184, v184, v6
  v_cvt_pk_bf16_f32 v185, v185, v185
  v_lshlrev_b32 v185, 16, v185
  v_add_f32 v185, v185, v93
  v_cvt_pk_bf16_f32 v185, v185, v185
  v_lshlrev_b32 v185, 16, v185
  v_mul_f32 v6, v185, v185
  v_mul_f32 v6, s78, v6
  v_fma_f32 v6, v6, v185, v185
  v_mul_f32 v6, s79, v6
  v_exp_f32 v6, v6
  s_nop 0
  v_add_f32 v6, 1.0, v6
  v_rcp_f32 v6, v6
  s_nop 0
  v_mul_f32 v185, v185, v6
  v_cvt_pk_bf16_f32 v186, v186, v186
  v_lshlrev_b32 v186, 16, v186
  v_add_f32 v186, v186, v94
  v_cvt_pk_bf16_f32 v186, v186, v186
  v_lshlrev_b32 v186, 16, v186
  v_mul_f32 v6, v186, v186
  v_mul_f32 v6, s78, v6
  v_fma_f32 v6, v6, v186, v186
  v_mul_f32 v6, s79, v6
  v_exp_f32 v6, v6
  s_nop 0
  v_add_f32 v6, 1.0, v6
  v_rcp_f32 v6, v6
  s_nop 0
  v_mul_f32 v186, v186, v6
  v_cvt_pk_bf16_f32 v187, v187, v187
  v_lshlrev_b32 v187, 16, v187
  v_add_f32 v187, v187, v95
  v_cvt_pk_bf16_f32 v187, v187, v187
  v_lshlrev_b32 v187, 16, v187
  v_mul_f32 v6, v187, v187
  v_mul_f32 v6, s78, v6
  v_fma_f32 v6, v6, v187, v187
  v_mul_f32 v6, s79, v6
  v_exp_f32 v6, v6
  s_nop 0
  v_add_f32 v6, 1.0, v6
  v_rcp_f32 v6, v6
  s_nop 0
  v_mul_f32 v187, v187, v6
  v_cvt_pk_bf16_f32 v74, v184, v185
  v_cvt_pk_bf16_f32 v75, v186, v187
  buffer_store_dwordx4 v[72:75], v60, s[48:51], s75 offen offset:2048 sc1
  v_cvt_pk_bf16_f32 v180, v180, v180
  v_lshlrev_b32 v180, 16, v180
  v_add_f32 v180, v180, v88
  v_cvt_pk_bf16_f32 v180, v180, v180
  v_lshlrev_b32 v180, 16, v180
  v_mul_f32 v6, v180, v180
  v_mul_f32 v6, s78, v6
  v_fma_f32 v6, v6, v180, v180
  v_mul_f32 v6, s79, v6
  v_exp_f32 v6, v6
  s_nop 0
  v_add_f32 v6, 1.0, v6
  v_rcp_f32 v6, v6
  s_nop 0
  v_mul_f32 v180, v180, v6
  v_cvt_pk_bf16_f32 v181, v181, v181
  v_lshlrev_b32 v181, 16, v181
  v_add_f32 v181, v181, v89
  v_cvt_pk_bf16_f32 v181, v181, v181
  v_lshlrev_b32 v181, 16, v181
  v_mul_f32 v6, v181, v181
  v_mul_f32 v6, s78, v6
  v_fma_f32 v6, v6, v181, v181
  v_mul_f32 v6, s79, v6
  v_exp_f32 v6, v6
  s_nop 0
  v_add_f32 v6, 1.0, v6
  v_rcp_f32 v6, v6
  s_nop 0
  v_mul_f32 v181, v181, v6
  v_cvt_pk_bf16_f32 v182, v182, v182
  v_lshlrev_b32 v182, 16, v182
  v_add_f32 v182, v182, v90
  v_cvt_pk_bf16_f32 v182, v182, v182
  v_lshlrev_b32 v182, 16, v182
  v_mul_f32 v6, v182, v182
  v_mul_f32 v6, s78, v6
  v_fma_f32 v6, v6, v182, v182
  v_mul_f32 v6, s79, v6
  v_exp_f32 v6, v6
  s_nop 0
  v_add_f32 v6, 1.0, v6
  v_rcp_f32 v6, v6
  s_nop 0
  v_mul_f32 v182, v182, v6
  v_cvt_pk_bf16_f32 v183, v183, v183
  v_lshlrev_b32 v183, 16, v183
  v_add_f32 v183, v183, v91
  v_cvt_pk_bf16_f32 v183, v183, v183
  v_lshlrev_b32 v183, 16, v183
  v_mul_f32 v6, v183, v183
  v_mul_f32 v6, s78, v6
  v_fma_f32 v6, v6, v183, v183
  v_mul_f32 v6, s79, v6
  v_exp_f32 v6, v6
  s_nop 0
  v_add_f32 v6, 1.0, v6
  v_rcp_f32 v6, v6
  s_nop 0
  v_mul_f32 v183, v183, v6
  v_cvt_pk_bf16_f32 v76, v180, v181
  v_cvt_pk_bf16_f32 v77, v182, v183
  v_cvt_pk_bf16_f32 v188, v188, v188
  v_lshlrev_b32 v188, 16, v188
  v_add_f32 v188, v188, v92
  v_cvt_pk_bf16_f32 v188, v188, v188
  v_lshlrev_b32 v188, 16, v188
  v_mul_f32 v6, v188, v188
  v_mul_f32 v6, s78, v6
  v_fma_f32 v6, v6, v188, v188
  v_mul_f32 v6, s79, v6
  v_exp_f32 v6, v6
  s_nop 0
  v_add_f32 v6, 1.0, v6
  v_rcp_f32 v6, v6
  s_nop 0
  v_mul_f32 v188, v188, v6
  v_cvt_pk_bf16_f32 v189, v189, v189
  v_lshlrev_b32 v189, 16, v189
  v_add_f32 v189, v189, v93
  v_cvt_pk_bf16_f32 v189, v189, v189
  v_lshlrev_b32 v189, 16, v189
  v_mul_f32 v6, v189, v189
  v_mul_f32 v6, s78, v6
  v_fma_f32 v6, v6, v189, v189
  v_mul_f32 v6, s79, v6
  v_exp_f32 v6, v6
  s_nop 0
  v_add_f32 v6, 1.0, v6
  v_rcp_f32 v6, v6
  s_nop 0
  v_mul_f32 v189, v189, v6
  v_cvt_pk_bf16_f32 v190, v190, v190
  v_lshlrev_b32 v190, 16, v190
  v_add_f32 v190, v190, v94
  v_cvt_pk_bf16_f32 v190, v190, v190
  v_lshlrev_b32 v190, 16, v190
  v_mul_f32 v6, v190, v190
  v_mul_f32 v6, s78, v6
  v_fma_f32 v6, v6, v190, v190
  v_mul_f32 v6, s79, v6
  v_exp_f32 v6, v6
  s_nop 0
  v_add_f32 v6, 1.0, v6
  v_rcp_f32 v6, v6
  s_nop 0
  v_mul_f32 v190, v190, v6
  v_cvt_pk_bf16_f32 v191, v191, v191
  v_lshlrev_b32 v191, 16, v191
  v_add_f32 v191, v191, v95
  v_cvt_pk_bf16_f32 v191, v191, v191
  v_lshlrev_b32 v191, 16, v191
  v_mul_f32 v6, v191, v191
  v_mul_f32 v6, s78, v6
  v_fma_f32 v6, v6, v191, v191
  v_mul_f32 v6, s79, v6
  v_exp_f32 v6, v6
  s_nop 0
  v_add_f32 v6, 1.0, v6
  v_rcp_f32 v6, v6
  s_nop 0
  v_mul_f32 v191, v191, v6
  v_cvt_pk_bf16_f32 v78, v188, v189
  v_cvt_pk_bf16_f32 v79, v190, v191
  buffer_store_dwordx4 v[76:79], v60, s[48:51], s75 offen offset:3072 sc1
  v_cvt_pk_bf16_f32 v192, v192, v192
  v_lshlrev_b32 v192, 16, v192
  v_add_f32 v192, v192, v96
  v_cvt_pk_bf16_f32 v192, v192, v192
  v_lshlrev_b32 v192, 16, v192
  v_mul_f32 v6, v192, v192
  v_mul_f32 v6, s78, v6
  v_fma_f32 v6, v6, v192, v192
  v_mul_f32 v6, s79, v6
  v_exp_f32 v6, v6
  s_nop 0
  v_add_f32 v6, 1.0, v6
  v_rcp_f32 v6, v6
  s_nop 0
  v_mul_f32 v192, v192, v6
  v_cvt_pk_bf16_f32 v193, v193, v193
  v_lshlrev_b32 v193, 16, v193
  v_add_f32 v193, v193, v97
  v_cvt_pk_bf16_f32 v193, v193, v193
  v_lshlrev_b32 v193, 16, v193
  v_mul_f32 v6, v193, v193
  v_mul_f32 v6, s78, v6
  v_fma_f32 v6, v6, v193, v193
  v_mul_f32 v6, s79, v6
  v_exp_f32 v6, v6
  s_nop 0
  v_add_f32 v6, 1.0, v6
  v_rcp_f32 v6, v6
  s_nop 0
  v_mul_f32 v193, v193, v6
  v_cvt_pk_bf16_f32 v194, v194, v194
  v_lshlrev_b32 v194, 16, v194
  v_add_f32 v194, v194, v98
  v_cvt_pk_bf16_f32 v194, v194, v194
  v_lshlrev_b32 v194, 16, v194
  v_mul_f32 v6, v194, v194
  v_mul_f32 v6, s78, v6
  v_fma_f32 v6, v6, v194, v194
  v_mul_f32 v6, s79, v6
  v_exp_f32 v6, v6
  s_nop 0
  v_add_f32 v6, 1.0, v6
  v_rcp_f32 v6, v6
  s_nop 0
  v_mul_f32 v194, v194, v6
  v_cvt_pk_bf16_f32 v195, v195, v195
  v_lshlrev_b32 v195, 16, v195
  v_add_f32 v195, v195, v99
  v_cvt_pk_bf16_f32 v195, v195, v195
  v_lshlrev_b32 v195, 16, v195
  v_mul_f32 v6, v195, v195
  v_mul_f32 v6, s78, v6
  v_fma_f32 v6, v6, v195, v195
  v_mul_f32 v6, s79, v6
  v_exp_f32 v6, v6
  s_nop 0
  v_add_f32 v6, 1.0, v6
  v_rcp_f32 v6, v6
  s_nop 0
  v_mul_f32 v195, v195, v6
  v_cvt_pk_bf16_f32 v64, v192, v193
  v_cvt_pk_bf16_f32 v65, v194, v195
  v_cvt_pk_bf16_f32 v200, v200, v200
  v_lshlrev_b32 v200, 16, v200
  v_add_f32 v200, v200, v100
  v_cvt_pk_bf16_f32 v200, v200, v200
  v_lshlrev_b32 v200, 16, v200
  v_mul_f32 v6, v200, v200
  v_mul_f32 v6, s78, v6
  v_fma_f32 v6, v6, v200, v200
  v_mul_f32 v6, s79, v6
  v_exp_f32 v6, v6
  s_nop 0
  v_add_f32 v6, 1.0, v6
  v_rcp_f32 v6, v6
  s_nop 0
  v_mul_f32 v200, v200, v6
  v_cvt_pk_bf16_f32 v201, v201, v201
  v_lshlrev_b32 v201, 16, v201
  v_add_f32 v201, v201, v101
  v_cvt_pk_bf16_f32 v201, v201, v201
  v_lshlrev_b32 v201, 16, v201
  v_mul_f32 v6, v201, v201
  v_mul_f32 v6, s78, v6
  v_fma_f32 v6, v6, v201, v201
  v_mul_f32 v6, s79, v6
  v_exp_f32 v6, v6
  s_nop 0
  v_add_f32 v6, 1.0, v6
  v_rcp_f32 v6, v6
  s_nop 0
  v_mul_f32 v201, v201, v6
  v_cvt_pk_bf16_f32 v202, v202, v202
  v_lshlrev_b32 v202, 16, v202
  v_add_f32 v202, v202, v102
  v_cvt_pk_bf16_f32 v202, v202, v202
  v_lshlrev_b32 v202, 16, v202
  v_mul_f32 v6, v202, v202
  v_mul_f32 v6, s78, v6
  v_fma_f32 v6, v6, v202, v202
  v_mul_f32 v6, s79, v6
  v_exp_f32 v6, v6
  s_nop 0
  v_add_f32 v6, 1.0, v6
  v_rcp_f32 v6, v6
  s_nop 0
  v_mul_f32 v202, v202, v6
  v_cvt_pk_bf16_f32 v203, v203, v203
  v_lshlrev_b32 v203, 16, v203
  v_add_f32 v203, v203, v103
  v_cvt_pk_bf16_f32 v203, v203, v203
  v_lshlrev_b32 v203, 16, v203
  v_mul_f32 v6, v203, v203
  v_mul_f32 v6, s78, v6
  v_fma_f32 v6, v6, v203, v203
  v_mul_f32 v6, s79, v6
  v_exp_f32 v6, v6
  s_nop 0
  v_add_f32 v6, 1.0, v6
  v_rcp_f32 v6, v6
  s_nop 0
  v_mul_f32 v203, v203, v6
  v_cvt_pk_bf16_f32 v66, v200, v201
  v_cvt_pk_bf16_f32 v67, v202, v203
  s_add_u32 s75, s75, 4096
  buffer_store_dwordx4 v[64:67], v60, s[48:51], s75 offen offset:0 sc1
  v_cvt_pk_bf16_f32 v196, v196, v196
  v_lshlrev_b32 v196, 16, v196
  v_add_f32 v196, v196, v96
  v_cvt_pk_bf16_f32 v196, v196, v196
  v_lshlrev_b32 v196, 16, v196
  v_mul_f32 v6, v196, v196
  v_mul_f32 v6, s78, v6
  v_fma_f32 v6, v6, v196, v196
  v_mul_f32 v6, s79, v6
  v_exp_f32 v6, v6
  s_nop 0
  v_add_f32 v6, 1.0, v6
  v_rcp_f32 v6, v6
  s_nop 0
  v_mul_f32 v196, v196, v6
  v_cvt_pk_bf16_f32 v197, v197, v197
  v_lshlrev_b32 v197, 16, v197
  v_add_f32 v197, v197, v97
  v_cvt_pk_bf16_f32 v197, v197, v197
  v_lshlrev_b32 v197, 16, v197
  v_mul_f32 v6, v197, v197
  v_mul_f32 v6, s78, v6
  v_fma_f32 v6, v6, v197, v197
  v_mul_f32 v6, s79, v6
  v_exp_f32 v6, v6
  s_nop 0
  v_add_f32 v6, 1.0, v6
  v_rcp_f32 v6, v6
  s_nop 0
  v_mul_f32 v197, v197, v6
  v_cvt_pk_bf16_f32 v198, v198, v198
  v_lshlrev_b32 v198, 16, v198
  v_add_f32 v198, v198, v98
  v_cvt_pk_bf16_f32 v198, v198, v198
  v_lshlrev_b32 v198, 16, v198
  v_mul_f32 v6, v198, v198
  v_mul_f32 v6, s78, v6
  v_fma_f32 v6, v6, v198, v198
  v_mul_f32 v6, s79, v6
  v_exp_f32 v6, v6
  s_nop 0
  v_add_f32 v6, 1.0, v6
  v_rcp_f32 v6, v6
  s_nop 0
  v_mul_f32 v198, v198, v6
  v_cvt_pk_bf16_f32 v199, v199, v199
  v_lshlrev_b32 v199, 16, v199
  v_add_f32 v199, v199, v99
  v_cvt_pk_bf16_f32 v199, v199, v199
  v_lshlrev_b32 v199, 16, v199
  v_mul_f32 v6, v199, v199
  v_mul_f32 v6, s78, v6
  v_fma_f32 v6, v6, v199, v199
  v_mul_f32 v6, s79, v6
  v_exp_f32 v6, v6
  s_nop 0
  v_add_f32 v6, 1.0, v6
  v_rcp_f32 v6, v6
  s_nop 0
  v_mul_f32 v199, v199, v6
  v_cvt_pk_bf16_f32 v68, v196, v197
  v_cvt_pk_bf16_f32 v69, v198, v199
  v_cvt_pk_bf16_f32 v204, v204, v204
  v_lshlrev_b32 v204, 16, v204
  v_add_f32 v204, v204, v100
  v_cvt_pk_bf16_f32 v204, v204, v204
  v_lshlrev_b32 v204, 16, v204
  v_mul_f32 v6, v204, v204
  v_mul_f32 v6, s78, v6
  v_fma_f32 v6, v6, v204, v204
  v_mul_f32 v6, s79, v6
  v_exp_f32 v6, v6
  s_nop 0
  v_add_f32 v6, 1.0, v6
  v_rcp_f32 v6, v6
  s_nop 0
  v_mul_f32 v204, v204, v6
  v_cvt_pk_bf16_f32 v205, v205, v205
  v_lshlrev_b32 v205, 16, v205
  v_add_f32 v205, v205, v101
  v_cvt_pk_bf16_f32 v205, v205, v205
  v_lshlrev_b32 v205, 16, v205
  v_mul_f32 v6, v205, v205
  v_mul_f32 v6, s78, v6
  v_fma_f32 v6, v6, v205, v205
  v_mul_f32 v6, s79, v6
  v_exp_f32 v6, v6
  s_nop 0
  v_add_f32 v6, 1.0, v6
  v_rcp_f32 v6, v6
  s_nop 0
  v_mul_f32 v205, v205, v6
  v_cvt_pk_bf16_f32 v206, v206, v206
  v_lshlrev_b32 v206, 16, v206
  v_add_f32 v206, v206, v102
  v_cvt_pk_bf16_f32 v206, v206, v206
  v_lshlrev_b32 v206, 16, v206
  v_mul_f32 v6, v206, v206
  v_mul_f32 v6, s78, v6
  v_fma_f32 v6, v6, v206, v206
  v_mul_f32 v6, s79, v6
  v_exp_f32 v6, v6
  s_nop 0
  v_add_f32 v6, 1.0, v6
  v_rcp_f32 v6, v6
  s_nop 0
  v_mul_f32 v206, v206, v6
  v_cvt_pk_bf16_f32 v207, v207, v207
  v_lshlrev_b32 v207, 16, v207
  v_add_f32 v207, v207, v103
  v_cvt_pk_bf16_f32 v207, v207, v207
  v_lshlrev_b32 v207, 16, v207
  v_mul_f32 v6, v207, v207
  v_mul_f32 v6, s78, v6
  v_fma_f32 v6, v6, v207, v207
  v_mul_f32 v6, s79, v6
  v_exp_f32 v6, v6
  s_nop 0
  v_add_f32 v6, 1.0, v6
  v_rcp_f32 v6, v6
  s_nop 0
  v_mul_f32 v207, v207, v6
  v_cvt_pk_bf16_f32 v70, v204, v205
  v_cvt_pk_bf16_f32 v71, v206, v207
  buffer_store_dwordx4 v[68:71], v60, s[48:51], s75 offen offset:1024 sc1
  v_cvt_pk_bf16_f32 v208, v208, v208
  v_lshlrev_b32 v208, 16, v208
  v_add_f32 v208, v208, v104
  v_cvt_pk_bf16_f32 v208, v208, v208
  v_lshlrev_b32 v208, 16, v208
  v_mul_f32 v6, v208, v208
  v_mul_f32 v6, s78, v6
  v_fma_f32 v6, v6, v208, v208
  v_mul_f32 v6, s79, v6
  v_exp_f32 v6, v6
  s_nop 0
  v_add_f32 v6, 1.0, v6
  v_rcp_f32 v6, v6
  s_nop 0
  v_mul_f32 v208, v208, v6
  v_cvt_pk_bf16_f32 v209, v209, v209
  v_lshlrev_b32 v209, 16, v209
  v_add_f32 v209, v209, v105
  v_cvt_pk_bf16_f32 v209, v209, v209
  v_lshlrev_b32 v209, 16, v209
  v_mul_f32 v6, v209, v209
  v_mul_f32 v6, s78, v6
  v_fma_f32 v6, v6, v209, v209
  v_mul_f32 v6, s79, v6
  v_exp_f32 v6, v6
  s_nop 0
  v_add_f32 v6, 1.0, v6
  v_rcp_f32 v6, v6
  s_nop 0
  v_mul_f32 v209, v209, v6
  v_cvt_pk_bf16_f32 v210, v210, v210
  v_lshlrev_b32 v210, 16, v210
  v_add_f32 v210, v210, v106
  v_cvt_pk_bf16_f32 v210, v210, v210
  v_lshlrev_b32 v210, 16, v210
  v_mul_f32 v6, v210, v210
  v_mul_f32 v6, s78, v6
  v_fma_f32 v6, v6, v210, v210
  v_mul_f32 v6, s79, v6
  v_exp_f32 v6, v6
  s_nop 0
  v_add_f32 v6, 1.0, v6
  v_rcp_f32 v6, v6
  s_nop 0
  v_mul_f32 v210, v210, v6
  v_cvt_pk_bf16_f32 v211, v211, v211
  v_lshlrev_b32 v211, 16, v211
  v_add_f32 v211, v211, v107
  v_cvt_pk_bf16_f32 v211, v211, v211
  v_lshlrev_b32 v211, 16, v211
  v_mul_f32 v6, v211, v211
  v_mul_f32 v6, s78, v6
  v_fma_f32 v6, v6, v211, v211
  v_mul_f32 v6, s79, v6
  v_exp_f32 v6, v6
  s_nop 0
  v_add_f32 v6, 1.0, v6
  v_rcp_f32 v6, v6
  s_nop 0
  v_mul_f32 v211, v211, v6
  v_cvt_pk_bf16_f32 v72, v208, v209
  v_cvt_pk_bf16_f32 v73, v210, v211
  v_cvt_pk_bf16_f32 v216, v216, v216
  v_lshlrev_b32 v216, 16, v216
  v_add_f32 v216, v216, v108
  v_cvt_pk_bf16_f32 v216, v216, v216
  v_lshlrev_b32 v216, 16, v216
  v_mul_f32 v6, v216, v216
  v_mul_f32 v6, s78, v6
  v_fma_f32 v6, v6, v216, v216
  v_mul_f32 v6, s79, v6
  v_exp_f32 v6, v6
  s_nop 0
  v_add_f32 v6, 1.0, v6
  v_rcp_f32 v6, v6
  s_nop 0
  v_mul_f32 v216, v216, v6
  v_cvt_pk_bf16_f32 v217, v217, v217
  v_lshlrev_b32 v217, 16, v217
  v_add_f32 v217, v217, v109
  v_cvt_pk_bf16_f32 v217, v217, v217
  v_lshlrev_b32 v217, 16, v217
  v_mul_f32 v6, v217, v217
  v_mul_f32 v6, s78, v6
  v_fma_f32 v6, v6, v217, v217
  v_mul_f32 v6, s79, v6
  v_exp_f32 v6, v6
  s_nop 0
  v_add_f32 v6, 1.0, v6
  v_rcp_f32 v6, v6
  s_nop 0
  v_mul_f32 v217, v217, v6
  v_cvt_pk_bf16_f32 v218, v218, v218
  v_lshlrev_b32 v218, 16, v218
  v_add_f32 v218, v218, v110
  v_cvt_pk_bf16_f32 v218, v218, v218
  v_lshlrev_b32 v218, 16, v218
  v_mul_f32 v6, v218, v218
  v_mul_f32 v6, s78, v6
  v_fma_f32 v6, v6, v218, v218
  v_mul_f32 v6, s79, v6
  v_exp_f32 v6, v6
  s_nop 0
  v_add_f32 v6, 1.0, v6
  v_rcp_f32 v6, v6
  s_nop 0
  v_mul_f32 v218, v218, v6
  v_cvt_pk_bf16_f32 v219, v219, v219
  v_lshlrev_b32 v219, 16, v219
  v_add_f32 v219, v219, v111
  v_cvt_pk_bf16_f32 v219, v219, v219
  v_lshlrev_b32 v219, 16, v219
  v_mul_f32 v6, v219, v219
  v_mul_f32 v6, s78, v6
  v_fma_f32 v6, v6, v219, v219
  v_mul_f32 v6, s79, v6
  v_exp_f32 v6, v6
  s_nop 0
  v_add_f32 v6, 1.0, v6
  v_rcp_f32 v6, v6
  s_nop 0
  v_mul_f32 v219, v219, v6
  v_cvt_pk_bf16_f32 v74, v216, v217
  v_cvt_pk_bf16_f32 v75, v218, v219
  buffer_store_dwordx4 v[72:75], v60, s[48:51], s75 offen offset:2048 sc1
  v_cvt_pk_bf16_f32 v212, v212, v212
  v_lshlrev_b32 v212, 16, v212
  v_add_f32 v212, v212, v104
  v_cvt_pk_bf16_f32 v212, v212, v212
  v_lshlrev_b32 v212, 16, v212
  v_mul_f32 v6, v212, v212
  v_mul_f32 v6, s78, v6
  v_fma_f32 v6, v6, v212, v212
  v_mul_f32 v6, s79, v6
  v_exp_f32 v6, v6
  s_nop 0
  v_add_f32 v6, 1.0, v6
  v_rcp_f32 v6, v6
  s_nop 0
  v_mul_f32 v212, v212, v6
  v_cvt_pk_bf16_f32 v213, v213, v213
  v_lshlrev_b32 v213, 16, v213
  v_add_f32 v213, v213, v105
  v_cvt_pk_bf16_f32 v213, v213, v213
  v_lshlrev_b32 v213, 16, v213
  v_mul_f32 v6, v213, v213
  v_mul_f32 v6, s78, v6
  v_fma_f32 v6, v6, v213, v213
  v_mul_f32 v6, s79, v6
  v_exp_f32 v6, v6
  s_nop 0
  v_add_f32 v6, 1.0, v6
  v_rcp_f32 v6, v6
  s_nop 0
  v_mul_f32 v213, v213, v6
  v_cvt_pk_bf16_f32 v214, v214, v214
  v_lshlrev_b32 v214, 16, v214
  v_add_f32 v214, v214, v106
  v_cvt_pk_bf16_f32 v214, v214, v214
  v_lshlrev_b32 v214, 16, v214
  v_mul_f32 v6, v214, v214
  v_mul_f32 v6, s78, v6
  v_fma_f32 v6, v6, v214, v214
  v_mul_f32 v6, s79, v6
  v_exp_f32 v6, v6
  s_nop 0
  v_add_f32 v6, 1.0, v6
  v_rcp_f32 v6, v6
  s_nop 0
  v_mul_f32 v214, v214, v6
  v_cvt_pk_bf16_f32 v215, v215, v215
  v_lshlrev_b32 v215, 16, v215
  v_add_f32 v215, v215, v107
  v_cvt_pk_bf16_f32 v215, v215, v215
  v_lshlrev_b32 v215, 16, v215
  v_mul_f32 v6, v215, v215
  v_mul_f32 v6, s78, v6
  v_fma_f32 v6, v6, v215, v215
  v_mul_f32 v6, s79, v6
  v_exp_f32 v6, v6
  s_nop 0
  v_add_f32 v6, 1.0, v6
  v_rcp_f32 v6, v6
  s_nop 0
  v_mul_f32 v215, v215, v6
  v_cvt_pk_bf16_f32 v76, v212, v213
  v_cvt_pk_bf16_f32 v77, v214, v215
  v_cvt_pk_bf16_f32 v220, v220, v220
  v_lshlrev_b32 v220, 16, v220
  v_add_f32 v220, v220, v108
  v_cvt_pk_bf16_f32 v220, v220, v220
  v_lshlrev_b32 v220, 16, v220
  v_mul_f32 v6, v220, v220
  v_mul_f32 v6, s78, v6
  v_fma_f32 v6, v6, v220, v220
  v_mul_f32 v6, s79, v6
  v_exp_f32 v6, v6
  s_nop 0
  v_add_f32 v6, 1.0, v6
  v_rcp_f32 v6, v6
  s_nop 0
  v_mul_f32 v220, v220, v6
  v_cvt_pk_bf16_f32 v221, v221, v221
  v_lshlrev_b32 v221, 16, v221
  v_add_f32 v221, v221, v109
  v_cvt_pk_bf16_f32 v221, v221, v221
  v_lshlrev_b32 v221, 16, v221
  v_mul_f32 v6, v221, v221
  v_mul_f32 v6, s78, v6
  v_fma_f32 v6, v6, v221, v221
  v_mul_f32 v6, s79, v6
  v_exp_f32 v6, v6
  s_nop 0
  v_add_f32 v6, 1.0, v6
  v_rcp_f32 v6, v6
  s_nop 0
  v_mul_f32 v221, v221, v6
  v_cvt_pk_bf16_f32 v222, v222, v222
  v_lshlrev_b32 v222, 16, v222
  v_add_f32 v222, v222, v110
  v_cvt_pk_bf16_f32 v222, v222, v222
  v_lshlrev_b32 v222, 16, v222
  v_mul_f32 v6, v222, v222
  v_mul_f32 v6, s78, v6
  v_fma_f32 v6, v6, v222, v222
  v_mul_f32 v6, s79, v6
  v_exp_f32 v6, v6
  s_nop 0
  v_add_f32 v6, 1.0, v6
  v_rcp_f32 v6, v6
  s_nop 0
  v_mul_f32 v222, v222, v6
  v_cvt_pk_bf16_f32 v223, v223, v223
  v_lshlrev_b32 v223, 16, v223
  v_add_f32 v223, v223, v111
  v_cvt_pk_bf16_f32 v223, v223, v223
  v_lshlrev_b32 v223, 16, v223
  v_mul_f32 v6, v223, v223
  v_mul_f32 v6, s78, v6
  v_fma_f32 v6, v6, v223, v223
  v_mul_f32 v6, s79, v6
  v_exp_f32 v6, v6
  s_nop 0
  v_add_f32 v6, 1.0, v6
  v_rcp_f32 v6, v6
  s_nop 0
  v_mul_f32 v223, v223, v6
  v_cvt_pk_bf16_f32 v78, v220, v221
  v_cvt_pk_bf16_f32 v79, v222, v223
  buffer_store_dwordx4 v[76:79], v60, s[48:51], s75 offen offset:3072 sc1
  v_cvt_pk_bf16_f32 v224, v224, v224
  v_lshlrev_b32 v224, 16, v224
  v_add_f32 v224, v224, v112
  v_cvt_pk_bf16_f32 v224, v224, v224
  v_lshlrev_b32 v224, 16, v224
  v_mul_f32 v6, v224, v224
  v_mul_f32 v6, s78, v6
  v_fma_f32 v6, v6, v224, v224
  v_mul_f32 v6, s79, v6
  v_exp_f32 v6, v6
  s_nop 0
  v_add_f32 v6, 1.0, v6
  v_rcp_f32 v6, v6
  s_nop 0
  v_mul_f32 v224, v224, v6
  v_cvt_pk_bf16_f32 v225, v225, v225
  v_lshlrev_b32 v225, 16, v225
  v_add_f32 v225, v225, v113
  v_cvt_pk_bf16_f32 v225, v225, v225
  v_lshlrev_b32 v225, 16, v225
  v_mul_f32 v6, v225, v225
  v_mul_f32 v6, s78, v6
  v_fma_f32 v6, v6, v225, v225
  v_mul_f32 v6, s79, v6
  v_exp_f32 v6, v6
  s_nop 0
  v_add_f32 v6, 1.0, v6
  v_rcp_f32 v6, v6
  s_nop 0
  v_mul_f32 v225, v225, v6
  v_cvt_pk_bf16_f32 v226, v226, v226
  v_lshlrev_b32 v226, 16, v226
  v_add_f32 v226, v226, v114
  v_cvt_pk_bf16_f32 v226, v226, v226
  v_lshlrev_b32 v226, 16, v226
  v_mul_f32 v6, v226, v226
  v_mul_f32 v6, s78, v6
  v_fma_f32 v6, v6, v226, v226
  v_mul_f32 v6, s79, v6
  v_exp_f32 v6, v6
  s_nop 0
  v_add_f32 v6, 1.0, v6
  v_rcp_f32 v6, v6
  s_nop 0
  v_mul_f32 v226, v226, v6
  v_cvt_pk_bf16_f32 v227, v227, v227
  v_lshlrev_b32 v227, 16, v227
  v_add_f32 v227, v227, v115
  v_cvt_pk_bf16_f32 v227, v227, v227
  v_lshlrev_b32 v227, 16, v227
  v_mul_f32 v6, v227, v227
  v_mul_f32 v6, s78, v6
  v_fma_f32 v6, v6, v227, v227
  v_mul_f32 v6, s79, v6
  v_exp_f32 v6, v6
  s_nop 0
  v_add_f32 v6, 1.0, v6
  v_rcp_f32 v6, v6
  s_nop 0
  v_mul_f32 v227, v227, v6
  v_cvt_pk_bf16_f32 v64, v224, v225
  v_cvt_pk_bf16_f32 v65, v226, v227
  v_cvt_pk_bf16_f32 v232, v232, v232
  v_lshlrev_b32 v232, 16, v232
  v_add_f32 v232, v232, v116
  v_cvt_pk_bf16_f32 v232, v232, v232
  v_lshlrev_b32 v232, 16, v232
  v_mul_f32 v6, v232, v232
  v_mul_f32 v6, s78, v6
  v_fma_f32 v6, v6, v232, v232
  v_mul_f32 v6, s79, v6
  v_exp_f32 v6, v6
  s_nop 0
  v_add_f32 v6, 1.0, v6
  v_rcp_f32 v6, v6
  s_nop 0
  v_mul_f32 v232, v232, v6
  v_cvt_pk_bf16_f32 v233, v233, v233
  v_lshlrev_b32 v233, 16, v233
  v_add_f32 v233, v233, v117
  v_cvt_pk_bf16_f32 v233, v233, v233
  v_lshlrev_b32 v233, 16, v233
  v_mul_f32 v6, v233, v233
  v_mul_f32 v6, s78, v6
  v_fma_f32 v6, v6, v233, v233
  v_mul_f32 v6, s79, v6
  v_exp_f32 v6, v6
  s_nop 0
  v_add_f32 v6, 1.0, v6
  v_rcp_f32 v6, v6
  s_nop 0
  v_mul_f32 v233, v233, v6
  v_cvt_pk_bf16_f32 v234, v234, v234
  v_lshlrev_b32 v234, 16, v234
  v_add_f32 v234, v234, v118
  v_cvt_pk_bf16_f32 v234, v234, v234
  v_lshlrev_b32 v234, 16, v234
  v_mul_f32 v6, v234, v234
  v_mul_f32 v6, s78, v6
  v_fma_f32 v6, v6, v234, v234
  v_mul_f32 v6, s79, v6
  v_exp_f32 v6, v6
  s_nop 0
  v_add_f32 v6, 1.0, v6
  v_rcp_f32 v6, v6
  s_nop 0
  v_mul_f32 v234, v234, v6
  v_cvt_pk_bf16_f32 v235, v235, v235
  v_lshlrev_b32 v235, 16, v235
  v_add_f32 v235, v235, v119
  v_cvt_pk_bf16_f32 v235, v235, v235
  v_lshlrev_b32 v235, 16, v235
  v_mul_f32 v6, v235, v235
  v_mul_f32 v6, s78, v6
  v_fma_f32 v6, v6, v235, v235
  v_mul_f32 v6, s79, v6
  v_exp_f32 v6, v6
  s_nop 0
  v_add_f32 v6, 1.0, v6
  v_rcp_f32 v6, v6
  s_nop 0
  v_mul_f32 v235, v235, v6
  v_cvt_pk_bf16_f32 v66, v232, v233
  v_cvt_pk_bf16_f32 v67, v234, v235
  s_add_u32 s75, s75, 4096
  buffer_store_dwordx4 v[64:67], v60, s[48:51], s75 offen offset:0 sc1
  v_cvt_pk_bf16_f32 v228, v228, v228
  v_lshlrev_b32 v228, 16, v228
  v_add_f32 v228, v228, v112
  v_cvt_pk_bf16_f32 v228, v228, v228
  v_lshlrev_b32 v228, 16, v228
  v_mul_f32 v6, v228, v228
  v_mul_f32 v6, s78, v6
  v_fma_f32 v6, v6, v228, v228
  v_mul_f32 v6, s79, v6
  v_exp_f32 v6, v6
  s_nop 0
  v_add_f32 v6, 1.0, v6
  v_rcp_f32 v6, v6
  s_nop 0
  v_mul_f32 v228, v228, v6
  v_cvt_pk_bf16_f32 v229, v229, v229
  v_lshlrev_b32 v229, 16, v229
  v_add_f32 v229, v229, v113
  v_cvt_pk_bf16_f32 v229, v229, v229
  v_lshlrev_b32 v229, 16, v229
  v_mul_f32 v6, v229, v229
  v_mul_f32 v6, s78, v6
  v_fma_f32 v6, v6, v229, v229
  v_mul_f32 v6, s79, v6
  v_exp_f32 v6, v6
  s_nop 0
  v_add_f32 v6, 1.0, v6
  v_rcp_f32 v6, v6
  s_nop 0
  v_mul_f32 v229, v229, v6
  v_cvt_pk_bf16_f32 v230, v230, v230
  v_lshlrev_b32 v230, 16, v230
  v_add_f32 v230, v230, v114
  v_cvt_pk_bf16_f32 v230, v230, v230
  v_lshlrev_b32 v230, 16, v230
  v_mul_f32 v6, v230, v230
  v_mul_f32 v6, s78, v6
  v_fma_f32 v6, v6, v230, v230
  v_mul_f32 v6, s79, v6
  v_exp_f32 v6, v6
  s_nop 0
  v_add_f32 v6, 1.0, v6
  v_rcp_f32 v6, v6
  s_nop 0
  v_mul_f32 v230, v230, v6
  v_cvt_pk_bf16_f32 v231, v231, v231
  v_lshlrev_b32 v231, 16, v231
  v_add_f32 v231, v231, v115
  v_cvt_pk_bf16_f32 v231, v231, v231
  v_lshlrev_b32 v231, 16, v231
  v_mul_f32 v6, v231, v231
  v_mul_f32 v6, s78, v6
  v_fma_f32 v6, v6, v231, v231
  v_mul_f32 v6, s79, v6
  v_exp_f32 v6, v6
  s_nop 0
  v_add_f32 v6, 1.0, v6
  v_rcp_f32 v6, v6
  s_nop 0
  v_mul_f32 v231, v231, v6
  v_cvt_pk_bf16_f32 v68, v228, v229
  v_cvt_pk_bf16_f32 v69, v230, v231
  v_cvt_pk_bf16_f32 v236, v236, v236
  v_lshlrev_b32 v236, 16, v236
  v_add_f32 v236, v236, v116
  v_cvt_pk_bf16_f32 v236, v236, v236
  v_lshlrev_b32 v236, 16, v236
  v_mul_f32 v6, v236, v236
  v_mul_f32 v6, s78, v6
  v_fma_f32 v6, v6, v236, v236
  v_mul_f32 v6, s79, v6
  v_exp_f32 v6, v6
  s_nop 0
  v_add_f32 v6, 1.0, v6
  v_rcp_f32 v6, v6
  s_nop 0
  v_mul_f32 v236, v236, v6
  v_cvt_pk_bf16_f32 v237, v237, v237
  v_lshlrev_b32 v237, 16, v237
  v_add_f32 v237, v237, v117
  v_cvt_pk_bf16_f32 v237, v237, v237
  v_lshlrev_b32 v237, 16, v237
  v_mul_f32 v6, v237, v237
  v_mul_f32 v6, s78, v6
  v_fma_f32 v6, v6, v237, v237
  v_mul_f32 v6, s79, v6
  v_exp_f32 v6, v6
  s_nop 0
  v_add_f32 v6, 1.0, v6
  v_rcp_f32 v6, v6
  s_nop 0
  v_mul_f32 v237, v237, v6
  v_cvt_pk_bf16_f32 v238, v238, v238
  v_lshlrev_b32 v238, 16, v238
  v_add_f32 v238, v238, v118
  v_cvt_pk_bf16_f32 v238, v238, v238
  v_lshlrev_b32 v238, 16, v238
  v_mul_f32 v6, v238, v238
  v_mul_f32 v6, s78, v6
  v_fma_f32 v6, v6, v238, v238
  v_mul_f32 v6, s79, v6
  v_exp_f32 v6, v6
  s_nop 0
  v_add_f32 v6, 1.0, v6
  v_rcp_f32 v6, v6
  s_nop 0
  v_mul_f32 v238, v238, v6
  v_cvt_pk_bf16_f32 v239, v239, v239
  v_lshlrev_b32 v239, 16, v239
  v_add_f32 v239, v239, v119
  v_cvt_pk_bf16_f32 v239, v239, v239
  v_lshlrev_b32 v239, 16, v239
  v_mul_f32 v6, v239, v239
  v_mul_f32 v6, s78, v6
  v_fma_f32 v6, v6, v239, v239
  v_mul_f32 v6, s79, v6
  v_exp_f32 v6, v6
  s_nop 0
  v_add_f32 v6, 1.0, v6
  v_rcp_f32 v6, v6
  s_nop 0
  v_mul_f32 v239, v239, v6
  v_cvt_pk_bf16_f32 v70, v236, v237
  v_cvt_pk_bf16_f32 v71, v238, v239
  buffer_store_dwordx4 v[68:71], v60, s[48:51], s75 offen offset:1024 sc1
  v_cvt_pk_bf16_f32 v240, v240, v240
  v_lshlrev_b32 v240, 16, v240
  v_add_f32 v240, v240, v120
  v_cvt_pk_bf16_f32 v240, v240, v240
  v_lshlrev_b32 v240, 16, v240
  v_mul_f32 v6, v240, v240
  v_mul_f32 v6, s78, v6
  v_fma_f32 v6, v6, v240, v240
  v_mul_f32 v6, s79, v6
  v_exp_f32 v6, v6
  s_nop 0
  v_add_f32 v6, 1.0, v6
  v_rcp_f32 v6, v6
  s_nop 0
  v_mul_f32 v240, v240, v6
  v_cvt_pk_bf16_f32 v241, v241, v241
  v_lshlrev_b32 v241, 16, v241
  v_add_f32 v241, v241, v121
  v_cvt_pk_bf16_f32 v241, v241, v241
  v_lshlrev_b32 v241, 16, v241
  v_mul_f32 v6, v241, v241
  v_mul_f32 v6, s78, v6
  v_fma_f32 v6, v6, v241, v241
  v_mul_f32 v6, s79, v6
  v_exp_f32 v6, v6
  s_nop 0
  v_add_f32 v6, 1.0, v6
  v_rcp_f32 v6, v6
  s_nop 0
  v_mul_f32 v241, v241, v6
  v_cvt_pk_bf16_f32 v242, v242, v242
  v_lshlrev_b32 v242, 16, v242
  v_add_f32 v242, v242, v122
  v_cvt_pk_bf16_f32 v242, v242, v242
  v_lshlrev_b32 v242, 16, v242
  v_mul_f32 v6, v242, v242
  v_mul_f32 v6, s78, v6
  v_fma_f32 v6, v6, v242, v242
  v_mul_f32 v6, s79, v6
  v_exp_f32 v6, v6
  s_nop 0
  v_add_f32 v6, 1.0, v6
  v_rcp_f32 v6, v6
  s_nop 0
  v_mul_f32 v242, v242, v6
  v_cvt_pk_bf16_f32 v243, v243, v243
  v_lshlrev_b32 v243, 16, v243
  v_add_f32 v243, v243, v123
  v_cvt_pk_bf16_f32 v243, v243, v243
  v_lshlrev_b32 v243, 16, v243
  v_mul_f32 v6, v243, v243
  v_mul_f32 v6, s78, v6
  v_fma_f32 v6, v6, v243, v243
  v_mul_f32 v6, s79, v6
  v_exp_f32 v6, v6
  s_nop 0
  v_add_f32 v6, 1.0, v6
  v_rcp_f32 v6, v6
  s_nop 0
  v_mul_f32 v243, v243, v6
  v_cvt_pk_bf16_f32 v72, v240, v241
  v_cvt_pk_bf16_f32 v73, v242, v243
  v_cvt_pk_bf16_f32 v248, v248, v248
  v_lshlrev_b32 v248, 16, v248
  v_add_f32 v248, v248, v124
  v_cvt_pk_bf16_f32 v248, v248, v248
  v_lshlrev_b32 v248, 16, v248
  v_mul_f32 v6, v248, v248
  v_mul_f32 v6, s78, v6
  v_fma_f32 v6, v6, v248, v248
  v_mul_f32 v6, s79, v6
  v_exp_f32 v6, v6
  s_nop 0
  v_add_f32 v6, 1.0, v6
  v_rcp_f32 v6, v6
  s_nop 0
  v_mul_f32 v248, v248, v6
  v_cvt_pk_bf16_f32 v249, v249, v249
  v_lshlrev_b32 v249, 16, v249
  v_add_f32 v249, v249, v125
  v_cvt_pk_bf16_f32 v249, v249, v249
  v_lshlrev_b32 v249, 16, v249
  v_mul_f32 v6, v249, v249
  v_mul_f32 v6, s78, v6
  v_fma_f32 v6, v6, v249, v249
  v_mul_f32 v6, s79, v6
  v_exp_f32 v6, v6
  s_nop 0
  v_add_f32 v6, 1.0, v6
  v_rcp_f32 v6, v6
  s_nop 0
  v_mul_f32 v249, v249, v6
  v_cvt_pk_bf16_f32 v250, v250, v250
  v_lshlrev_b32 v250, 16, v250
  v_add_f32 v250, v250, v126
  v_cvt_pk_bf16_f32 v250, v250, v250
  v_lshlrev_b32 v250, 16, v250
  v_mul_f32 v6, v250, v250
  v_mul_f32 v6, s78, v6
  v_fma_f32 v6, v6, v250, v250
  v_mul_f32 v6, s79, v6
  v_exp_f32 v6, v6
  s_nop 0
  v_add_f32 v6, 1.0, v6
  v_rcp_f32 v6, v6
  s_nop 0
  v_mul_f32 v250, v250, v6
  v_cvt_pk_bf16_f32 v251, v251, v251
  v_lshlrev_b32 v251, 16, v251
  v_add_f32 v251, v251, v127
  v_cvt_pk_bf16_f32 v251, v251, v251
  v_lshlrev_b32 v251, 16, v251
  v_mul_f32 v6, v251, v251
  v_mul_f32 v6, s78, v6
  v_fma_f32 v6, v6, v251, v251
  v_mul_f32 v6, s79, v6
  v_exp_f32 v6, v6
  s_nop 0
  v_add_f32 v6, 1.0, v6
  v_rcp_f32 v6, v6
  s_nop 0
  v_mul_f32 v251, v251, v6
  v_cvt_pk_bf16_f32 v74, v248, v249
  v_cvt_pk_bf16_f32 v75, v250, v251
  buffer_store_dwordx4 v[72:75], v60, s[48:51], s75 offen offset:2048 sc1
  v_cvt_pk_bf16_f32 v244, v244, v244
  v_lshlrev_b32 v244, 16, v244
  v_add_f32 v244, v244, v120
  v_cvt_pk_bf16_f32 v244, v244, v244
  v_lshlrev_b32 v244, 16, v244
  v_mul_f32 v6, v244, v244
  v_mul_f32 v6, s78, v6
  v_fma_f32 v6, v6, v244, v244
  v_mul_f32 v6, s79, v6
  v_exp_f32 v6, v6
  s_nop 0
  v_add_f32 v6, 1.0, v6
  v_rcp_f32 v6, v6
  s_nop 0
  v_mul_f32 v244, v244, v6
  v_cvt_pk_bf16_f32 v245, v245, v245
  v_lshlrev_b32 v245, 16, v245
  v_add_f32 v245, v245, v121
  v_cvt_pk_bf16_f32 v245, v245, v245
  v_lshlrev_b32 v245, 16, v245
  v_mul_f32 v6, v245, v245
  v_mul_f32 v6, s78, v6
  v_fma_f32 v6, v6, v245, v245
  v_mul_f32 v6, s79, v6
  v_exp_f32 v6, v6
  s_nop 0
  v_add_f32 v6, 1.0, v6
  v_rcp_f32 v6, v6
  s_nop 0
  v_mul_f32 v245, v245, v6
  v_cvt_pk_bf16_f32 v246, v246, v246
  v_lshlrev_b32 v246, 16, v246
  v_add_f32 v246, v246, v122
  v_cvt_pk_bf16_f32 v246, v246, v246
  v_lshlrev_b32 v246, 16, v246
  v_mul_f32 v6, v246, v246
  v_mul_f32 v6, s78, v6
  v_fma_f32 v6, v6, v246, v246
  v_mul_f32 v6, s79, v6
  v_exp_f32 v6, v6
  s_nop 0
  v_add_f32 v6, 1.0, v6
  v_rcp_f32 v6, v6
  s_nop 0
  v_mul_f32 v246, v246, v6
  v_cvt_pk_bf16_f32 v247, v247, v247
  v_lshlrev_b32 v247, 16, v247
  v_add_f32 v247, v247, v123
  v_cvt_pk_bf16_f32 v247, v247, v247
  v_lshlrev_b32 v247, 16, v247
  v_mul_f32 v6, v247, v247
  v_mul_f32 v6, s78, v6
  v_fma_f32 v6, v6, v247, v247
  v_mul_f32 v6, s79, v6
  v_exp_f32 v6, v6
  s_nop 0
  v_add_f32 v6, 1.0, v6
  v_rcp_f32 v6, v6
  s_nop 0
  v_mul_f32 v247, v247, v6
  v_cvt_pk_bf16_f32 v76, v244, v245
  v_cvt_pk_bf16_f32 v77, v246, v247
  v_cvt_pk_bf16_f32 v252, v252, v252
  v_lshlrev_b32 v252, 16, v252
  v_add_f32 v252, v252, v124
  v_cvt_pk_bf16_f32 v252, v252, v252
  v_lshlrev_b32 v252, 16, v252
  v_mul_f32 v6, v252, v252
  v_mul_f32 v6, s78, v6
  v_fma_f32 v6, v6, v252, v252
  v_mul_f32 v6, s79, v6
  v_exp_f32 v6, v6
  s_nop 0
  v_add_f32 v6, 1.0, v6
  v_rcp_f32 v6, v6
  s_nop 0
  v_mul_f32 v252, v252, v6
  v_cvt_pk_bf16_f32 v253, v253, v253
  v_lshlrev_b32 v253, 16, v253
  v_add_f32 v253, v253, v125
  v_cvt_pk_bf16_f32 v253, v253, v253
  v_lshlrev_b32 v253, 16, v253
  v_mul_f32 v6, v253, v253
  v_mul_f32 v6, s78, v6
  v_fma_f32 v6, v6, v253, v253
  v_mul_f32 v6, s79, v6
  v_exp_f32 v6, v6
  s_nop 0
  v_add_f32 v6, 1.0, v6
  v_rcp_f32 v6, v6
  s_nop 0
  v_mul_f32 v253, v253, v6
  v_cvt_pk_bf16_f32 v254, v254, v254
  v_lshlrev_b32 v254, 16, v254
  v_add_f32 v254, v254, v126
  v_cvt_pk_bf16_f32 v254, v254, v254
  v_lshlrev_b32 v254, 16, v254
  v_mul_f32 v6, v254, v254
  v_mul_f32 v6, s78, v6
  v_fma_f32 v6, v6, v254, v254
  v_mul_f32 v6, s79, v6
  v_exp_f32 v6, v6
  s_nop 0
  v_add_f32 v6, 1.0, v6
  v_rcp_f32 v6, v6
  s_nop 0
  v_mul_f32 v254, v254, v6
  v_cvt_pk_bf16_f32 v255, v255, v255
  v_lshlrev_b32 v255, 16, v255
  v_add_f32 v255, v255, v127
  v_cvt_pk_bf16_f32 v255, v255, v255
  v_lshlrev_b32 v255, 16, v255
  v_mul_f32 v6, v255, v255
  v_mul_f32 v6, s78, v6
  v_fma_f32 v6, v6, v255, v255
  v_mul_f32 v6, s79, v6
  v_exp_f32 v6, v6
  s_nop 0
  v_add_f32 v6, 1.0, v6
  v_rcp_f32 v6, v6
  s_nop 0
  v_mul_f32 v255, v255, v6
  v_cvt_pk_bf16_f32 v78, v252, v253
  v_cvt_pk_bf16_f32 v79, v254, v255
  buffer_store_dwordx4 v[76:79], v60, s[48:51], s75 offen offset:3072 sc1
  s_branch mai_w_signal
mai_w_vz2:
  s_waitcnt vmcnt(0)
  s_barrier
  v_accvgpr_read_b32 v48, a128
  v_accvgpr_read_b32 v49, a129
  v_accvgpr_read_b32 v50, a130
  v_accvgpr_read_b32 v51, a131
  v_accvgpr_read_b32 v52, a132
  v_accvgpr_read_b32 v53, a133
  v_accvgpr_read_b32 v54, a134
  v_accvgpr_read_b32 v55, a135
  v_accvgpr_read_b32 v56, a136
  v_accvgpr_read_b32 v57, a137
  v_accvgpr_read_b32 v58, a138
  v_accvgpr_read_b32 v59, a139
  s_cmp_lt_u32 s93, 2
  s_cbranch_scc1 mai_vz_noiss
  s_mul_i32 s57, s56, 12288
  s_add_u32 s57, s57, 0
  s_add_u32 m0, s57, 0
  s_nop 0
  buffer_load_dwordx4 v48, s[24:27], s88 offen lds
  s_add_u32 m0, s57, 1024
  s_nop 0
  buffer_load_dwordx4 v49, s[24:27], s88 offen lds
  s_add_u32 m0, s57, 2048
  s_nop 0
  buffer_load_dwordx4 v50, s[24:27], s88 offen lds
  s_add_u32 m0, s57, 3072
  s_nop 0
  buffer_load_dwordx4 v51, s[24:27], s88 offen lds
  s_add_u32 m0, s57, 4096
  s_nop 0
  buffer_load_dwordx4 v52, s[24:27], s88 offen lds
  s_add_u32 m0, s57, 5120
  s_nop 0
  buffer_load_dwordx4 v53, s[24:27], s88 offen lds
  s_add_u32 m0, s57, 6144
  s_nop 0
  buffer_load_dwordx4 v54, s[24:27], s88 offen lds
  s_add_u32 m0, s57, 7168
  s_nop 0
  buffer_load_dwordx4 v55, s[24:27], s88 offen lds
  s_add_u32 m0, s57, 8192
  s_nop 0
  buffer_load_dwordx4 v56, s[24:27], s88 offen lds
  s_add_u32 m0, s57, 9216
  s_nop 0
  buffer_load_dwordx4 v57, s[24:27], s88 offen lds
  s_add_u32 m0, s57, 10240
  s_nop 0
  buffer_load_dwordx4 v58, s[24:27], s88 offen lds
  s_add_u32 m0, s57, 11264
  s_nop 0
  buffer_load_dwordx4 v59, s[24:27], s88 offen lds
  s_add_u32 s88, s88, 256
  s_mul_i32 s57, s56, 12288
  s_add_u32 s57, s57, 49152
  s_add_u32 m0, s57, 0
  s_nop 0
  buffer_load_dwordx4 v48, s[24:27], s88 offen lds
  s_add_u32 m0, s57, 1024
  s_nop 0
  buffer_load_dwordx4 v49, s[24:27], s88 offen lds
  s_add_u32 m0, s57, 2048
  s_nop 0
  buffer_load_dwordx4 v50, s[24:27], s88 offen lds
  s_add_u32 m0, s57, 3072
  s_nop 0
  buffer_load_dwordx4 v51, s[24:27], s88 offen lds
  s_add_u32 m0, s57, 4096
  s_nop 0
  buffer_load_dwordx4 v52, s[24:27], s88 offen lds
  s_add_u32 m0, s57, 5120
  s_nop 0
  buffer_load_dwordx4 v53, s[24:27], s88 offen lds
  s_add_u32 m0, s57, 6144
  s_nop 0
  buffer_load_dwordx4 v54, s[24:27], s88 offen lds
  s_add_u32 m0, s57, 7168
  s_nop 0
  buffer_load_dwordx4 v55, s[24:27], s88 offen lds
  s_add_u32 m0, s57, 8192
  s_nop 0
  buffer_load_dwordx4 v56, s[24:27], s88 offen lds
  s_add_u32 m0, s57, 9216
  s_nop 0
  buffer_load_dwordx4 v57, s[24:27], s88 offen lds
  s_add_u32 m0, s57, 10240
  s_nop 0
  buffer_load_dwordx4 v58, s[24:27], s88 offen lds
  s_add_u32 m0, s57, 11264
  s_nop 0
  buffer_load_dwordx4 v59, s[24:27], s88 offen lds
  s_add_u32 s88, s88, 256
mai_vz_noiss:
  v_cvt_pk_bf16_f32 v64, v160, v161
  v_cvt_pk_bf16_f32 v65, v162, v163
  v_cvt_pk_bf16_f32 v66, v168, v169
  v_cvt_pk_bf16_f32 v67, v170, v171
  v_cvt_pk_bf16_f32 v68, v176, v177
  v_cvt_pk_bf16_f32 v69, v178, v179
  v_cvt_pk_bf16_f32 v70, v184, v185
  v_cvt_pk_bf16_f32 v71, v186, v187
  v_cvt_pk_bf16_f32 v72, v192, v193
  v_cvt_pk_bf16_f32 v73, v194, v195
  v_cvt_pk_bf16_f32 v74, v200, v201
  v_cvt_pk_bf16_f32 v75, v202, v203
  v_cvt_pk_bf16_f32 v76, v208, v209
  v_cvt_pk_bf16_f32 v77, v210, v211
  v_cvt_pk_bf16_f32 v78, v216, v217
  v_cvt_pk_bf16_f32 v79, v218, v219
  v_cvt_pk_bf16_f32 v80, v224, v225
  v_cvt_pk_bf16_f32 v81, v226, v227
  v_cvt_pk_bf16_f32 v82, v232, v233
  v_cvt_pk_bf16_f32 v83, v234, v235
  v_cvt_pk_bf16_f32 v84, v240, v241
  v_cvt_pk_bf16_f32 v85, v242, v243
  v_cvt_pk_bf16_f32 v86, v248, v249
  v_cvt_pk_bf16_f32 v87, v250, v251
  v_cvt_pk_bf16_f32 v88, v164, v165
  v_cvt_pk_bf16_f32 v89, v166, v167
  v_cvt_pk_bf16_f32 v90, v172, v173
  v_cvt_pk_bf16_f32 v91, v174, v175
  v_cvt_pk_bf16_f32 v92, v180, v181
  v_cvt_pk_bf16_f32 v93, v182, v183
  v_cvt_pk_bf16_f32 v94, v188, v189
  v_cvt_pk_bf16_f32 v95, v190, v191
  v_cvt_pk_bf16_f32 v96, v196, v197
  v_cvt_pk_bf16_f32 v97, v198, v199
  v_cvt_pk_bf16_f32 v98, v204, v205
  v_cvt_pk_bf16_f32 v99, v206, v207
  v_cvt_pk_bf16_f32 v100, v212, v213
  v_cvt_pk_bf16_f32 v101, v214, v215
  v_cvt_pk_bf16_f32 v102, v220, v221
  v_cvt_pk_bf16_f32 v103, v222, v223
  v_cvt_pk_bf16_f32 v104, v228, v229
  v_cvt_pk_bf16_f32 v105, v230, v231
  v_cvt_pk_bf16_f32 v106, v236, v237
  v_cvt_pk_bf16_f32 v107, v238, v239
  v_cvt_pk_bf16_f32 v108, v244, v245
  v_cvt_pk_bf16_f32 v109, v246, v247
  v_cvt_pk_bf16_f32 v110, v252, v253
  v_cvt_pk_bf16_f32 v111, v254, v255
  v_lshrrev_b32 v2, 4, v1
  v_bfe_u32 v3, v1, 2, 2
  v_and_b32 v4, 3, v1
  v_lshl_add_u32 v5, v2, 2, v3
  v_lshrrev_b32 v7, 1, v5
  v_xor_b32 v7, v7, v5
  v_and_b32 v7, 4, v7
  v_and_b32 v6, 3, v5
  v_or_b32 v6, v6, v7
  v_lshlrev_b32 v6, 1, v6
  v_lshrrev_b32 v7, 1, v4
  v_xor_b32 v7, v7, v6
  v_lshlrev_b32 v32, 8, v5
  v_lshl_add_u32 v32, v7, 4, v32
  v_and_b32 v7, 1, v4
  v_lshl_add_u32 v32, v7, 3, v32
  v_bfe_u32 v7, v1, 3, 1
  v_mul_u32_u24 v33, 16384, v7
  v_and_b32 v7, 7, v1
  v_lshl_add_u32 v33, v7, 6, v33
  v_lshl_add_u32 v33, v2, 4, v33
  s_mul_i32 s78, s89, 1310720
  s_lshl_b32 s57, s77, 9
  s_add_u32 s78, s78, s57
  s_add_u32 s78, s78, 89075712
  s_mul_i32 s57, s92, 262144
  s_add_u32 s78, s78, s57
  s_mov_b32 s79, 0
  s_mov_b32 s80, 98304
  s_mov_b32 s81, 0
mai_vz_chunk:
  s_waitcnt vmcnt(20)
  s_cmp_lt_u32 s79, 3
  s_cbranch_scc1 mai_vzw_38
  s_waitcnt vmcnt(8)
mai_vzw_38:
  s_barrier
  s_sub_u32 s82, s79, 1
  s_mul_i32 s83, s56, 12288
  s_add_u32 s83, s83, s81
  v_xor_b32 v16, 0, v32
  v_add_u32 v16, s80, v16
  v_xor_b32 v17, 32, v32
  v_add_u32 v17, s80, v17
  v_xor_b32 v18, 64, v32
  v_add_u32 v18, s80, v18
  v_xor_b32 v19, 96, v32
  v_add_u32 v19, s80, v19
  v_xor_b32 v20, 128, v32
  v_add_u32 v20, s80, v20
  v_xor_b32 v21, 160, v32
  v_add_u32 v21, s80, v21
  v_xor_b32 v22, 192, v32
  v_add_u32 v22, s80, v22
  v_xor_b32 v23, 224, v32
  v_add_u32 v23, s80, v23
  ds_read_b64_tr_b16 v[112:113], v16 offset:0
  ds_read_b64_tr_b16 v[114:115], v16 offset:4096
  ds_read_b64_tr_b16 v[116:117], v16 offset:8192
  ds_read_b64_tr_b16 v[118:119], v16 offset:12288
  ds_read_b64_tr_b16 v[120:121], v16 offset:16384
  ds_read_b64_tr_b16 v[122:123], v16 offset:20480
  ds_read_b64_tr_b16 v[124:125], v16 offset:24576
  ds_read_b64_tr_b16 v[126:127], v16 offset:28672
  ds_read_b64_tr_b16 v[128:129], v16 offset:32768
  ds_read_b64_tr_b16 v[130:131], v16 offset:36864
  ds_read_b64_tr_b16 v[132:133], v16 offset:40960
  ds_read_b64_tr_b16 v[134:135], v16 offset:45056
  ds_read_b64_tr_b16 v[136:137], v17 offset:0
  ds_read_b64_tr_b16 v[138:139], v17 offset:4096
  ds_read_b64_tr_b16 v[140:141], v17 offset:8192
  ds_read_b64_tr_b16 v[142:143], v17 offset:12288
  ds_read_b64_tr_b16 v[144:145], v17 offset:16384
  ds_read_b64_tr_b16 v[146:147], v17 offset:20480
  ds_read_b64_tr_b16 v[148:149], v17 offset:24576
  ds_read_b64_tr_b16 v[150:151], v17 offset:28672
  ds_read_b64_tr_b16 v[152:153], v17 offset:32768
  ds_read_b64_tr_b16 v[154:155], v17 offset:36864
  ds_read_b64_tr_b16 v[156:157], v17 offset:40960
  ds_read_b64_tr_b16 v[158:159], v17 offset:45056
  s_waitcnt lgkmcnt(12)
  v_mfma_f32_16x16x32_bf16 v[160:163], v[64:67], v[112:115], 0
  ds_read_b64_tr_b16 v[184:185], v18 offset:0
  v_mfma_f32_16x16x32_bf16 v[164:167], v[88:91], v[112:115], 0
  ds_read_b64_tr_b16 v[186:187], v18 offset:4096
  v_mfma_f32_16x16x32_bf16 v[160:163], v[68:71], v[116:119], v[160:163]
  ds_read_b64_tr_b16 v[188:189], v18 offset:8192
  v_mfma_f32_16x16x32_bf16 v[164:167], v[92:95], v[116:119], v[164:167]
  ds_read_b64_tr_b16 v[190:191], v18 offset:12288
  v_mfma_f32_16x16x32_bf16 v[160:163], v[72:75], v[120:123], v[160:163]
  ds_read_b64_tr_b16 v[192:193], v18 offset:16384
  v_mfma_f32_16x16x32_bf16 v[164:167], v[96:99], v[120:123], v[164:167]
  ds_read_b64_tr_b16 v[194:195], v18 offset:20480
  v_mfma_f32_16x16x32_bf16 v[160:163], v[76:79], v[124:127], v[160:163]
  ds_read_b64_tr_b16 v[196:197], v18 offset:24576
  v_mfma_f32_16x16x32_bf16 v[164:167], v[100:103], v[124:127], v[164:167]
  ds_read_b64_tr_b16 v[198:199], v18 offset:28672
  v_mfma_f32_16x16x32_bf16 v[160:163], v[80:83], v[128:131], v[160:163]
  ds_read_b64_tr_b16 v[200:201], v18 offset:32768
  v_mfma_f32_16x16x32_bf16 v[164:167], v[104:107], v[128:131], v[164:167]
  ds_read_b64_tr_b16 v[202:203], v18 offset:36864
  s_cmp_ge_u32 s82, 2
  s_cbranch_scc1 mai_vzi_39
  s_add_u32 m0, s83, 0
  s_nop 0
  buffer_load_dwordx4 v48, s[24:27], s88 offen lds
  s_add_u32 m0, s83, 1024
  s_nop 0
  buffer_load_dwordx4 v49, s[24:27], s88 offen lds
mai_vzi_39:
  v_mfma_f32_16x16x32_bf16 v[160:163], v[84:87], v[132:135], v[160:163]
  ds_read_b64_tr_b16 v[204:205], v18 offset:40960
  v_mfma_f32_16x16x32_bf16 v[164:167], v[108:111], v[132:135], v[164:167]
  ds_read_b64_tr_b16 v[206:207], v18 offset:45056
  s_waitcnt lgkmcnt(12)
  v_mfma_f32_16x16x32_bf16 v[168:171], v[64:67], v[136:139], 0
  ds_read_b64_tr_b16 v[112:113], v19 offset:0
  v_mfma_f32_16x16x32_bf16 v[172:175], v[88:91], v[136:139], 0
  ds_read_b64_tr_b16 v[114:115], v19 offset:4096
  v_mfma_f32_16x16x32_bf16 v[168:171], v[68:71], v[140:143], v[168:171]
  ds_read_b64_tr_b16 v[116:117], v19 offset:8192
  v_mfma_f32_16x16x32_bf16 v[172:175], v[92:95], v[140:143], v[172:175]
  ds_read_b64_tr_b16 v[118:119], v19 offset:12288
  v_mfma_f32_16x16x32_bf16 v[168:171], v[72:75], v[144:147], v[168:171]
  ds_read_b64_tr_b16 v[120:121], v19 offset:16384
  v_mfma_f32_16x16x32_bf16 v[172:175], v[96:99], v[144:147], v[172:175]
  ds_read_b64_tr_b16 v[122:123], v19 offset:20480
  v_mfma_f32_16x16x32_bf16 v[168:171], v[76:79], v[148:151], v[168:171]
  ds_read_b64_tr_b16 v[124:125], v19 offset:24576
  v_mfma_f32_16x16x32_bf16 v[172:175], v[100:103], v[148:151], v[172:175]
  ds_read_b64_tr_b16 v[126:127], v19 offset:28672
  v_cvt_pk_bf16_f32 v176, v160, v161
  v_cvt_pk_bf16_f32 v177, v162, v163
  v_cvt_pk_bf16_f32 v178, v164, v165
  v_cvt_pk_bf16_f32 v179, v166, v167
  buffer_store_dwordx4 v[176:179], v33, s[48:51], s78 offen sc1
  s_add_u32 s78, s78, 32768
  v_mfma_f32_16x16x32_bf16 v[168:171], v[80:83], v[152:155], v[168:171]
  ds_read_b64_tr_b16 v[128:129], v19 offset:32768
  v_mfma_f32_16x16x32_bf16 v[172:175], v[104:107], v[152:155], v[172:175]
  ds_read_b64_tr_b16 v[130:131], v19 offset:36864
  s_cmp_ge_u32 s82, 2
  s_cbranch_scc1 mai_vzi_40
  s_add_u32 m0, s83, 2048
  s_nop 0
  buffer_load_dwordx4 v50, s[24:27], s88 offen lds
  s_add_u32 m0, s83, 3072
  s_nop 0
  buffer_load_dwordx4 v51, s[24:27], s88 offen lds
mai_vzi_40:
  v_mfma_f32_16x16x32_bf16 v[168:171], v[84:87], v[156:159], v[168:171]
  ds_read_b64_tr_b16 v[132:133], v19 offset:40960
  v_mfma_f32_16x16x32_bf16 v[172:175], v[108:111], v[156:159], v[172:175]
  ds_read_b64_tr_b16 v[134:135], v19 offset:45056
  s_waitcnt lgkmcnt(12)
  v_mfma_f32_16x16x32_bf16 v[160:163], v[64:67], v[184:187], 0
  ds_read_b64_tr_b16 v[136:137], v20 offset:0
  v_mfma_f32_16x16x32_bf16 v[164:167], v[88:91], v[184:187], 0
  ds_read_b64_tr_b16 v[138:139], v20 offset:4096
  v_mfma_f32_16x16x32_bf16 v[160:163], v[68:71], v[188:191], v[160:163]
  ds_read_b64_tr_b16 v[140:141], v20 offset:8192
  v_mfma_f32_16x16x32_bf16 v[164:167], v[92:95], v[188:191], v[164:167]
  ds_read_b64_tr_b16 v[142:143], v20 offset:12288
  v_mfma_f32_16x16x32_bf16 v[160:163], v[72:75], v[192:195], v[160:163]
  ds_read_b64_tr_b16 v[144:145], v20 offset:16384
  v_mfma_f32_16x16x32_bf16 v[164:167], v[96:99], v[192:195], v[164:167]
  ds_read_b64_tr_b16 v[146:147], v20 offset:20480
  v_mfma_f32_16x16x32_bf16 v[160:163], v[76:79], v[196:199], v[160:163]
  ds_read_b64_tr_b16 v[148:149], v20 offset:24576
  v_mfma_f32_16x16x32_bf16 v[164:167], v[100:103], v[196:199], v[164:167]
  ds_read_b64_tr_b16 v[150:151], v20 offset:28672
  v_cvt_pk_bf16_f32 v180, v168, v169
  v_cvt_pk_bf16_f32 v181, v170, v171
  v_cvt_pk_bf16_f32 v182, v172, v173
  v_cvt_pk_bf16_f32 v183, v174, v175
  buffer_store_dwordx4 v[180:183], v33, s[48:51], s78 offen sc1
  s_add_u32 s78, s78, 32768
  v_mfma_f32_16x16x32_bf16 v[160:163], v[80:83], v[200:203], v[160:163]
  ds_read_b64_tr_b16 v[152:153], v20 offset:32768
  v_mfma_f32_16x16x32_bf16 v[164:167], v[104:107], v[200:203], v[164:167]
  ds_read_b64_tr_b16 v[154:155], v20 offset:36864
  s_cmp_ge_u32 s82, 2
  s_cbranch_scc1 mai_vzi_41
  s_add_u32 m0, s83, 4096
  s_nop 0
  buffer_load_dwordx4 v52, s[24:27], s88 offen lds
  s_add_u32 m0, s83, 5120
  s_nop 0
  buffer_load_dwordx4 v53, s[24:27], s88 offen lds
mai_vzi_41:
  v_mfma_f32_16x16x32_bf16 v[160:163], v[84:87], v[204:207], v[160:163]
  ds_read_b64_tr_b16 v[156:157], v20 offset:40960
  v_mfma_f32_16x16x32_bf16 v[164:167], v[108:111], v[204:207], v[164:167]
  ds_read_b64_tr_b16 v[158:159], v20 offset:45056
  s_waitcnt lgkmcnt(12)
  v_mfma_f32_16x16x32_bf16 v[168:171], v[64:67], v[112:115], 0
  ds_read_b64_tr_b16 v[184:185], v21 offset:0
  v_mfma_f32_16x16x32_bf16 v[172:175], v[88:91], v[112:115], 0
  ds_read_b64_tr_b16 v[186:187], v21 offset:4096
  v_mfma_f32_16x16x32_bf16 v[168:171], v[68:71], v[116:119], v[168:171]
  ds_read_b64_tr_b16 v[188:189], v21 offset:8192
  v_mfma_f32_16x16x32_bf16 v[172:175], v[92:95], v[116:119], v[172:175]
  ds_read_b64_tr_b16 v[190:191], v21 offset:12288
  v_mfma_f32_16x16x32_bf16 v[168:171], v[72:75], v[120:123], v[168:171]
  ds_read_b64_tr_b16 v[192:193], v21 offset:16384
  v_mfma_f32_16x16x32_bf16 v[172:175], v[96:99], v[120:123], v[172:175]
  ds_read_b64_tr_b16 v[194:195], v21 offset:20480
  v_mfma_f32_16x16x32_bf16 v[168:171], v[76:79], v[124:127], v[168:171]
  ds_read_b64_tr_b16 v[196:197], v21 offset:24576
  v_mfma_f32_16x16x32_bf16 v[172:175], v[100:103], v[124:127], v[172:175]
  ds_read_b64_tr_b16 v[198:199], v21 offset:28672
  v_cvt_pk_bf16_f32 v176, v160, v161
  v_cvt_pk_bf16_f32 v177, v162, v163
  v_cvt_pk_bf16_f32 v178, v164, v165
  v_cvt_pk_bf16_f32 v179, v166, v167
  buffer_store_dwordx4 v[176:179], v33, s[48:51], s78 offen sc1
  s_add_u32 s78, s78, 32768
  v_mfma_f32_16x16x32_bf16 v[168:171], v[80:83], v[128:131], v[168:171]
  ds_read_b64_tr_b16 v[200:201], v21 offset:32768
  v_mfma_f32_16x16x32_bf16 v[172:175], v[104:107], v[128:131], v[172:175]
  ds_read_b64_tr_b16 v[202:203], v21 offset:36864
  s_cmp_ge_u32 s82, 2
  s_cbranch_scc1 mai_vzi_42
  s_add_u32 m0, s83, 6144
  s_nop 0
  buffer_load_dwordx4 v54, s[24:27], s88 offen lds
  s_add_u32 m0, s83, 7168
  s_nop 0
  buffer_load_dwordx4 v55, s[24:27], s88 offen lds
mai_vzi_42:
  v_mfma_f32_16x16x32_bf16 v[168:171], v[84:87], v[132:135], v[168:171]
  ds_read_b64_tr_b16 v[204:205], v21 offset:40960
  v_mfma_f32_16x16x32_bf16 v[172:175], v[108:111], v[132:135], v[172:175]
  ds_read_b64_tr_b16 v[206:207], v21 offset:45056
  s_waitcnt lgkmcnt(12)
  v_mfma_f32_16x16x32_bf16 v[160:163], v[64:67], v[136:139], 0
  ds_read_b64_tr_b16 v[112:113], v22 offset:0
  v_mfma_f32_16x16x32_bf16 v[164:167], v[88:91], v[136:139], 0
  ds_read_b64_tr_b16 v[114:115], v22 offset:4096
  v_mfma_f32_16x16x32_bf16 v[160:163], v[68:71], v[140:143], v[160:163]
  ds_read_b64_tr_b16 v[116:117], v22 offset:8192
  v_mfma_f32_16x16x32_bf16 v[164:167], v[92:95], v[140:143], v[164:167]
  ds_read_b64_tr_b16 v[118:119], v22 offset:12288
  v_mfma_f32_16x16x32_bf16 v[160:163], v[72:75], v[144:147], v[160:163]
  ds_read_b64_tr_b16 v[120:121], v22 offset:16384
  v_mfma_f32_16x16x32_bf16 v[164:167], v[96:99], v[144:147], v[164:167]
  ds_read_b64_tr_b16 v[122:123], v22 offset:20480
  v_mfma_f32_16x16x32_bf16 v[160:163], v[76:79], v[148:151], v[160:163]
  ds_read_b64_tr_b16 v[124:125], v22 offset:24576
  v_mfma_f32_16x16x32_bf16 v[164:167], v[100:103], v[148:151], v[164:167]
  ds_read_b64_tr_b16 v[126:127], v22 offset:28672
  v_cvt_pk_bf16_f32 v180, v168, v169
  v_cvt_pk_bf16_f32 v181, v170, v171
  v_cvt_pk_bf16_f32 v182, v172, v173
  v_cvt_pk_bf16_f32 v183, v174, v175
  buffer_store_dwordx4 v[180:183], v33, s[48:51], s78 offen sc1
  s_add_u32 s78, s78, 32768
  v_mfma_f32_16x16x32_bf16 v[160:163], v[80:83], v[152:155], v[160:163]
  ds_read_b64_tr_b16 v[128:129], v22 offset:32768
  v_mfma_f32_16x16x32_bf16 v[164:167], v[104:107], v[152:155], v[164:167]
  ds_read_b64_tr_b16 v[130:131], v22 offset:36864
  s_cmp_ge_u32 s82, 2
  s_cbranch_scc1 mai_vzi_43
  s_add_u32 m0, s83, 8192
  s_nop 0
  buffer_load_dwordx4 v56, s[24:27], s88 offen lds
  s_add_u32 m0, s83, 9216
  s_nop 0
  buffer_load_dwordx4 v57, s[24:27], s88 offen lds
mai_vzi_43:
  v_mfma_f32_16x16x32_bf16 v[160:163], v[84:87], v[156:159], v[160:163]
  ds_read_b64_tr_b16 v[132:133], v22 offset:40960
  v_mfma_f32_16x16x32_bf16 v[164:167], v[108:111], v[156:159], v[164:167]
  ds_read_b64_tr_b16 v[134:135], v22 offset:45056
  s_waitcnt lgkmcnt(12)
  v_mfma_f32_16x16x32_bf16 v[168:171], v[64:67], v[184:187], 0
  ds_read_b64_tr_b16 v[136:137], v23 offset:0
  v_mfma_f32_16x16x32_bf16 v[172:175], v[88:91], v[184:187], 0
  ds_read_b64_tr_b16 v[138:139], v23 offset:4096
  v_mfma_f32_16x16x32_bf16 v[168:171], v[68:71], v[188:191], v[168:171]
  ds_read_b64_tr_b16 v[140:141], v23 offset:8192
  v_mfma_f32_16x16x32_bf16 v[172:175], v[92:95], v[188:191], v[172:175]
  ds_read_b64_tr_b16 v[142:143], v23 offset:12288
  v_mfma_f32_16x16x32_bf16 v[168:171], v[72:75], v[192:195], v[168:171]
  ds_read_b64_tr_b16 v[144:145], v23 offset:16384
  v_mfma_f32_16x16x32_bf16 v[172:175], v[96:99], v[192:195], v[172:175]
  ds_read_b64_tr_b16 v[146:147], v23 offset:20480
  v_mfma_f32_16x16x32_bf16 v[168:171], v[76:79], v[196:199], v[168:171]
  ds_read_b64_tr_b16 v[148:149], v23 offset:24576
  v_mfma_f32_16x16x32_bf16 v[172:175], v[100:103], v[196:199], v[172:175]
  ds_read_b64_tr_b16 v[150:151], v23 offset:28672
  v_cvt_pk_bf16_f32 v176, v160, v161
  v_cvt_pk_bf16_f32 v177, v162, v163
  v_cvt_pk_bf16_f32 v178, v164, v165
  v_cvt_pk_bf16_f32 v179, v166, v167
  buffer_store_dwordx4 v[176:179], v33, s[48:51], s78 offen sc1
  s_add_u32 s78, s78, 32768
  v_mfma_f32_16x16x32_bf16 v[168:171], v[80:83], v[200:203], v[168:171]
  ds_read_b64_tr_b16 v[152:153], v23 offset:32768
  v_mfma_f32_16x16x32_bf16 v[172:175], v[104:107], v[200:203], v[172:175]
  ds_read_b64_tr_b16 v[154:155], v23 offset:36864
  s_cmp_ge_u32 s82, 2
  s_cbranch_scc1 mai_vzi_44
  s_add_u32 m0, s83, 10240
  s_nop 0
  buffer_load_dwordx4 v58, s[24:27], s88 offen lds
  s_add_u32 m0, s83, 11264
  s_nop 0
  buffer_load_dwordx4 v59, s[24:27], s88 offen lds
  s_add_u32 s88, s88, 256
mai_vzi_44:
  v_mfma_f32_16x16x32_bf16 v[168:171], v[84:87], v[204:207], v[168:171]
  ds_read_b64_tr_b16 v[156:157], v23 offset:40960
  v_mfma_f32_16x16x32_bf16 v[172:175], v[108:111], v[204:207], v[172:175]
  ds_read_b64_tr_b16 v[158:159], v23 offset:45056
  s_waitcnt lgkmcnt(12)
  v_mfma_f32_16x16x32_bf16 v[160:163], v[64:67], v[112:115], 0
  v_mfma_f32_16x16x32_bf16 v[164:167], v[88:91], v[112:115], 0
  v_mfma_f32_16x16x32_bf16 v[160:163], v[68:71], v[116:119], v[160:163]
  v_mfma_f32_16x16x32_bf16 v[164:167], v[92:95], v[116:119], v[164:167]
  v_mfma_f32_16x16x32_bf16 v[160:163], v[72:75], v[120:123], v[160:163]
  v_mfma_f32_16x16x32_bf16 v[164:167], v[96:99], v[120:123], v[164:167]
  v_mfma_f32_16x16x32_bf16 v[160:163], v[76:79], v[124:127], v[160:163]
  v_mfma_f32_16x16x32_bf16 v[164:167], v[100:103], v[124:127], v[164:167]
  v_cvt_pk_bf16_f32 v180, v168, v169
  v_cvt_pk_bf16_f32 v181, v170, v171
  v_cvt_pk_bf16_f32 v182, v172, v173
  v_cvt_pk_bf16_f32 v183, v174, v175
  buffer_store_dwordx4 v[180:183], v33, s[48:51], s78 offen sc1
  s_add_u32 s78, s78, 32768
  v_mfma_f32_16x16x32_bf16 v[160:163], v[80:83], v[128:131], v[160:163]
  v_mfma_f32_16x16x32_bf16 v[164:167], v[104:107], v[128:131], v[164:167]
  v_mfma_f32_16x16x32_bf16 v[160:163], v[84:87], v[132:135], v[160:163]
  v_mfma_f32_16x16x32_bf16 v[164:167], v[108:111], v[132:135], v[164:167]
  s_waitcnt lgkmcnt(0)
  v_mfma_f32_16x16x32_bf16 v[168:171], v[64:67], v[136:139], 0
  v_mfma_f32_16x16x32_bf16 v[172:175], v[88:91], v[136:139], 0
  v_mfma_f32_16x16x32_bf16 v[168:171], v[68:71], v[140:143], v[168:171]
  v_mfma_f32_16x16x32_bf16 v[172:175], v[92:95], v[140:143], v[172:175]
  v_mfma_f32_16x16x32_bf16 v[168:171], v[72:75], v[144:147], v[168:171]
  v_mfma_f32_16x16x32_bf16 v[172:175], v[96:99], v[144:147], v[172:175]
  v_mfma_f32_16x16x32_bf16 v[168:171], v[76:79], v[148:151], v[168:171]
  v_mfma_f32_16x16x32_bf16 v[172:175], v[100:103], v[148:151], v[172:175]
  v_cvt_pk_bf16_f32 v176, v160, v161
  v_cvt_pk_bf16_f32 v177, v162, v163
  v_cvt_pk_bf16_f32 v178, v164, v165
  v_cvt_pk_bf16_f32 v179, v166, v167
  buffer_store_dwordx4 v[176:179], v33, s[48:51], s78 offen sc1
  s_add_u32 s78, s78, 32768
  v_mfma_f32_16x16x32_bf16 v[168:171], v[80:83], v[152:155], v[168:171]
  v_mfma_f32_16x16x32_bf16 v[172:175], v[104:107], v[152:155], v[172:175]
  v_mfma_f32_16x16x32_bf16 v[168:171], v[84:87], v[156:159], v[168:171]
  v_mfma_f32_16x16x32_bf16 v[172:175], v[108:111], v[156:159], v[172:175]
  s_nop 6
  v_cvt_pk_bf16_f32 v180, v168, v169
  v_cvt_pk_bf16_f32 v181, v170, v171
  v_cvt_pk_bf16_f32 v182, v172, v173
  v_cvt_pk_bf16_f32 v183, v174, v175
  buffer_store_dwordx4 v[180:183], v33, s[48:51], s78 offen sc1
  s_add_u32 s78, s78, 32768
  s_mov_b32 s81, s80
  s_add_u32 s80, s80, 49152
  s_cmp_ge_u32 s80, 147456
  s_cselect_b32 s80, 0, s80
  s_add_u32 s79, s79, 1
  s_cmp_lt_u32 s79, s93
  s_cbranch_scc1 mai_vz_chunk
  s_branch mai_w_signal
mai_w_ffn2:
  s_sub_u32 s58, s64, 1664
  s_mul_hi_u32 s57, s58, 858993460
  s_mul_i32 s59, s57, 5
  s_sub_u32 s59, s58, s59
  s_lshl_b32 s73, s57, 7
  s_lshl_b32 s76, s57, 7
  s_add_u32 s78, s76, 4096
  s_add_u32 s76, s76, 6144
  s_lshl_b32 s74, s59, 7
  s_mov_b32 s75, 179253248
  s_mov_b32 s65, 1280
  s_mov_b32 s68, 98304
  s_mov_b32 s67, 172961792
  s_mov_b32 s69, 24
  s_mov_b32 s52, s36
  s_mov_b32 s53, s37
  s_mov_b32 s54, s38
  s_mov_b32 s55, s39
  s_cmp_lg_u32 s56, 0
  s_cbranch_scc1 mai_spindf1_46
  s_mov_b32 s58, 0
mai_spinf1_45:
  buffer_load_dword v2, off, s[48:51], s78 sc1
  s_waitcnt vmcnt(0)
  v_readfirstlane_b32 s57, v2
  s_cmp_ge_u32 s57, 8
  s_cbranch_scc1 mai_spindf1_46
  s_sleep 10
  s_add_u32 s58, s58, 1
  s_cmp_lt_u32 s58, 4194304
  s_cbranch_scc1 mai_spinf1_45
mai_spindf1_46:
  s_barrier
  s_lshl_b32 s66, s74, 1
  v_lshlrev_b32 v60, 4, v1
  s_lshr_b32 s89, s73, 5
  s_add_u32 s89, s89, s56
  s_mul_i32 s57, s89, s68
  s_add_u32 s67, s67, s57
  s_mul_i32 s57, s56, 256
  v_add_u32 v2, s57, v1
  v_lshrrev_b32 v3, 4, v2
  v_and_b32 v4, 15, v2
  v_lshrrev_b32 v2, 1, v3
  v_xor_b32 v2, v2, v3
  v_and_b32 v2, 4, v2
  v_and_b32 v5, 3, v3
  v_or_b32 v5, v5, v2
  v_lshlrev_b32 v5, 1, v5
  v_xor_b32 v4, v4, v5
  v_mul_lo_u32 v48, v3, s65
  v_lshl_add_u32 v48, v4, 4, v48
  v_add_u32 v2, s57, v1
  v_add_u32 v2, 64, v2
  v_lshrrev_b32 v3, 4, v2
  v_and_b32 v4, 15, v2
  v_lshrrev_b32 v2, 1, v3
  v_xor_b32 v2, v2, v3
  v_and_b32 v2, 4, v2
  v_and_b32 v5, 3, v3
  v_or_b32 v5, v5, v2
  v_lshlrev_b32 v5, 1, v5
  v_xor_b32 v4, v4, v5
  v_mul_lo_u32 v49, v3, s65
  v_lshl_add_u32 v49, v4, 4, v49
  v_add_u32 v2, s57, v1
  v_add_u32 v2, 128, v2
  v_lshrrev_b32 v3, 4, v2
  v_and_b32 v4, 15, v2
  v_lshrrev_b32 v2, 1, v3
  v_xor_b32 v2, v2, v3
  v_and_b32 v2, 4, v2
  v_and_b32 v5, 3, v3
  v_or_b32 v5, v5, v2
  v_lshlrev_b32 v5, 1, v5
  v_xor_b32 v4, v4, v5
  v_mul_lo_u32 v50, v3, s65
  v_lshl_add_u32 v50, v4, 4, v50
  v_add_u32 v2, s57, v1
  v_add_u32 v2, 192, v2
  v_lshrrev_b32 v3, 4, v2
  v_and_b32 v4, 15, v2
  v_lshrrev_b32 v2, 1, v3
  v_xor_b32 v2, v2, v3
  v_and_b32 v2, 4, v2
  v_and_b32 v5, 3, v3
  v_or_b32 v5, v5, v2
  v_lshlrev_b32 v5, 1, v5
  v_xor_b32 v4, v4, v5
  v_mul_lo_u32 v51, v3, s65
  v_lshl_add_u32 v51, v4, 4, v51
  v_lshrrev_b32 v2, 4, v1
  v_bfe_u32 v3, v1, 2, 2
  v_and_b32 v4, 3, v1
  v_lshl_add_u32 v5, v2, 2, v3
  v_lshrrev_b32 v7, 1, v5
  v_xor_b32 v7, v7, v5
  v_and_b32 v7, 4, v7
  v_and_b32 v6, 3, v5
  v_or_b32 v6, v6, v7
  v_lshlrev_b32 v6, 1, v6
  v_lshrrev_b32 v7, 1, v4
  v_add_u32 v7, 0, v7
  v_xor_b32 v7, v7, v6
  v_mul_u32_u24 v8, 16, v5
  v_add_u32 v7, v7, v8
  v_and_b32 v8, 1, v4
  v_lshlrev_b32 v8, 3, v8
  v_lshl_add_u32 v32, v7, 4, v8
  v_lshrrev_b32 v7, 1, v4
  v_add_u32 v7, 2, v7
  v_xor_b32 v7, v7, v6
  v_mul_u32_u24 v8, 16, v5
  v_add_u32 v7, v7, v8
  v_and_b32 v8, 1, v4
  v_lshlrev_b32 v8, 3, v8
  v_lshl_add_u32 v33, v7, 4, v8
  v_lshrrev_b32 v7, 1, v4
  v_add_u32 v7, 4, v7
  v_xor_b32 v7, v7, v6
  v_mul_u32_u24 v8, 16, v5
  v_add_u32 v7, v7, v8
  v_and_b32 v8, 1, v4
  v_lshlrev_b32 v8, 3, v8
  v_lshl_add_u32 v34, v7, 4, v8
  v_lshrrev_b32 v7, 1, v4
  v_add_u32 v7, 6, v7
  v_xor_b32 v7, v7, v6
  v_mul_u32_u24 v8, 16, v5
  v_add_u32 v7, v7, v8
  v_and_b32 v8, 1, v4
  v_lshlrev_b32 v8, 3, v8
  v_lshl_add_u32 v35, v7, 4, v8
  v_lshrrev_b32 v7, 1, v4
  v_add_u32 v7, 8, v7
  v_xor_b32 v7, v7, v6
  v_mul_u32_u24 v8, 16, v5
  v_add_u32 v7, v7, v8
  v_and_b32 v8, 1, v4
  v_lshlrev_b32 v8, 3, v8
  v_lshl_add_u32 v36, v7, 4, v8
  v_lshrrev_b32 v7, 1, v4
  v_add_u32 v7, 10, v7
  v_xor_b32 v7, v7, v6
  v_mul_u32_u24 v8, 16, v5
  v_add_u32 v7, v7, v8
  v_and_b32 v8, 1, v4
  v_lshlrev_b32 v8, 3, v8
  v_lshl_add_u32 v37, v7, 4, v8
  v_lshrrev_b32 v7, 1, v4
  v_add_u32 v7, 12, v7
  v_xor_b32 v7, v7, v6
  v_mul_u32_u24 v8, 16, v5
  v_add_u32 v7, v7, v8
  v_and_b32 v8, 1, v4
  v_lshlrev_b32 v8, 3, v8
  v_lshl_add_u32 v38, v7, 4, v8
  v_lshrrev_b32 v7, 1, v4
  v_add_u32 v7, 14, v7
  v_xor_b32 v7, v7, v6
  v_mul_u32_u24 v8, 16, v5
  v_add_u32 v7, v7, v8
  v_and_b32 v8, 1, v4
  v_lshlrev_b32 v8, 3, v8
  v_lshl_add_u32 v39, v7, 4, v8
  v_lshl_add_u32 v5, v2, 2, v3
  v_add_u32 v5, 16, v5
  v_lshrrev_b32 v7, 1, v5
  v_xor_b32 v7, v7, v5
  v_and_b32 v7, 4, v7
  v_and_b32 v6, 3, v5
  v_or_b32 v6, v6, v7
  v_lshlrev_b32 v6, 1, v6
  v_lshrrev_b32 v7, 1, v4
  v_add_u32 v7, 0, v7
  v_xor_b32 v7, v7, v6
  v_mul_u32_u24 v8, 16, v5
  v_add_u32 v7, v7, v8
  v_and_b32 v8, 1, v4
  v_lshlrev_b32 v8, 3, v8
  v_lshl_add_u32 v40, v7, 4, v8
  v_lshrrev_b32 v7, 1, v4
  v_add_u32 v7, 2, v7
  v_xor_b32 v7, v7, v6
  v_mul_u32_u24 v8, 16, v5
  v_add_u32 v7, v7, v8
  v_and_b32 v8, 1, v4
  v_lshlrev_b32 v8, 3, v8
  v_lshl_add_u32 v41, v7, 4, v8
  v_lshrrev_b32 v7, 1, v4
  v_add_u32 v7, 4, v7
  v_xor_b32 v7, v7, v6
  v_mul_u32_u24 v8, 16, v5
  v_add_u32 v7, v7, v8
  v_and_b32 v8, 1, v4
  v_lshlrev_b32 v8, 3, v8
  v_lshl_add_u32 v42, v7, 4, v8
  v_lshrrev_b32 v7, 1, v4
  v_add_u32 v7, 6, v7
  v_xor_b32 v7, v7, v6
  v_mul_u32_u24 v8, 16, v5
  v_add_u32 v7, v7, v8
  v_and_b32 v8, 1, v4
  v_lshlrev_b32 v8, 3, v8
  v_lshl_add_u32 v43, v7, 4, v8
  v_lshrrev_b32 v7, 1, v4
  v_add_u32 v7, 8, v7
  v_xor_b32 v7, v7, v6
  v_mul_u32_u24 v8, 16, v5
  v_add_u32 v7, v7, v8
  v_and_b32 v8, 1, v4
  v_lshlrev_b32 v8, 3, v8
  v_lshl_add_u32 v44, v7, 4, v8
  v_lshrrev_b32 v7, 1, v4
  v_add_u32 v7, 10, v7
  v_xor_b32 v7, v7, v6
  v_mul_u32_u24 v8, 16, v5
  v_add_u32 v7, v7, v8
  v_and_b32 v8, 1, v4
  v_lshlrev_b32 v8, 3, v8
  v_lshl_add_u32 v45, v7, 4, v8
  v_lshrrev_b32 v7, 1, v4
  v_add_u32 v7, 12, v7
  v_xor_b32 v7, v7, v6
  v_mul_u32_u24 v8, 16, v5
  v_add_u32 v7, v7, v8
  v_and_b32 v8, 1, v4
  v_lshlrev_b32 v8, 3, v8
  v_lshl_add_u32 v46, v7, 4, v8
  v_lshrrev_b32 v7, 1, v4
  v_add_u32 v7, 14, v7
  v_xor_b32 v7, v7, v6
  v_mul_u32_u24 v8, 16, v5
  v_add_u32 v7, v7, v8
  v_and_b32 v8, 1, v4
  v_lshlrev_b32 v8, 3, v8
  v_lshl_add_u32 v47, v7, 4, v8
  v_mov_b32 v160, 0
  v_mov_b32 v161, 0
  v_mov_b32 v162, 0
  v_mov_b32 v163, 0
  v_mov_b32 v164, 0
  v_mov_b32 v165, 0
  v_mov_b32 v166, 0
  v_mov_b32 v167, 0
  v_mov_b32 v168, 0
  v_mov_b32 v169, 0
  v_mov_b32 v170, 0
  v_mov_b32 v171, 0
  v_mov_b32 v172, 0
  v_mov_b32 v173, 0
  v_mov_b32 v174, 0
  v_mov_b32 v175, 0
  v_mov_b32 v176, 0
  v_mov_b32 v177, 0
  v_mov_b32 v178, 0
  v_mov_b32 v179, 0
  v_mov_b32 v180, 0
  v_mov_b32 v181, 0
  v_mov_b32 v182, 0
  v_mov_b32 v183, 0
  v_mov_b32 v184, 0
  v_mov_b32 v185, 0
  v_mov_b32 v186, 0
  v_mov_b32 v187, 0
  v_mov_b32 v188, 0
  v_mov_b32 v189, 0
  v_mov_b32 v190, 0
  v_mov_b32 v191, 0
  v_mov_b32 v192, 0
  v_mov_b32 v193, 0
  v_mov_b32 v194, 0
  v_mov_b32 v195, 0
  v_mov_b32 v196, 0
  v_mov_b32 v197, 0
  v_mov_b32 v198, 0
  v_mov_b32 v199, 0
  v_mov_b32 v200, 0
  v_mov_b32 v201, 0
  v_mov_b32 v202, 0
  v_mov_b32 v203, 0
  v_mov_b32 v204, 0
  v_mov_b32 v205, 0
  v_mov_b32 v206, 0
  v_mov_b32 v207, 0
  v_mov_b32 v208, 0
  v_mov_b32 v209, 0
  v_mov_b32 v210, 0
  v_mov_b32 v211, 0
  v_mov_b32 v212, 0
  v_mov_b32 v213, 0
  v_mov_b32 v214, 0
  v_mov_b32 v215, 0
  v_mov_b32 v216, 0
  v_mov_b32 v217, 0
  v_mov_b32 v218, 0
  v_mov_b32 v219, 0
  v_mov_b32 v220, 0
  v_mov_b32 v221, 0
  v_mov_b32 v222, 0
  v_mov_b32 v223, 0
  s_mul_i32 s87, s56, 4096
  s_mov_b32 s85, s66
  s_mov_b32 s86, s67
  s_add_u32 m0, s87, 0
  s_nop 0
  buffer_load_dwordx4 v48, s[52:55], s85 offen lds
  s_add_u32 m0, s87, 1024
  s_nop 0
  buffer_load_dwordx4 v49, s[52:55], s85 offen lds
  s_add_u32 m0, s87, 2048
  s_nop 0
  buffer_load_dwordx4 v50, s[52:55], s85 offen lds
  s_add_u32 m0, s87, 3072
  s_nop 0
  buffer_load_dwordx4 v51, s[52:55], s85 offen lds
  buffer_load_dwordx4 a[0:3], v60, s[48:51], s86 offen offset:0 sc1
  buffer_load_dwordx4 a[4:7], v60, s[48:51], s86 offen offset:1024 sc1
  buffer_load_dwordx4 a[8:11], v60, s[48:51], s86 offen offset:2048 sc1
  buffer_load_dwordx4 a[12:15], v60, s[48:51], s86 offen offset:3072 sc1
  s_lshl_b32 s57, s65, 6
  s_add_u32 s66, s66, s57
  s_add_u32 s67, s67, 4096
  s_mov_b32 s85, s66
  s_mov_b32 s86, s67
  s_add_u32 m0, s87, 16384
  s_nop 0
  buffer_load_dwordx4 v48, s[52:55], s85 offen lds
  s_add_u32 m0, s87, 17408
  s_nop 0
  buffer_load_dwordx4 v49, s[52:55], s85 offen lds
  s_add_u32 m0, s87, 18432
  s_nop 0
  buffer_load_dwordx4 v50, s[52:55], s85 offen lds
  s_add_u32 m0, s87, 19456
  s_nop 0
  buffer_load_dwordx4 v51, s[52:55], s85 offen lds
  buffer_load_dwordx4 a[16:19], v60, s[48:51], s86 offen offset:0 sc1
  buffer_load_dwordx4 a[20:23], v60, s[48:51], s86 offen offset:1024 sc1
  buffer_load_dwordx4 a[24:27], v60, s[48:51], s86 offen offset:2048 sc1
  buffer_load_dwordx4 a[28:31], v60, s[48:51], s86 offen offset:3072 sc1
  s_lshl_b32 s57, s65, 6
  s_add_u32 s66, s66, s57
  s_add_u32 s67, s67, 4096
  s_mov_b32 s85, s66
  s_mov_b32 s86, s67
  s_add_u32 m0, s87, 32768
  s_nop 0
  buffer_load_dwordx4 v48, s[52:55], s85 offen lds
  s_add_u32 m0, s87, 33792
  s_nop 0
  buffer_load_dwordx4 v49, s[52:55], s85 offen lds
  s_add_u32 m0, s87, 34816
  s_nop 0
  buffer_load_dwordx4 v50, s[52:55], s85 offen lds
  s_add_u32 m0, s87, 35840
  s_nop 0
  buffer_load_dwordx4 v51, s[52:55], s85 offen lds
  buffer_load_dwordx4 a[32:35], v60, s[48:51], s86 offen offset:0 sc1
  buffer_load_dwordx4 a[36:39], v60, s[48:51], s86 offen offset:1024 sc1
  buffer_load_dwordx4 a[40:43], v60, s[48:51], s86 offen offset:2048 sc1
  buffer_load_dwordx4 a[44:47], v60, s[48:51], s86 offen offset:3072 sc1
  s_lshl_b32 s57, s65, 6
  s_add_u32 s66, s66, s57
  s_add_u32 s67, s67, 4096
  s_waitcnt vmcnt(16)
  s_barrier
  v_add_u32 v16, 0, v32
  v_add_u32 v17, 0, v33
  v_add_u32 v18, 0, v34
  v_add_u32 v19, 0, v35
  v_add_u32 v20, 0, v36
  v_add_u32 v21, 0, v37
  v_add_u32 v22, 0, v38
  v_add_u32 v23, 0, v39
  v_add_u32 v24, 0, v40
  v_add_u32 v25, 0, v41
  v_add_u32 v26, 0, v42
  v_add_u32 v27, 0, v43
  v_add_u32 v28, 0, v44
  v_add_u32 v29, 0, v45
  v_add_u32 v30, 0, v46
  v_add_u32 v31, 0, v47
  ds_read_b64_tr_b16 v[64:65], v16 offset:0
  ds_read_b64_tr_b16 v[66:67], v24 offset:0
  ds_read_b64_tr_b16 v[68:69], v17 offset:0
  ds_read_b64_tr_b16 v[70:71], v25 offset:0
  ds_read_b64_tr_b16 v[72:73], v18 offset:0
  ds_read_b64_tr_b16 v[74:75], v26 offset:0
  ds_read_b64_tr_b16 v[76:77], v19 offset:0
  ds_read_b64_tr_b16 v[78:79], v27 offset:0
  ds_read_b64_tr_b16 v[80:81], v20 offset:0
  ds_read_b64_tr_b16 v[82:83], v28 offset:0
  ds_read_b64_tr_b16 v[84:85], v21 offset:0
  ds_read_b64_tr_b16 v[86:87], v29 offset:0
  ds_read_b64_tr_b16 v[88:89], v22 offset:0
  ds_read_b64_tr_b16 v[90:91], v30 offset:0
  ds_read_b64_tr_b16 v[92:93], v23 offset:0
  ds_read_b64_tr_b16 v[94:95], v31 offset:0
  s_waitcnt lgkmcnt(0)
  s_mov_b32 s70, 0
mai_g1loopb:
  s_add_u32 s58, s70, 3
  s_cmp_lt_u32 s58, s69
  s_cselect_b32 s85, s66, 1073741824
  s_cselect_b32 s86, s67, 1073741824
  s_lshl_b32 s57, s65, 6
  s_add_u32 s66, s66, s57
  s_add_u32 s67, s67, 4096
  s_waitcnt vmcnt(8)
  s_barrier
  v_mfma_f32_16x16x32_bf16 v[160:163], v[64:67], a[0:3], v[160:163]
  ds_read_b64_tr_b16 v[112:113], v16 offset:8192
  ds_read_b64_tr_b16 v[114:115], v24 offset:8192
  v_mfma_f32_16x16x32_bf16 v[164:167], v[64:67], a[4:7], v[164:167]
  ds_read_b64_tr_b16 v[116:117], v17 offset:8192
  ds_read_b64_tr_b16 v[118:119], v25 offset:8192
  v_mfma_f32_16x16x32_bf16 v[168:171], v[68:71], a[0:3], v[168:171]
  ds_read_b64_tr_b16 v[120:121], v18 offset:8192
  ds_read_b64_tr_b16 v[122:123], v26 offset:8192
  v_mfma_f32_16x16x32_bf16 v[172:175], v[68:71], a[4:7], v[172:175]
  ds_read_b64_tr_b16 v[124:125], v19 offset:8192
  ds_read_b64_tr_b16 v[126:127], v27 offset:8192
  v_mfma_f32_16x16x32_bf16 v[176:179], v[72:75], a[0:3], v[176:179]
  ds_read_b64_tr_b16 v[128:129], v20 offset:8192
  ds_read_b64_tr_b16 v[130:131], v28 offset:8192
  v_mfma_f32_16x16x32_bf16 v[180:183], v[72:75], a[4:7], v[180:183]
  ds_read_b64_tr_b16 v[132:133], v21 offset:8192
  ds_read_b64_tr_b16 v[134:135], v29 offset:8192
  v_mfma_f32_16x16x32_bf16 v[184:187], v[76:79], a[0:3], v[184:187]
  ds_read_b64_tr_b16 v[136:137], v22 offset:8192
  ds_read_b64_tr_b16 v[138:139], v30 offset:8192
  v_mfma_f32_16x16x32_bf16 v[188:191], v[76:79], a[4:7], v[188:191]
  ds_read_b64_tr_b16 v[140:141], v23 offset:8192
  ds_read_b64_tr_b16 v[142:143], v31 offset:8192
  v_mfma_f32_16x16x32_bf16 v[192:195], v[80:83], a[0:3], v[192:195]
  s_add_u32 m0, s87, 49152
  v_mfma_f32_16x16x32_bf16 v[196:199], v[80:83], a[4:7], v[196:199]
  buffer_load_dwordx4 v48, s[52:55], s85 offen lds
  v_mfma_f32_16x16x32_bf16 v[200:203], v[84:87], a[0:3], v[200:203]
  s_add_u32 m0, s87, 50176
  v_mfma_f32_16x16x32_bf16 v[204:207], v[84:87], a[4:7], v[204:207]
  buffer_load_dwordx4 v49, s[52:55], s85 offen lds
  v_mfma_f32_16x16x32_bf16 v[208:211], v[88:91], a[0:3], v[208:211]
  s_add_u32 m0, s87, 51200
  v_mfma_f32_16x16x32_bf16 v[212:215], v[88:91], a[4:7], v[212:215]
  buffer_load_dwordx4 v50, s[52:55], s85 offen lds
  v_add_u32 v16, 16384, v32
  v_add_u32 v17, 16384, v33
  v_mfma_f32_16x16x32_bf16 v[216:219], v[92:95], a[0:3], v[216:219]
  v_add_u32 v18, 16384, v34
  v_add_u32 v19, 16384, v35
  v_mfma_f32_16x16x32_bf16 v[220:223], v[92:95], a[4:7], v[220:223]
  v_add_u32 v20, 16384, v36
  v_add_u32 v21, 16384, v37
  v_add_u32 v22, 16384, v38
  v_add_u32 v23, 16384, v39
  v_add_u32 v24, 16384, v40
  v_add_u32 v25, 16384, v41
  v_add_u32 v26, 16384, v42
  v_add_u32 v27, 16384, v43
  v_add_u32 v28, 16384, v44
  v_add_u32 v29, 16384, v45
  v_add_u32 v30, 16384, v46
  v_add_u32 v31, 16384, v47
  s_waitcnt lgkmcnt(0)
  v_mfma_f32_16x16x32_bf16 v[160:163], v[112:115], a[8:11], v[160:163]
  ds_read_b64_tr_b16 v[64:65], v16 offset:0
  ds_read_b64_tr_b16 v[66:67], v24 offset:0
  v_mfma_f32_16x16x32_bf16 v[164:167], v[112:115], a[12:15], v[164:167]
  ds_read_b64_tr_b16 v[68:69], v17 offset:0
  ds_read_b64_tr_b16 v[70:71], v25 offset:0
  v_mfma_f32_16x16x32_bf16 v[168:171], v[116:119], a[8:11], v[168:171]
  ds_read_b64_tr_b16 v[72:73], v18 offset:0
  ds_read_b64_tr_b16 v[74:75], v26 offset:0
  v_mfma_f32_16x16x32_bf16 v[172:175], v[116:119], a[12:15], v[172:175]
  ds_read_b64_tr_b16 v[76:77], v19 offset:0
  ds_read_b64_tr_b16 v[78:79], v27 offset:0
  v_mfma_f32_16x16x32_bf16 v[176:179], v[120:123], a[8:11], v[176:179]
  ds_read_b64_tr_b16 v[80:81], v20 offset:0
  ds_read_b64_tr_b16 v[82:83], v28 offset:0
  v_mfma_f32_16x16x32_bf16 v[180:183], v[120:123], a[12:15], v[180:183]
  ds_read_b64_tr_b16 v[84:85], v21 offset:0
  ds_read_b64_tr_b16 v[86:87], v29 offset:0
  v_mfma_f32_16x16x32_bf16 v[184:187], v[124:127], a[8:11], v[184:187]
  ds_read_b64_tr_b16 v[88:89], v22 offset:0
  ds_read_b64_tr_b16 v[90:91], v30 offset:0
  v_mfma_f32_16x16x32_bf16 v[188:191], v[124:127], a[12:15], v[188:191]
  ds_read_b64_tr_b16 v[92:93], v23 offset:0
  ds_read_b64_tr_b16 v[94:95], v31 offset:0
  v_mfma_f32_16x16x32_bf16 v[192:195], v[128:131], a[8:11], v[192:195]
  s_add_u32 m0, s87, 52224
  v_mfma_f32_16x16x32_bf16 v[196:199], v[128:131], a[12:15], v[196:199]
  buffer_load_dwordx4 v51, s[52:55], s85 offen lds
  v_mfma_f32_16x16x32_bf16 v[200:203], v[132:135], a[8:11], v[200:203]
  buffer_load_dwordx4 a[48:51], v60, s[48:51], s86 offen offset:0 sc1
  v_mfma_f32_16x16x32_bf16 v[204:207], v[132:135], a[12:15], v[204:207]
  buffer_load_dwordx4 a[52:55], v60, s[48:51], s86 offen offset:1024 sc1
  v_mfma_f32_16x16x32_bf16 v[208:211], v[136:139], a[8:11], v[208:211]
  buffer_load_dwordx4 a[56:59], v60, s[48:51], s86 offen offset:2048 sc1
  v_mfma_f32_16x16x32_bf16 v[212:215], v[136:139], a[12:15], v[212:215]
  buffer_load_dwordx4 a[60:63], v60, s[48:51], s86 offen offset:3072 sc1
  v_mfma_f32_16x16x32_bf16 v[216:219], v[140:143], a[8:11], v[216:219]
  v_mfma_f32_16x16x32_bf16 v[220:223], v[140:143], a[12:15], v[220:223]
  s_waitcnt lgkmcnt(0)
  s_add_u32 s70, s70, 1
  s_cmp_ge_u32 s70, s69
  s_cbranch_scc1 mai_g1endb
  s_add_u32 s58, s70, 3
  s_cmp_lt_u32 s58, s69
  s_cselect_b32 s85, s66, 1073741824
  s_cselect_b32 s86, s67, 1073741824
  s_lshl_b32 s57, s65, 6
  s_add_u32 s66, s66, s57
  s_add_u32 s67, s67, 4096
  s_waitcnt vmcnt(8)
  s_barrier
  v_mfma_f32_16x16x32_bf16 v[160:163], v[64:67], a[16:19], v[160:163]
  ds_read_b64_tr_b16 v[112:113], v16 offset:8192
  ds_read_b64_tr_b16 v[114:115], v24 offset:8192
  v_mfma_f32_16x16x32_bf16 v[164:167], v[64:67], a[20:23], v[164:167]
  ds_read_b64_tr_b16 v[116:117], v17 offset:8192
  ds_read_b64_tr_b16 v[118:119], v25 offset:8192
  v_mfma_f32_16x16x32_bf16 v[168:171], v[68:71], a[16:19], v[168:171]
  ds_read_b64_tr_b16 v[120:121], v18 offset:8192
  ds_read_b64_tr_b16 v[122:123], v26 offset:8192
  v_mfma_f32_16x16x32_bf16 v[172:175], v[68:71], a[20:23], v[172:175]
  ds_read_b64_tr_b16 v[124:125], v19 offset:8192
  ds_read_b64_tr_b16 v[126:127], v27 offset:8192
  v_mfma_f32_16x16x32_bf16 v[176:179], v[72:75], a[16:19], v[176:179]
  ds_read_b64_tr_b16 v[128:129], v20 offset:8192
  ds_read_b64_tr_b16 v[130:131], v28 offset:8192
  v_mfma_f32_16x16x32_bf16 v[180:183], v[72:75], a[20:23], v[180:183]
  ds_read_b64_tr_b16 v[132:133], v21 offset:8192
  ds_read_b64_tr_b16 v[134:135], v29 offset:8192
  v_mfma_f32_16x16x32_bf16 v[184:187], v[76:79], a[16:19], v[184:187]
  ds_read_b64_tr_b16 v[136:137], v22 offset:8192
  ds_read_b64_tr_b16 v[138:139], v30 offset:8192
  v_mfma_f32_16x16x32_bf16 v[188:191], v[76:79], a[20:23], v[188:191]
  ds_read_b64_tr_b16 v[140:141], v23 offset:8192
  ds_read_b64_tr_b16 v[142:143], v31 offset:8192
  v_mfma_f32_16x16x32_bf16 v[192:195], v[80:83], a[16:19], v[192:195]
  s_add_u32 m0, s87, 0
  v_mfma_f32_16x16x32_bf16 v[196:199], v[80:83], a[20:23], v[196:199]
  buffer_load_dwordx4 v48, s[52:55], s85 offen lds
  v_mfma_f32_16x16x32_bf16 v[200:203], v[84:87], a[16:19], v[200:203]
  s_add_u32 m0, s87, 1024
  v_mfma_f32_16x16x32_bf16 v[204:207], v[84:87], a[20:23], v[204:207]
  buffer_load_dwordx4 v49, s[52:55], s85 offen lds
  v_mfma_f32_16x16x32_bf16 v[208:211], v[88:91], a[16:19], v[208:211]
  s_add_u32 m0, s87, 2048
  v_mfma_f32_16x16x32_bf16 v[212:215], v[88:91], a[20:23], v[212:215]
  buffer_load_dwordx4 v50, s[52:55], s85 offen lds
  v_add_u32 v16, 32768, v32
  v_add_u32 v17, 32768, v33
  v_mfma_f32_16x16x32_bf16 v[216:219], v[92:95], a[16:19], v[216:219]
  v_add_u32 v18, 32768, v34
  v_add_u32 v19, 32768, v35
  v_mfma_f32_16x16x32_bf16 v[220:223], v[92:95], a[20:23], v[220:223]
  v_add_u32 v20, 32768, v36
  v_add_u32 v21, 32768, v37
  v_add_u32 v22, 32768, v38
  v_add_u32 v23, 32768, v39
  v_add_u32 v24, 32768, v40
  v_add_u32 v25, 32768, v41
  v_add_u32 v26, 32768, v42
  v_add_u32 v27, 32768, v43
  v_add_u32 v28, 32768, v44
  v_add_u32 v29, 32768, v45
  v_add_u32 v30, 32768, v46
  v_add_u32 v31, 32768, v47
  s_waitcnt lgkmcnt(0)
  v_mfma_f32_16x16x32_bf16 v[160:163], v[112:115], a[24:27], v[160:163]
  ds_read_b64_tr_b16 v[64:65], v16 offset:0
  ds_read_b64_tr_b16 v[66:67], v24 offset:0
  v_mfma_f32_16x16x32_bf16 v[164:167], v[112:115], a[28:31], v[164:167]
  ds_read_b64_tr_b16 v[68:69], v17 offset:0
  ds_read_b64_tr_b16 v[70:71], v25 offset:0
  v_mfma_f32_16x16x32_bf16 v[168:171], v[116:119], a[24:27], v[168:171]
  ds_read_b64_tr_b16 v[72:73], v18 offset:0
  ds_read_b64_tr_b16 v[74:75], v26 offset:0
  v_mfma_f32_16x16x32_bf16 v[172:175], v[116:119], a[28:31], v[172:175]
  ds_read_b64_tr_b16 v[76:77], v19 offset:0
  ds_read_b64_tr_b16 v[78:79], v27 offset:0
  v_mfma_f32_16x16x32_bf16 v[176:179], v[120:123], a[24:27], v[176:179]
  ds_read_b64_tr_b16 v[80:81], v20 offset:0
  ds_read_b64_tr_b16 v[82:83], v28 offset:0
  v_mfma_f32_16x16x32_bf16 v[180:183], v[120:123], a[28:31], v[180:183]
  ds_read_b64_tr_b16 v[84:85], v21 offset:0
  ds_read_b64_tr_b16 v[86:87], v29 offset:0
  v_mfma_f32_16x16x32_bf16 v[184:187], v[124:127], a[24:27], v[184:187]
  ds_read_b64_tr_b16 v[88:89], v22 offset:0
  ds_read_b64_tr_b16 v[90:91], v30 offset:0
  v_mfma_f32_16x16x32_bf16 v[188:191], v[124:127], a[28:31], v[188:191]
  ds_read_b64_tr_b16 v[92:93], v23 offset:0
  ds_read_b64_tr_b16 v[94:95], v31 offset:0
  v_mfma_f32_16x16x32_bf16 v[192:195], v[128:131], a[24:27], v[192:195]
  s_add_u32 m0, s87, 3072
  v_mfma_f32_16x16x32_bf16 v[196:199], v[128:131], a[28:31], v[196:199]
  buffer_load_dwordx4 v51, s[52:55], s85 offen lds
  v_mfma_f32_16x16x32_bf16 v[200:203], v[132:135], a[24:27], v[200:203]
  buffer_load_dwordx4 a[0:3], v60, s[48:51], s86 offen offset:0 sc1
  v_mfma_f32_16x16x32_bf16 v[204:207], v[132:135], a[28:31], v[204:207]
  buffer_load_dwordx4 a[4:7], v60, s[48:51], s86 offen offset:1024 sc1
  v_mfma_f32_16x16x32_bf16 v[208:211], v[136:139], a[24:27], v[208:211]
  buffer_load_dwordx4 a[8:11], v60, s[48:51], s86 offen offset:2048 sc1
  v_mfma_f32_16x16x32_bf16 v[212:215], v[136:139], a[28:31], v[212:215]
  buffer_load_dwordx4 a[12:15], v60, s[48:51], s86 offen offset:3072 sc1
  v_mfma_f32_16x16x32_bf16 v[216:219], v[140:143], a[24:27], v[216:219]
  v_mfma_f32_16x16x32_bf16 v[220:223], v[140:143], a[28:31], v[220:223]
  s_waitcnt lgkmcnt(0)
  s_add_u32 s70, s70, 1
  s_cmp_ge_u32 s70, s69
  s_cbranch_scc1 mai_g1endb
  s_add_u32 s58, s70, 3
  s_cmp_lt_u32 s58, s69
  s_cselect_b32 s85, s66, 1073741824
  s_cselect_b32 s86, s67, 1073741824
  s_lshl_b32 s57, s65, 6
  s_add_u32 s66, s66, s57
  s_add_u32 s67, s67, 4096
  s_waitcnt vmcnt(8)
  s_barrier
  v_mfma_f32_16x16x32_bf16 v[160:163], v[64:67], a[32:35], v[160:163]
  ds_read_b64_tr_b16 v[112:113], v16 offset:8192
  ds_read_b64_tr_b16 v[114:115], v24 offset:8192
  v_mfma_f32_16x16x32_bf16 v[164:167], v[64:67], a[36:39], v[164:167]
  ds_read_b64_tr_b16 v[116:117], v17 offset:8192
  ds_read_b64_tr_b16 v[118:119], v25 offset:8192
  v_mfma_f32_16x16x32_bf16 v[168:171], v[68:71], a[32:35], v[168:171]
  ds_read_b64_tr_b16 v[120:121], v18 offset:8192
  ds_read_b64_tr_b16 v[122:123], v26 offset:8192
  v_mfma_f32_16x16x32_bf16 v[172:175], v[68:71], a[36:39], v[172:175]
  ds_read_b64_tr_b16 v[124:125], v19 offset:8192
  ds_read_b64_tr_b16 v[126:127], v27 offset:8192
  v_mfma_f32_16x16x32_bf16 v[176:179], v[72:75], a[32:35], v[176:179]
  ds_read_b64_tr_b16 v[128:129], v20 offset:8192
  ds_read_b64_tr_b16 v[130:131], v28 offset:8192
  v_mfma_f32_16x16x32_bf16 v[180:183], v[72:75], a[36:39], v[180:183]
  ds_read_b64_tr_b16 v[132:133], v21 offset:8192
  ds_read_b64_tr_b16 v[134:135], v29 offset:8192
  v_mfma_f32_16x16x32_bf16 v[184:187], v[76:79], a[32:35], v[184:187]
  ds_read_b64_tr_b16 v[136:137], v22 offset:8192
  ds_read_b64_tr_b16 v[138:139], v30 offset:8192
  v_mfma_f32_16x16x32_bf16 v[188:191], v[76:79], a[36:39], v[188:191]
  ds_read_b64_tr_b16 v[140:141], v23 offset:8192
  ds_read_b64_tr_b16 v[142:143], v31 offset:8192
  v_mfma_f32_16x16x32_bf16 v[192:195], v[80:83], a[32:35], v[192:195]
  s_add_u32 m0, s87, 16384
  v_mfma_f32_16x16x32_bf16 v[196:199], v[80:83], a[36:39], v[196:199]
  buffer_load_dwordx4 v48, s[52:55], s85 offen lds
  v_mfma_f32_16x16x32_bf16 v[200:203], v[84:87], a[32:35], v[200:203]
  s_add_u32 m0, s87, 17408
  v_mfma_f32_16x16x32_bf16 v[204:207], v[84:87], a[36:39], v[204:207]
  buffer_load_dwordx4 v49, s[52:55], s85 offen lds
  v_mfma_f32_16x16x32_bf16 v[208:211], v[88:91], a[32:35], v[208:211]
  s_add_u32 m0, s87, 18432
  v_mfma_f32_16x16x32_bf16 v[212:215], v[88:91], a[36:39], v[212:215]
  buffer_load_dwordx4 v50, s[52:55], s85 offen lds
  v_add_u32 v16, 49152, v32
  v_add_u32 v17, 49152, v33
  v_mfma_f32_16x16x32_bf16 v[216:219], v[92:95], a[32:35], v[216:219]
  v_add_u32 v18, 49152, v34
  v_add_u32 v19, 49152, v35
  v_mfma_f32_16x16x32_bf16 v[220:223], v[92:95], a[36:39], v[220:223]
  v_add_u32 v20, 49152, v36
  v_add_u32 v21, 49152, v37
  v_add_u32 v22, 49152, v38
  v_add_u32 v23, 49152, v39
  v_add_u32 v24, 49152, v40
  v_add_u32 v25, 49152, v41
  v_add_u32 v26, 49152, v42
  v_add_u32 v27, 49152, v43
  v_add_u32 v28, 49152, v44
  v_add_u32 v29, 49152, v45
  v_add_u32 v30, 49152, v46
  v_add_u32 v31, 49152, v47
  s_waitcnt lgkmcnt(0)
  v_mfma_f32_16x16x32_bf16 v[160:163], v[112:115], a[40:43], v[160:163]
  ds_read_b64_tr_b16 v[64:65], v16 offset:0
  ds_read_b64_tr_b16 v[66:67], v24 offset:0
  v_mfma_f32_16x16x32_bf16 v[164:167], v[112:115], a[44:47], v[164:167]
  ds_read_b64_tr_b16 v[68:69], v17 offset:0
  ds_read_b64_tr_b16 v[70:71], v25 offset:0
  v_mfma_f32_16x16x32_bf16 v[168:171], v[116:119], a[40:43], v[168:171]
  ds_read_b64_tr_b16 v[72:73], v18 offset:0
  ds_read_b64_tr_b16 v[74:75], v26 offset:0
  v_mfma_f32_16x16x32_bf16 v[172:175], v[116:119], a[44:47], v[172:175]
  ds_read_b64_tr_b16 v[76:77], v19 offset:0
  ds_read_b64_tr_b16 v[78:79], v27 offset:0
  v_mfma_f32_16x16x32_bf16 v[176:179], v[120:123], a[40:43], v[176:179]
  ds_read_b64_tr_b16 v[80:81], v20 offset:0
  ds_read_b64_tr_b16 v[82:83], v28 offset:0
  v_mfma_f32_16x16x32_bf16 v[180:183], v[120:123], a[44:47], v[180:183]
  ds_read_b64_tr_b16 v[84:85], v21 offset:0
  ds_read_b64_tr_b16 v[86:87], v29 offset:0
  v_mfma_f32_16x16x32_bf16 v[184:187], v[124:127], a[40:43], v[184:187]
  ds_read_b64_tr_b16 v[88:89], v22 offset:0
  ds_read_b64_tr_b16 v[90:91], v30 offset:0
  v_mfma_f32_16x16x32_bf16 v[188:191], v[124:127], a[44:47], v[188:191]
  ds_read_b64_tr_b16 v[92:93], v23 offset:0
  ds_read_b64_tr_b16 v[94:95], v31 offset:0
  v_mfma_f32_16x16x32_bf16 v[192:195], v[128:131], a[40:43], v[192:195]
  s_add_u32 m0, s87, 19456
  v_mfma_f32_16x16x32_bf16 v[196:199], v[128:131], a[44:47], v[196:199]
  buffer_load_dwordx4 v51, s[52:55], s85 offen lds
  v_mfma_f32_16x16x32_bf16 v[200:203], v[132:135], a[40:43], v[200:203]
  buffer_load_dwordx4 a[16:19], v60, s[48:51], s86 offen offset:0 sc1
  v_mfma_f32_16x16x32_bf16 v[204:207], v[132:135], a[44:47], v[204:207]
  buffer_load_dwordx4 a[20:23], v60, s[48:51], s86 offen offset:1024 sc1
  v_mfma_f32_16x16x32_bf16 v[208:211], v[136:139], a[40:43], v[208:211]
  buffer_load_dwordx4 a[24:27], v60, s[48:51], s86 offen offset:2048 sc1
  v_mfma_f32_16x16x32_bf16 v[212:215], v[136:139], a[44:47], v[212:215]
  buffer_load_dwordx4 a[28:31], v60, s[48:51], s86 offen offset:3072 sc1
  v_mfma_f32_16x16x32_bf16 v[216:219], v[140:143], a[40:43], v[216:219]
  v_mfma_f32_16x16x32_bf16 v[220:223], v[140:143], a[44:47], v[220:223]
  s_waitcnt lgkmcnt(0)
  s_add_u32 s70, s70, 1
  s_cmp_ge_u32 s70, s69
  s_cbranch_scc1 mai_g1endb
  s_add_u32 s58, s70, 3
  s_cmp_lt_u32 s58, s69
  s_cselect_b32 s85, s66, 1073741824
  s_cselect_b32 s86, s67, 1073741824
  s_lshl_b32 s57, s65, 6
  s_add_u32 s66, s66, s57
  s_add_u32 s67, s67, 4096
  s_waitcnt vmcnt(8)
  s_barrier
  v_mfma_f32_16x16x32_bf16 v[160:163], v[64:67], a[48:51], v[160:163]
  ds_read_b64_tr_b16 v[112:113], v16 offset:8192
  ds_read_b64_tr_b16 v[114:115], v24 offset:8192
  v_mfma_f32_16x16x32_bf16 v[164:167], v[64:67], a[52:55], v[164:167]
  ds_read_b64_tr_b16 v[116:117], v17 offset:8192
  ds_read_b64_tr_b16 v[118:119], v25 offset:8192
  v_mfma_f32_16x16x32_bf16 v[168:171], v[68:71], a[48:51], v[168:171]
  ds_read_b64_tr_b16 v[120:121], v18 offset:8192
  ds_read_b64_tr_b16 v[122:123], v26 offset:8192
  v_mfma_f32_16x16x32_bf16 v[172:175], v[68:71], a[52:55], v[172:175]
  ds_read_b64_tr_b16 v[124:125], v19 offset:8192
  ds_read_b64_tr_b16 v[126:127], v27 offset:8192
  v_mfma_f32_16x16x32_bf16 v[176:179], v[72:75], a[48:51], v[176:179]
  ds_read_b64_tr_b16 v[128:129], v20 offset:8192
  ds_read_b64_tr_b16 v[130:131], v28 offset:8192
  v_mfma_f32_16x16x32_bf16 v[180:183], v[72:75], a[52:55], v[180:183]
  ds_read_b64_tr_b16 v[132:133], v21 offset:8192
  ds_read_b64_tr_b16 v[134:135], v29 offset:8192
  v_mfma_f32_16x16x32_bf16 v[184:187], v[76:79], a[48:51], v[184:187]
  ds_read_b64_tr_b16 v[136:137], v22 offset:8192
  ds_read_b64_tr_b16 v[138:139], v30 offset:8192
  v_mfma_f32_16x16x32_bf16 v[188:191], v[76:79], a[52:55], v[188:191]
  ds_read_b64_tr_b16 v[140:141], v23 offset:8192
  ds_read_b64_tr_b16 v[142:143], v31 offset:8192
  v_mfma_f32_16x16x32_bf16 v[192:195], v[80:83], a[48:51], v[192:195]
  s_add_u32 m0, s87, 32768
  v_mfma_f32_16x16x32_bf16 v[196:199], v[80:83], a[52:55], v[196:199]
  buffer_load_dwordx4 v48, s[52:55], s85 offen lds
  v_mfma_f32_16x16x32_bf16 v[200:203], v[84:87], a[48:51], v[200:203]
  s_add_u32 m0, s87, 33792
  v_mfma_f32_16x16x32_bf16 v[204:207], v[84:87], a[52:55], v[204:207]
  buffer_load_dwordx4 v49, s[52:55], s85 offen lds
  v_mfma_f32_16x16x32_bf16 v[208:211], v[88:91], a[48:51], v[208:211]
  s_add_u32 m0, s87, 34816
  v_mfma_f32_16x16x32_bf16 v[212:215], v[88:91], a[52:55], v[212:215]
  buffer_load_dwordx4 v50, s[52:55], s85 offen lds
  v_add_u32 v16, 0, v32
  v_add_u32 v17, 0, v33
  v_mfma_f32_16x16x32_bf16 v[216:219], v[92:95], a[48:51], v[216:219]
  v_add_u32 v18, 0, v34
  v_add_u32 v19, 0, v35
  v_mfma_f32_16x16x32_bf16 v[220:223], v[92:95], a[52:55], v[220:223]
  v_add_u32 v20, 0, v36
  v_add_u32 v21, 0, v37
  v_add_u32 v22, 0, v38
  v_add_u32 v23, 0, v39
  v_add_u32 v24, 0, v40
  v_add_u32 v25, 0, v41
  v_add_u32 v26, 0, v42
  v_add_u32 v27, 0, v43
  v_add_u32 v28, 0, v44
  v_add_u32 v29, 0, v45
  v_add_u32 v30, 0, v46
  v_add_u32 v31, 0, v47
  s_waitcnt lgkmcnt(0)
  v_mfma_f32_16x16x32_bf16 v[160:163], v[112:115], a[56:59], v[160:163]
  ds_read_b64_tr_b16 v[64:65], v16 offset:0
  ds_read_b64_tr_b16 v[66:67], v24 offset:0
  v_mfma_f32_16x16x32_bf16 v[164:167], v[112:115], a[60:63], v[164:167]
  ds_read_b64_tr_b16 v[68:69], v17 offset:0
  ds_read_b64_tr_b16 v[70:71], v25 offset:0
  v_mfma_f32_16x16x32_bf16 v[168:171], v[116:119], a[56:59], v[168:171]
  ds_read_b64_tr_b16 v[72:73], v18 offset:0
  ds_read_b64_tr_b16 v[74:75], v26 offset:0
  v_mfma_f32_16x16x32_bf16 v[172:175], v[116:119], a[60:63], v[172:175]
  ds_read_b64_tr_b16 v[76:77], v19 offset:0
  ds_read_b64_tr_b16 v[78:79], v27 offset:0
  v_mfma_f32_16x16x32_bf16 v[176:179], v[120:123], a[56:59], v[176:179]
  ds_read_b64_tr_b16 v[80:81], v20 offset:0
  ds_read_b64_tr_b16 v[82:83], v28 offset:0
  v_mfma_f32_16x16x32_bf16 v[180:183], v[120:123], a[60:63], v[180:183]
  ds_read_b64_tr_b16 v[84:85], v21 offset:0
  ds_read_b64_tr_b16 v[86:87], v29 offset:0
  v_mfma_f32_16x16x32_bf16 v[184:187], v[124:127], a[56:59], v[184:187]
  ds_read_b64_tr_b16 v[88:89], v22 offset:0
  ds_read_b64_tr_b16 v[90:91], v30 offset:0
  v_mfma_f32_16x16x32_bf16 v[188:191], v[124:127], a[60:63], v[188:191]
  ds_read_b64_tr_b16 v[92:93], v23 offset:0
  ds_read_b64_tr_b16 v[94:95], v31 offset:0
  v_mfma_f32_16x16x32_bf16 v[192:195], v[128:131], a[56:59], v[192:195]
  s_add_u32 m0, s87, 35840
  v_mfma_f32_16x16x32_bf16 v[196:199], v[128:131], a[60:63], v[196:199]
  buffer_load_dwordx4 v51, s[52:55], s85 offen lds
  v_mfma_f32_16x16x32_bf16 v[200:203], v[132:135], a[56:59], v[200:203]
  buffer_load_dwordx4 a[32:35], v60, s[48:51], s86 offen offset:0 sc1
  v_mfma_f32_16x16x32_bf16 v[204:207], v[132:135], a[60:63], v[204:207]
  buffer_load_dwordx4 a[36:39], v60, s[48:51], s86 offen offset:1024 sc1
  v_mfma_f32_16x16x32_bf16 v[208:211], v[136:139], a[56:59], v[208:211]
  buffer_load_dwordx4 a[40:43], v60, s[48:51], s86 offen offset:2048 sc1
  v_mfma_f32_16x16x32_bf16 v[212:215], v[136:139], a[60:63], v[212:215]
  buffer_load_dwordx4 a[44:47], v60, s[48:51], s86 offen offset:3072 sc1
  v_mfma_f32_16x16x32_bf16 v[216:219], v[140:143], a[56:59], v[216:219]
  v_mfma_f32_16x16x32_bf16 v[220:223], v[140:143], a[60:63], v[220:223]
  s_waitcnt lgkmcnt(0)
  s_add_u32 s70, s70, 1
  s_cmp_ge_u32 s70, s69
  s_cbranch_scc1 mai_g1endb
  s_branch mai_g1loopb
mai_g1endb:
  v_lshrrev_b32 v5, 4, v1
  v_lshlrev_b32 v5, 3, v5
  s_lshl_b32 s58, s74, 1
  buffer_load_dwordx2 v[128:129], v5, s[40:43], s58 offen offset:0
  buffer_load_dwordx2 v[130:131], v5, s[40:43], s58 offen offset:32
  buffer_load_dwordx2 v[132:133], v5, s[40:43], s58 offen offset:64
  buffer_load_dwordx2 v[134:135], v5, s[40:43], s58 offen offset:96
  buffer_load_dwordx2 v[136:137], v5, s[40:43], s58 offen offset:128
  buffer_load_dwordx2 v[138:139], v5, s[40:43], s58 offen offset:160
  buffer_load_dwordx2 v[140:141], v5, s[40:43], s58 offen offset:192
  buffer_load_dwordx2 v[142:143], v5, s[40:43], s58 offen offset:224
  s_waitcnt vmcnt(0)
  v_lshlrev_b32 v80, 16, v128
  v_and_b32 v81, 4294901760, v128
  v_lshlrev_b32 v82, 16, v129
  v_and_b32 v83, 4294901760, v129
  v_lshlrev_b32 v84, 16, v130
  v_and_b32 v85, 4294901760, v130
  v_lshlrev_b32 v86, 16, v131
  v_and_b32 v87, 4294901760, v131
  v_lshlrev_b32 v88, 16, v132
  v_and_b32 v89, 4294901760, v132
  v_lshlrev_b32 v90, 16, v133
  v_and_b32 v91, 4294901760, v133
  v_lshlrev_b32 v92, 16, v134
  v_and_b32 v93, 4294901760, v134
  v_lshlrev_b32 v94, 16, v135
  v_and_b32 v95, 4294901760, v135
  v_lshlrev_b32 v96, 16, v136
  v_and_b32 v97, 4294901760, v136
  v_lshlrev_b32 v98, 16, v137
  v_and_b32 v99, 4294901760, v137
  v_lshlrev_b32 v100, 16, v138
  v_and_b32 v101, 4294901760, v138
  v_lshlrev_b32 v102, 16, v139
  v_and_b32 v103, 4294901760, v139
  v_lshlrev_b32 v104, 16, v140
  v_and_b32 v105, 4294901760, v140
  v_lshlrev_b32 v106, 16, v141
  v_and_b32 v107, 4294901760, v141
  v_lshlrev_b32 v108, 16, v142
  v_and_b32 v109, 4294901760, v142
  v_lshlrev_b32 v110, 16, v143
  v_and_b32 v111, 4294901760, v143
  s_mov_b32 s79, 3216550459
  s_mul_i32 s57, s89, 40960
  s_lshl_b32 s58, s74, 6
  s_add_u32 s75, s75, s57
  s_add_u32 s75, s75, s58
  v_cvt_pk_bf16_f32 v160, v160, v160
  v_lshlrev_b32 v160, 16, v160
  v_add_f32 v160, v160, v80
  v_cvt_pk_bf16_f32 v160, v160, v160
  v_lshlrev_b32 v160, 16, v160
  v_mul_f32 v6, s79, v160
  v_exp_f32 v6, v6
  s_nop 0
  v_add_f32 v6, 1.0, v6
  v_rcp_f32 v6, v6
  s_nop 0
  v_mul_f32 v160, v160, v6
  v_cvt_pk_bf16_f32 v161, v161, v161
  v_lshlrev_b32 v161, 16, v161
  v_add_f32 v161, v161, v81
  v_cvt_pk_bf16_f32 v161, v161, v161
  v_lshlrev_b32 v161, 16, v161
  v_mul_f32 v6, s79, v161
  v_exp_f32 v6, v6
  s_nop 0
  v_add_f32 v6, 1.0, v6
  v_rcp_f32 v6, v6
  s_nop 0
  v_mul_f32 v161, v161, v6
  v_cvt_pk_bf16_f32 v162, v162, v162
  v_lshlrev_b32 v162, 16, v162
  v_add_f32 v162, v162, v82
  v_cvt_pk_bf16_f32 v162, v162, v162
  v_lshlrev_b32 v162, 16, v162
  v_mul_f32 v6, s79, v162
  v_exp_f32 v6, v6
  s_nop 0
  v_add_f32 v6, 1.0, v6
  v_rcp_f32 v6, v6
  s_nop 0
  v_mul_f32 v162, v162, v6
  v_cvt_pk_bf16_f32 v163, v163, v163
  v_lshlrev_b32 v163, 16, v163
  v_add_f32 v163, v163, v83
  v_cvt_pk_bf16_f32 v163, v163, v163
  v_lshlrev_b32 v163, 16, v163
  v_mul_f32 v6, s79, v163
  v_exp_f32 v6, v6
  s_nop 0
  v_add_f32 v6, 1.0, v6
  v_rcp_f32 v6, v6
  s_nop 0
  v_mul_f32 v163, v163, v6
  v_cvt_pk_bf16_f32 v64, v160, v161
  v_cvt_pk_bf16_f32 v65, v162, v163
  v_cvt_pk_bf16_f32 v164, v164, v164
  v_lshlrev_b32 v164, 16, v164
  v_add_f32 v164, v164, v80
  v_cvt_pk_bf16_f32 v164, v164, v164
  v_lshlrev_b32 v164, 16, v164
  v_mul_f32 v6, s79, v164
  v_exp_f32 v6, v6
  s_nop 0
  v_add_f32 v6, 1.0, v6
  v_rcp_f32 v6, v6
  s_nop 0
  v_mul_f32 v164, v164, v6
  v_cvt_pk_bf16_f32 v165, v165, v165
  v_lshlrev_b32 v165, 16, v165
  v_add_f32 v165, v165, v81
  v_cvt_pk_bf16_f32 v165, v165, v165
  v_lshlrev_b32 v165, 16, v165
  v_mul_f32 v6, s79, v165
  v_exp_f32 v6, v6
  s_nop 0
  v_add_f32 v6, 1.0, v6
  v_rcp_f32 v6, v6
  s_nop 0
  v_mul_f32 v165, v165, v6
  v_cvt_pk_bf16_f32 v166, v166, v166
  v_lshlrev_b32 v166, 16, v166
  v_add_f32 v166, v166, v82
  v_cvt_pk_bf16_f32 v166, v166, v166
  v_lshlrev_b32 v166, 16, v166
  v_mul_f32 v6, s79, v166
  v_exp_f32 v6, v6
  s_nop 0
  v_add_f32 v6, 1.0, v6
  v_rcp_f32 v6, v6
  s_nop 0
  v_mul_f32 v166, v166, v6
  v_cvt_pk_bf16_f32 v167, v167, v167
  v_lshlrev_b32 v167, 16, v167
  v_add_f32 v167, v167, v83
  v_cvt_pk_bf16_f32 v167, v167, v167
  v_lshlrev_b32 v167, 16, v167
  v_mul_f32 v6, s79, v167
  v_exp_f32 v6, v6
  s_nop 0
  v_add_f32 v6, 1.0, v6
  v_rcp_f32 v6, v6
  s_nop 0
  v_mul_f32 v167, v167, v6
  v_cvt_pk_bf16_f32 v66, v164, v165
  v_cvt_pk_bf16_f32 v67, v166, v167
  buffer_store_dwordx4 v[64:67], v60, s[48:51], s75 offen offset:0 sc1
  v_cvt_pk_bf16_f32 v168, v168, v168
  v_lshlrev_b32 v168, 16, v168
  v_add_f32 v168, v168, v84
  v_cvt_pk_bf16_f32 v168, v168, v168
  v_lshlrev_b32 v168, 16, v168
  v_mul_f32 v6, s79, v168
  v_exp_f32 v6, v6
  s_nop 0
  v_add_f32 v6, 1.0, v6
  v_rcp_f32 v6, v6
  s_nop 0
  v_mul_f32 v168, v168, v6
  v_cvt_pk_bf16_f32 v169, v169, v169
  v_lshlrev_b32 v169, 16, v169
  v_add_f32 v169, v169, v85
  v_cvt_pk_bf16_f32 v169, v169, v169
  v_lshlrev_b32 v169, 16, v169
  v_mul_f32 v6, s79, v169
  v_exp_f32 v6, v6
  s_nop 0
  v_add_f32 v6, 1.0, v6
  v_rcp_f32 v6, v6
  s_nop 0
  v_mul_f32 v169, v169, v6
  v_cvt_pk_bf16_f32 v170, v170, v170
  v_lshlrev_b32 v170, 16, v170
  v_add_f32 v170, v170, v86
  v_cvt_pk_bf16_f32 v170, v170, v170
  v_lshlrev_b32 v170, 16, v170
  v_mul_f32 v6, s79, v170
  v_exp_f32 v6, v6
  s_nop 0
  v_add_f32 v6, 1.0, v6
  v_rcp_f32 v6, v6
  s_nop 0
  v_mul_f32 v170, v170, v6
  v_cvt_pk_bf16_f32 v171, v171, v171
  v_lshlrev_b32 v171, 16, v171
  v_add_f32 v171, v171, v87
  v_cvt_pk_bf16_f32 v171, v171, v171
  v_lshlrev_b32 v171, 16, v171
  v_mul_f32 v6, s79, v171
  v_exp_f32 v6, v6
  s_nop 0
  v_add_f32 v6, 1.0, v6
  v_rcp_f32 v6, v6
  s_nop 0
  v_mul_f32 v171, v171, v6
  v_cvt_pk_bf16_f32 v68, v168, v169
  v_cvt_pk_bf16_f32 v69, v170, v171
  v_cvt_pk_bf16_f32 v172, v172, v172
  v_lshlrev_b32 v172, 16, v172
  v_add_f32 v172, v172, v84
  v_cvt_pk_bf16_f32 v172, v172, v172
  v_lshlrev_b32 v172, 16, v172
  v_mul_f32 v6, s79, v172
  v_exp_f32 v6, v6
  s_nop 0
  v_add_f32 v6, 1.0, v6
  v_rcp_f32 v6, v6
  s_nop 0
  v_mul_f32 v172, v172, v6
  v_cvt_pk_bf16_f32 v173, v173, v173
  v_lshlrev_b32 v173, 16, v173
  v_add_f32 v173, v173, v85
  v_cvt_pk_bf16_f32 v173, v173, v173
  v_lshlrev_b32 v173, 16, v173
  v_mul_f32 v6, s79, v173
  v_exp_f32 v6, v6
  s_nop 0
  v_add_f32 v6, 1.0, v6
  v_rcp_f32 v6, v6
  s_nop 0
  v_mul_f32 v173, v173, v6
  v_cvt_pk_bf16_f32 v174, v174, v174
  v_lshlrev_b32 v174, 16, v174
  v_add_f32 v174, v174, v86
  v_cvt_pk_bf16_f32 v174, v174, v174
  v_lshlrev_b32 v174, 16, v174
  v_mul_f32 v6, s79, v174
  v_exp_f32 v6, v6
  s_nop 0
  v_add_f32 v6, 1.0, v6
  v_rcp_f32 v6, v6
  s_nop 0
  v_mul_f32 v174, v174, v6
  v_cvt_pk_bf16_f32 v175, v175, v175
  v_lshlrev_b32 v175, 16, v175
  v_add_f32 v175, v175, v87
  v_cvt_pk_bf16_f32 v175, v175, v175
  v_lshlrev_b32 v175, 16, v175
  v_mul_f32 v6, s79, v175
  v_exp_f32 v6, v6
  s_nop 0
  v_add_f32 v6, 1.0, v6
  v_rcp_f32 v6, v6
  s_nop 0
  v_mul_f32 v175, v175, v6
  v_cvt_pk_bf16_f32 v70, v172, v173
  v_cvt_pk_bf16_f32 v71, v174, v175
  buffer_store_dwordx4 v[68:71], v60, s[48:51], s75 offen offset:1024 sc1
  v_cvt_pk_bf16_f32 v176, v176, v176
  v_lshlrev_b32 v176, 16, v176
  v_add_f32 v176, v176, v88
  v_cvt_pk_bf16_f32 v176, v176, v176
  v_lshlrev_b32 v176, 16, v176
  v_mul_f32 v6, s79, v176
  v_exp_f32 v6, v6
  s_nop 0
  v_add_f32 v6, 1.0, v6
  v_rcp_f32 v6, v6
  s_nop 0
  v_mul_f32 v176, v176, v6
  v_cvt_pk_bf16_f32 v177, v177, v177
  v_lshlrev_b32 v177, 16, v177
  v_add_f32 v177, v177, v89
  v_cvt_pk_bf16_f32 v177, v177, v177
  v_lshlrev_b32 v177, 16, v177
  v_mul_f32 v6, s79, v177
  v_exp_f32 v6, v6
  s_nop 0
  v_add_f32 v6, 1.0, v6
  v_rcp_f32 v6, v6
  s_nop 0
  v_mul_f32 v177, v177, v6
  v_cvt_pk_bf16_f32 v178, v178, v178
  v_lshlrev_b32 v178, 16, v178
  v_add_f32 v178, v178, v90
  v_cvt_pk_bf16_f32 v178, v178, v178
  v_lshlrev_b32 v178, 16, v178
  v_mul_f32 v6, s79, v178
  v_exp_f32 v6, v6
  s_nop 0
  v_add_f32 v6, 1.0, v6
  v_rcp_f32 v6, v6
  s_nop 0
  v_mul_f32 v178, v178, v6
  v_cvt_pk_bf16_f32 v179, v179, v179
  v_lshlrev_b32 v179, 16, v179
  v_add_f32 v179, v179, v91
  v_cvt_pk_bf16_f32 v179, v179, v179
  v_lshlrev_b32 v179, 16, v179
  v_mul_f32 v6, s79, v179
  v_exp_f32 v6, v6
  s_nop 0
  v_add_f32 v6, 1.0, v6
  v_rcp_f32 v6, v6
  s_nop 0
  v_mul_f32 v179, v179, v6
  v_cvt_pk_bf16_f32 v72, v176, v177
  v_cvt_pk_bf16_f32 v73, v178, v179
  v_cvt_pk_bf16_f32 v180, v180, v180
  v_lshlrev_b32 v180, 16, v180
  v_add_f32 v180, v180, v88
  v_cvt_pk_bf16_f32 v180, v180, v180
  v_lshlrev_b32 v180, 16, v180
  v_mul_f32 v6, s79, v180
  v_exp_f32 v6, v6
  s_nop 0
  v_add_f32 v6, 1.0, v6
  v_rcp_f32 v6, v6
  s_nop 0
  v_mul_f32 v180, v180, v6
  v_cvt_pk_bf16_f32 v181, v181, v181
  v_lshlrev_b32 v181, 16, v181
  v_add_f32 v181, v181, v89
  v_cvt_pk_bf16_f32 v181, v181, v181
  v_lshlrev_b32 v181, 16, v181
  v_mul_f32 v6, s79, v181
  v_exp_f32 v6, v6
  s_nop 0
  v_add_f32 v6, 1.0, v6
  v_rcp_f32 v6, v6
  s_nop 0
  v_mul_f32 v181, v181, v6
  v_cvt_pk_bf16_f32 v182, v182, v182
  v_lshlrev_b32 v182, 16, v182
  v_add_f32 v182, v182, v90
  v_cvt_pk_bf16_f32 v182, v182, v182
  v_lshlrev_b32 v182, 16, v182
  v_mul_f32 v6, s79, v182
  v_exp_f32 v6, v6
  s_nop 0
  v_add_f32 v6, 1.0, v6
  v_rcp_f32 v6, v6
  s_nop 0
  v_mul_f32 v182, v182, v6
  v_cvt_pk_bf16_f32 v183, v183, v183
  v_lshlrev_b32 v183, 16, v183
  v_add_f32 v183, v183, v91
  v_cvt_pk_bf16_f32 v183, v183, v183
  v_lshlrev_b32 v183, 16, v183
  v_mul_f32 v6, s79, v183
  v_exp_f32 v6, v6
  s_nop 0
  v_add_f32 v6, 1.0, v6
  v_rcp_f32 v6, v6
  s_nop 0
  v_mul_f32 v183, v183, v6
  v_cvt_pk_bf16_f32 v74, v180, v181
  v_cvt_pk_bf16_f32 v75, v182, v183
  buffer_store_dwordx4 v[72:75], v60, s[48:51], s75 offen offset:2048 sc1
  v_cvt_pk_bf16_f32 v184, v184, v184
  v_lshlrev_b32 v184, 16, v184
  v_add_f32 v184, v184, v92
  v_cvt_pk_bf16_f32 v184, v184, v184
  v_lshlrev_b32 v184, 16, v184
  v_mul_f32 v6, s79, v184
  v_exp_f32 v6, v6
  s_nop 0
  v_add_f32 v6, 1.0, v6
  v_rcp_f32 v6, v6
  s_nop 0
  v_mul_f32 v184, v184, v6
  v_cvt_pk_bf16_f32 v185, v185, v185
  v_lshlrev_b32 v185, 16, v185
  v_add_f32 v185, v185, v93
  v_cvt_pk_bf16_f32 v185, v185, v185
  v_lshlrev_b32 v185, 16, v185
  v_mul_f32 v6, s79, v185
  v_exp_f32 v6, v6
  s_nop 0
  v_add_f32 v6, 1.0, v6
  v_rcp_f32 v6, v6
  s_nop 0
  v_mul_f32 v185, v185, v6
  v_cvt_pk_bf16_f32 v186, v186, v186
  v_lshlrev_b32 v186, 16, v186
  v_add_f32 v186, v186, v94
  v_cvt_pk_bf16_f32 v186, v186, v186
  v_lshlrev_b32 v186, 16, v186
  v_mul_f32 v6, s79, v186
  v_exp_f32 v6, v6
  s_nop 0
  v_add_f32 v6, 1.0, v6
  v_rcp_f32 v6, v6
  s_nop 0
  v_mul_f32 v186, v186, v6
  v_cvt_pk_bf16_f32 v187, v187, v187
  v_lshlrev_b32 v187, 16, v187
  v_add_f32 v187, v187, v95
  v_cvt_pk_bf16_f32 v187, v187, v187
  v_lshlrev_b32 v187, 16, v187
  v_mul_f32 v6, s79, v187
  v_exp_f32 v6, v6
  s_nop 0
  v_add_f32 v6, 1.0, v6
  v_rcp_f32 v6, v6
  s_nop 0
  v_mul_f32 v187, v187, v6
  v_cvt_pk_bf16_f32 v76, v184, v185
  v_cvt_pk_bf16_f32 v77, v186, v187
  v_cvt_pk_bf16_f32 v188, v188, v188
  v_lshlrev_b32 v188, 16, v188
  v_add_f32 v188, v188, v92
  v_cvt_pk_bf16_f32 v188, v188, v188
  v_lshlrev_b32 v188, 16, v188
  v_mul_f32 v6, s79, v188
  v_exp_f32 v6, v6
  s_nop 0
  v_add_f32 v6, 1.0, v6
  v_rcp_f32 v6, v6
  s_nop 0
  v_mul_f32 v188, v188, v6
  v_cvt_pk_bf16_f32 v189, v189, v189
  v_lshlrev_b32 v189, 16, v189
  v_add_f32 v189, v189, v93
  v_cvt_pk_bf16_f32 v189, v189, v189
  v_lshlrev_b32 v189, 16, v189
  v_mul_f32 v6, s79, v189
  v_exp_f32 v6, v6
  s_nop 0
  v_add_f32 v6, 1.0, v6
  v_rcp_f32 v6, v6
  s_nop 0
  v_mul_f32 v189, v189, v6
  v_cvt_pk_bf16_f32 v190, v190, v190
  v_lshlrev_b32 v190, 16, v190
  v_add_f32 v190, v190, v94
  v_cvt_pk_bf16_f32 v190, v190, v190
  v_lshlrev_b32 v190, 16, v190
  v_mul_f32 v6, s79, v190
  v_exp_f32 v6, v6
  s_nop 0
  v_add_f32 v6, 1.0, v6
  v_rcp_f32 v6, v6
  s_nop 0
  v_mul_f32 v190, v190, v6
  v_cvt_pk_bf16_f32 v191, v191, v191
  v_lshlrev_b32 v191, 16, v191
  v_add_f32 v191, v191, v95
  v_cvt_pk_bf16_f32 v191, v191, v191
  v_lshlrev_b32 v191, 16, v191
  v_mul_f32 v6, s79, v191
  v_exp_f32 v6, v6
  s_nop 0
  v_add_f32 v6, 1.0, v6
  v_rcp_f32 v6, v6
  s_nop 0
  v_mul_f32 v191, v191, v6
  v_cvt_pk_bf16_f32 v78, v188, v189
  v_cvt_pk_bf16_f32 v79, v190, v191
  buffer_store_dwordx4 v[76:79], v60, s[48:51], s75 offen offset:3072 sc1
  v_cvt_pk_bf16_f32 v192, v192, v192
  v_lshlrev_b32 v192, 16, v192
  v_add_f32 v192, v192, v96
  v_cvt_pk_bf16_f32 v192, v192, v192
  v_lshlrev_b32 v192, 16, v192
  v_mul_f32 v6, s79, v192
  v_exp_f32 v6, v6
  s_nop 0
  v_add_f32 v6, 1.0, v6
  v_rcp_f32 v6, v6
  s_nop 0
  v_mul_f32 v192, v192, v6
  v_cvt_pk_bf16_f32 v193, v193, v193
  v_lshlrev_b32 v193, 16, v193
  v_add_f32 v193, v193, v97
  v_cvt_pk_bf16_f32 v193, v193, v193
  v_lshlrev_b32 v193, 16, v193
  v_mul_f32 v6, s79, v193
  v_exp_f32 v6, v6
  s_nop 0
  v_add_f32 v6, 1.0, v6
  v_rcp_f32 v6, v6
  s_nop 0
  v_mul_f32 v193, v193, v6
  v_cvt_pk_bf16_f32 v194, v194, v194
  v_lshlrev_b32 v194, 16, v194
  v_add_f32 v194, v194, v98
  v_cvt_pk_bf16_f32 v194, v194, v194
  v_lshlrev_b32 v194, 16, v194
  v_mul_f32 v6, s79, v194
  v_exp_f32 v6, v6
  s_nop 0
  v_add_f32 v6, 1.0, v6
  v_rcp_f32 v6, v6
  s_nop 0
  v_mul_f32 v194, v194, v6
  v_cvt_pk_bf16_f32 v195, v195, v195
  v_lshlrev_b32 v195, 16, v195
  v_add_f32 v195, v195, v99
  v_cvt_pk_bf16_f32 v195, v195, v195
  v_lshlrev_b32 v195, 16, v195
  v_mul_f32 v6, s79, v195
  v_exp_f32 v6, v6
  s_nop 0
  v_add_f32 v6, 1.0, v6
  v_rcp_f32 v6, v6
  s_nop 0
  v_mul_f32 v195, v195, v6
  v_cvt_pk_bf16_f32 v64, v192, v193
  v_cvt_pk_bf16_f32 v65, v194, v195
  v_cvt_pk_bf16_f32 v196, v196, v196
  v_lshlrev_b32 v196, 16, v196
  v_add_f32 v196, v196, v96
  v_cvt_pk_bf16_f32 v196, v196, v196
  v_lshlrev_b32 v196, 16, v196
  v_mul_f32 v6, s79, v196
  v_exp_f32 v6, v6
  s_nop 0
  v_add_f32 v6, 1.0, v6
  v_rcp_f32 v6, v6
  s_nop 0
  v_mul_f32 v196, v196, v6
  v_cvt_pk_bf16_f32 v197, v197, v197
  v_lshlrev_b32 v197, 16, v197
  v_add_f32 v197, v197, v97
  v_cvt_pk_bf16_f32 v197, v197, v197
  v_lshlrev_b32 v197, 16, v197
  v_mul_f32 v6, s79, v197
  v_exp_f32 v6, v6
  s_nop 0
  v_add_f32 v6, 1.0, v6
  v_rcp_f32 v6, v6
  s_nop 0
  v_mul_f32 v197, v197, v6
  v_cvt_pk_bf16_f32 v198, v198, v198
  v_lshlrev_b32 v198, 16, v198
  v_add_f32 v198, v198, v98
  v_cvt_pk_bf16_f32 v198, v198, v198
  v_lshlrev_b32 v198, 16, v198
  v_mul_f32 v6, s79, v198
  v_exp_f32 v6, v6
  s_nop 0
  v_add_f32 v6, 1.0, v6
  v_rcp_f32 v6, v6
  s_nop 0
  v_mul_f32 v198, v198, v6
  v_cvt_pk_bf16_f32 v199, v199, v199
  v_lshlrev_b32 v199, 16, v199
  v_add_f32 v199, v199, v99
  v_cvt_pk_bf16_f32 v199, v199, v199
  v_lshlrev_b32 v199, 16, v199
  v_mul_f32 v6, s79, v199
  v_exp_f32 v6, v6
  s_nop 0
  v_add_f32 v6, 1.0, v6
  v_rcp_f32 v6, v6
  s_nop 0
  v_mul_f32 v199, v199, v6
  v_cvt_pk_bf16_f32 v66, v196, v197
  v_cvt_pk_bf16_f32 v67, v198, v199
  s_add_u32 s75, s75, 4096
  buffer_store_dwordx4 v[64:67], v60, s[48:51], s75 offen offset:0 sc1
  v_cvt_pk_bf16_f32 v200, v200, v200
  v_lshlrev_b32 v200, 16, v200
  v_add_f32 v200, v200, v100
  v_cvt_pk_bf16_f32 v200, v200, v200
  v_lshlrev_b32 v200, 16, v200
  v_mul_f32 v6, s79, v200
  v_exp_f32 v6, v6
  s_nop 0
  v_add_f32 v6, 1.0, v6
  v_rcp_f32 v6, v6
  s_nop 0
  v_mul_f32 v200, v200, v6
  v_cvt_pk_bf16_f32 v201, v201, v201
  v_lshlrev_b32 v201, 16, v201
  v_add_f32 v201, v201, v101
  v_cvt_pk_bf16_f32 v201, v201, v201
  v_lshlrev_b32 v201, 16, v201
  v_mul_f32 v6, s79, v201
  v_exp_f32 v6, v6
  s_nop 0
  v_add_f32 v6, 1.0, v6
  v_rcp_f32 v6, v6
  s_nop 0
  v_mul_f32 v201, v201, v6
  v_cvt_pk_bf16_f32 v202, v202, v202
  v_lshlrev_b32 v202, 16, v202
  v_add_f32 v202, v202, v102
  v_cvt_pk_bf16_f32 v202, v202, v202
  v_lshlrev_b32 v202, 16, v202
  v_mul_f32 v6, s79, v202
  v_exp_f32 v6, v6
  s_nop 0
  v_add_f32 v6, 1.0, v6
  v_rcp_f32 v6, v6
  s_nop 0
  v_mul_f32 v202, v202, v6
  v_cvt_pk_bf16_f32 v203, v203, v203
  v_lshlrev_b32 v203, 16, v203
  v_add_f32 v203, v203, v103
  v_cvt_pk_bf16_f32 v203, v203, v203
  v_lshlrev_b32 v203, 16, v203
  v_mul_f32 v6, s79, v203
  v_exp_f32 v6, v6
  s_nop 0
  v_add_f32 v6, 1.0, v6
  v_rcp_f32 v6, v6
  s_nop 0
  v_mul_f32 v203, v203, v6
  v_cvt_pk_bf16_f32 v68, v200, v201
  v_cvt_pk_bf16_f32 v69, v202, v203
  v_cvt_pk_bf16_f32 v204, v204, v204
  v_lshlrev_b32 v204, 16, v204
  v_add_f32 v204, v204, v100
  v_cvt_pk_bf16_f32 v204, v204, v204
  v_lshlrev_b32 v204, 16, v204
  v_mul_f32 v6, s79, v204
  v_exp_f32 v6, v6
  s_nop 0
  v_add_f32 v6, 1.0, v6
  v_rcp_f32 v6, v6
  s_nop 0
  v_mul_f32 v204, v204, v6
  v_cvt_pk_bf16_f32 v205, v205, v205
  v_lshlrev_b32 v205, 16, v205
  v_add_f32 v205, v205, v101
  v_cvt_pk_bf16_f32 v205, v205, v205
  v_lshlrev_b32 v205, 16, v205
  v_mul_f32 v6, s79, v205
  v_exp_f32 v6, v6
  s_nop 0
  v_add_f32 v6, 1.0, v6
  v_rcp_f32 v6, v6
  s_nop 0
  v_mul_f32 v205, v205, v6
  v_cvt_pk_bf16_f32 v206, v206, v206
  v_lshlrev_b32 v206, 16, v206
  v_add_f32 v206, v206, v102
  v_cvt_pk_bf16_f32 v206, v206, v206
  v_lshlrev_b32 v206, 16, v206
  v_mul_f32 v6, s79, v206
  v_exp_f32 v6, v6
  s_nop 0
  v_add_f32 v6, 1.0, v6
  v_rcp_f32 v6, v6
  s_nop 0
  v_mul_f32 v206, v206, v6
  v_cvt_pk_bf16_f32 v207, v207, v207
  v_lshlrev_b32 v207, 16, v207
  v_add_f32 v207, v207, v103
  v_cvt_pk_bf16_f32 v207, v207, v207
  v_lshlrev_b32 v207, 16, v207
  v_mul_f32 v6, s79, v207
  v_exp_f32 v6, v6
  s_nop 0
  v_add_f32 v6, 1.0, v6
  v_rcp_f32 v6, v6
  s_nop 0
  v_mul_f32 v207, v207, v6
  v_cvt_pk_bf16_f32 v70, v204, v205
  v_cvt_pk_bf16_f32 v71, v206, v207
  buffer_store_dwordx4 v[68:71], v60, s[48:51], s75 offen offset:1024 sc1
  v_cvt_pk_bf16_f32 v208, v208, v208
  v_lshlrev_b32 v208, 16, v208
  v_add_f32 v208, v208, v104
  v_cvt_pk_bf16_f32 v208, v208, v208
  v_lshlrev_b32 v208, 16, v208
  v_mul_f32 v6, s79, v208
  v_exp_f32 v6, v6
  s_nop 0
  v_add_f32 v6, 1.0, v6
  v_rcp_f32 v6, v6
  s_nop 0
  v_mul_f32 v208, v208, v6
  v_cvt_pk_bf16_f32 v209, v209, v209
  v_lshlrev_b32 v209, 16, v209
  v_add_f32 v209, v209, v105
  v_cvt_pk_bf16_f32 v209, v209, v209
  v_lshlrev_b32 v209, 16, v209
  v_mul_f32 v6, s79, v209
  v_exp_f32 v6, v6
  s_nop 0
  v_add_f32 v6, 1.0, v6
  v_rcp_f32 v6, v6
  s_nop 0
  v_mul_f32 v209, v209, v6
  v_cvt_pk_bf16_f32 v210, v210, v210
  v_lshlrev_b32 v210, 16, v210
  v_add_f32 v210, v210, v106
  v_cvt_pk_bf16_f32 v210, v210, v210
  v_lshlrev_b32 v210, 16, v210
  v_mul_f32 v6, s79, v210
  v_exp_f32 v6, v6
  s_nop 0
  v_add_f32 v6, 1.0, v6
  v_rcp_f32 v6, v6
  s_nop 0
  v_mul_f32 v210, v210, v6
  v_cvt_pk_bf16_f32 v211, v211, v211
  v_lshlrev_b32 v211, 16, v211
  v_add_f32 v211, v211, v107
  v_cvt_pk_bf16_f32 v211, v211, v211
  v_lshlrev_b32 v211, 16, v211
  v_mul_f32 v6, s79, v211
  v_exp_f32 v6, v6
  s_nop 0
  v_add_f32 v6, 1.0, v6
  v_rcp_f32 v6, v6
  s_nop 0
  v_mul_f32 v211, v211, v6
  v_cvt_pk_bf16_f32 v72, v208, v209
  v_cvt_pk_bf16_f32 v73, v210, v211
  v_cvt_pk_bf16_f32 v212, v212, v212
  v_lshlrev_b32 v212, 16, v212
  v_add_f32 v212, v212, v104
  v_cvt_pk_bf16_f32 v212, v212, v212
  v_lshlrev_b32 v212, 16, v212
  v_mul_f32 v6, s79, v212
  v_exp_f32 v6, v6
  s_nop 0
  v_add_f32 v6, 1.0, v6
  v_rcp_f32 v6, v6
  s_nop 0
  v_mul_f32 v212, v212, v6
  v_cvt_pk_bf16_f32 v213, v213, v213
  v_lshlrev_b32 v213, 16, v213
  v_add_f32 v213, v213, v105
  v_cvt_pk_bf16_f32 v213, v213, v213
  v_lshlrev_b32 v213, 16, v213
  v_mul_f32 v6, s79, v213
  v_exp_f32 v6, v6
  s_nop 0
  v_add_f32 v6, 1.0, v6
  v_rcp_f32 v6, v6
  s_nop 0
  v_mul_f32 v213, v213, v6
  v_cvt_pk_bf16_f32 v214, v214, v214
  v_lshlrev_b32 v214, 16, v214
  v_add_f32 v214, v214, v106
  v_cvt_pk_bf16_f32 v214, v214, v214
  v_lshlrev_b32 v214, 16, v214
  v_mul_f32 v6, s79, v214
  v_exp_f32 v6, v6
  s_nop 0
  v_add_f32 v6, 1.0, v6
  v_rcp_f32 v6, v6
  s_nop 0
  v_mul_f32 v214, v214, v6
  v_cvt_pk_bf16_f32 v215, v215, v215
  v_lshlrev_b32 v215, 16, v215
  v_add_f32 v215, v215, v107
  v_cvt_pk_bf16_f32 v215, v215, v215
  v_lshlrev_b32 v215, 16, v215
  v_mul_f32 v6, s79, v215
  v_exp_f32 v6, v6
  s_nop 0
  v_add_f32 v6, 1.0, v6
  v_rcp_f32 v6, v6
  s_nop 0
  v_mul_f32 v215, v215, v6
  v_cvt_pk_bf16_f32 v74, v212, v213
  v_cvt_pk_bf16_f32 v75, v214, v215
  buffer_store_dwordx4 v[72:75], v60, s[48:51], s75 offen offset:2048 sc1
  v_cvt_pk_bf16_f32 v216, v216, v216
  v_lshlrev_b32 v216, 16, v216
  v_add_f32 v216, v216, v108
  v_cvt_pk_bf16_f32 v216, v216, v216
  v_lshlrev_b32 v216, 16, v216
  v_mul_f32 v6, s79, v216
  v_exp_f32 v6, v6
  s_nop 0
  v_add_f32 v6, 1.0, v6
  v_rcp_f32 v6, v6
  s_nop 0
  v_mul_f32 v216, v216, v6
  v_cvt_pk_bf16_f32 v217, v217, v217
  v_lshlrev_b32 v217, 16, v217
  v_add_f32 v217, v217, v109
  v_cvt_pk_bf16_f32 v217, v217, v217
  v_lshlrev_b32 v217, 16, v217
  v_mul_f32 v6, s79, v217
  v_exp_f32 v6, v6
  s_nop 0
  v_add_f32 v6, 1.0, v6
  v_rcp_f32 v6, v6
  s_nop 0
  v_mul_f32 v217, v217, v6
  v_cvt_pk_bf16_f32 v218, v218, v218
  v_lshlrev_b32 v218, 16, v218
  v_add_f32 v218, v218, v110
  v_cvt_pk_bf16_f32 v218, v218, v218
  v_lshlrev_b32 v218, 16, v218
  v_mul_f32 v6, s79, v218
  v_exp_f32 v6, v6
  s_nop 0
  v_add_f32 v6, 1.0, v6
  v_rcp_f32 v6, v6
  s_nop 0
  v_mul_f32 v218, v218, v6
  v_cvt_pk_bf16_f32 v219, v219, v219
  v_lshlrev_b32 v219, 16, v219
  v_add_f32 v219, v219, v111
  v_cvt_pk_bf16_f32 v219, v219, v219
  v_lshlrev_b32 v219, 16, v219
  v_mul_f32 v6, s79, v219
  v_exp_f32 v6, v6
  s_nop 0
  v_add_f32 v6, 1.0, v6
  v_rcp_f32 v6, v6
  s_nop 0
  v_mul_f32 v219, v219, v6
  v_cvt_pk_bf16_f32 v76, v216, v217
  v_cvt_pk_bf16_f32 v77, v218, v219
  v_cvt_pk_bf16_f32 v220, v220, v220
  v_lshlrev_b32 v220, 16, v220
  v_add_f32 v220, v220, v108
  v_cvt_pk_bf16_f32 v220, v220, v220
  v_lshlrev_b32 v220, 16, v220
  v_mul_f32 v6, s79, v220
  v_exp_f32 v6, v6
  s_nop 0
  v_add_f32 v6, 1.0, v6
  v_rcp_f32 v6, v6
  s_nop 0
  v_mul_f32 v220, v220, v6
  v_cvt_pk_bf16_f32 v221, v221, v221
  v_lshlrev_b32 v221, 16, v221
  v_add_f32 v221, v221, v109
  v_cvt_pk_bf16_f32 v221, v221, v221
  v_lshlrev_b32 v221, 16, v221
  v_mul_f32 v6, s79, v221
  v_exp_f32 v6, v6
  s_nop 0
  v_add_f32 v6, 1.0, v6
  v_rcp_f32 v6, v6
  s_nop 0
  v_mul_f32 v221, v221, v6
  v_cvt_pk_bf16_f32 v222, v222, v222
  v_lshlrev_b32 v222, 16, v222
  v_add_f32 v222, v222, v110
  v_cvt_pk_bf16_f32 v222, v222, v222
  v_lshlrev_b32 v222, 16, v222
  v_mul_f32 v6, s79, v222
  v_exp_f32 v6, v6
  s_nop 0
  v_add_f32 v6, 1.0, v6
  v_rcp_f32 v6, v6
  s_nop 0
  v_mul_f32 v222, v222, v6
  v_cvt_pk_bf16_f32 v223, v223, v223
  v_lshlrev_b32 v223, 16, v223
  v_add_f32 v223, v223, v111
  v_cvt_pk_bf16_f32 v223, v223, v223
  v_lshlrev_b32 v223, 16, v223
  v_mul_f32 v6, s79, v223
  v_exp_f32 v6, v6
  s_nop 0
  v_add_f32 v6, 1.0, v6
  v_rcp_f32 v6, v6
  s_nop 0
  v_mul_f32 v223, v223, v6
  v_cvt_pk_bf16_f32 v78, v220, v221
  v_cvt_pk_bf16_f32 v79, v222, v223
  buffer_store_dwordx4 v[76:79], v60, s[48:51], s75 offen offset:3072 sc1
mai_w_signal:
  s_cmp_ge_u32 s64, 1536
  s_cbranch_scc1 mai_w_sig2
mai_w_sig2:
  s_waitcnt vmcnt(0)
  s_barrier
  s_cmp_lg_u32 s56, 0
  s_cbranch_scc1 mai_sigw_47
  v_mov_b32 v2, s94
  s_mov_b64 exec, 1
  buffer_atomic_add v2, off, s[48:51], s76 sc1
  s_mov_b64 exec, -1
mai_sigw_47:
  s_cmp_ge_u32 s64, 1536
  s_cbranch_scc1 mai_w_next
  s_branch mai_w_next
mai_w_fill:
  s_mov_b32 s57, s95
  s_mul_i32 s57, s57, 81920
  s_add_u32 s57, s57, 7811072
  v_lshlrev_b32 v2, 4, v0
  v_mov_b32 v64, -1
  v_mov_b32 v65, -1
  v_mov_b32 v66, -1
  v_mov_b32 v67, -1
  s_mov_b32 s58, 0
mai_w_fill_l:
  buffer_store_dwordx4 v[64:67], v2, s[48:51], s57 offen sc1
  s_add_u32 s57, s57, 4096
  s_add_u32 s58, s58, 1
  s_cmp_lt_u32 s58, 20
  s_cbranch_scc1 mai_w_fill_l
  s_mov_b32 s76, 24576
  s_mov_b32 s64, 100000
  s_branch mai_w_signal
mai_w_ph3:
  s_sub_u32 s58, s64, 1744
  s_mul_hi_u32 s78, s58, 238609295
  s_mul_i32 s59, s78, 18
  s_sub_u32 s79, s58, s59
  s_cmp_ge_u32 s79, 8
  s_cbranch_scc1 mai_w_out
  s_lshr_b32 s81, s78, 2
  s_lshl_b32 s81, s81, 7
  s_add_u32 s82, s81, 2048
  s_cmp_lg_u32 s56, 0
  s_cbranch_scc1 mai_spindaq_49
  s_mov_b32 s58, 0
mai_spinaq_48:
  buffer_load_dword v2, off, s[48:51], s82 sc1
  s_waitcnt vmcnt(0)
  v_readfirstlane_b32 s57, v2
  s_cmp_ge_u32 s57, 32
  s_cbranch_scc1 mai_spindaq_49
  s_sleep 10
  s_add_u32 s58, s58, 1
  s_cmp_lt_u32 s58, 4194304
  s_cbranch_scc1 mai_spinaq_48
mai_spindaq_49:
  s_add_u32 s82, s81, 0
  s_cmp_lg_u32 s56, 0
  s_cbranch_scc1 mai_spindak_51
  s_mov_b32 s58, 0
mai_spinak_50:
  buffer_load_dword v2, off, s[48:51], s82 sc1
  s_waitcnt vmcnt(0)
  v_readfirstlane_b32 s57, v2
  s_cmp_ge_u32 s57, 320
  s_cbranch_scc1 mai_spindak_51
  s_sleep 10
  s_add_u32 s58, s58, 1
  s_cmp_lt_u32 s58, 4194304
  s_cbranch_scc1 mai_spinak_50
mai_spindak_51:
  s_barrier
  s_lshl_b32 s76, s78, 7
  s_add_u32 s76, s76, 16384
  s_lshl_b32 s77, s79, 2
  s_add_u32 s77, s77, s56
  v_lshrrev_b32 v2, 4, v1
  v_and_b32 v3, 15, v1
  v_lshlrev_b32 v6, 4, v1
  v_lshlrev_b32 v5, 3, v1
  v_lshrrev_b32 v8, 2, v3
  v_and_b32 v9, 3, v3
  v_lshl_add_u32 v4, v8, 3, v9
  s_mul_i32 s81, s78, 196608
  s_mul_i32 s57, s77, 6144
  s_add_u32 s81, s81, s57
  s_add_u32 s81, s81, 23539712
  s_mul_i32 s57, s78, 393216
  s_mul_i32 s58, s77, 12288
  s_add_u32 s57, s57, s58
  s_add_u32 s82, s57, 38744064
  s_add_u32 s83, s57, 63909888
  buffer_load_dwordx4 v[88:91], v6, s[48:51], s82 offen offset:0 sc1
  buffer_load_dwordx4 v[136:139], v6, s[48:51], s83 offen offset:0 sc1
  buffer_load_dwordx4 v[112:115], v6, s[48:51], s82 offen offset:1024 sc1
  buffer_load_dwordx4 v[160:163], v6, s[48:51], s83 offen offset:1024 sc1
  buffer_load_dwordx4 v[92:95], v6, s[48:51], s82 offen offset:2048 sc1
  buffer_load_dwordx4 v[140:143], v6, s[48:51], s83 offen offset:2048 sc1
  buffer_load_dwordx4 v[116:119], v6, s[48:51], s82 offen offset:3072 sc1
  buffer_load_dwordx4 v[164:167], v6, s[48:51], s83 offen offset:3072 sc1
  s_add_u32 s82, s82, 4096
  s_add_u32 s83, s83, 4096
  buffer_load_dwordx4 v[96:99], v6, s[48:51], s82 offen offset:0 sc1
  buffer_load_dwordx4 v[144:147], v6, s[48:51], s83 offen offset:0 sc1
  buffer_load_dwordx4 v[120:123], v6, s[48:51], s82 offen offset:1024 sc1
  buffer_load_dwordx4 v[168:171], v6, s[48:51], s83 offen offset:1024 sc1
  buffer_load_dwordx4 v[100:103], v6, s[48:51], s82 offen offset:2048 sc1
  buffer_load_dwordx4 v[148:151], v6, s[48:51], s83 offen offset:2048 sc1
  buffer_load_dwordx4 v[124:127], v6, s[48:51], s82 offen offset:3072 sc1
  buffer_load_dwordx4 v[172:175], v6, s[48:51], s83 offen offset:3072 sc1
  s_add_u32 s82, s82, 4096
  s_add_u32 s83, s83, 4096
  buffer_load_dwordx4 v[104:107], v6, s[48:51], s82 offen offset:0 sc1
  buffer_load_dwordx4 v[152:155], v6, s[48:51], s83 offen offset:0 sc1
  buffer_load_dwordx4 v[128:131], v6, s[48:51], s82 offen offset:1024 sc1
  buffer_load_dwordx4 v[176:179], v6, s[48:51], s83 offen offset:1024 sc1
  buffer_load_dwordx4 v[108:111], v6, s[48:51], s82 offen offset:2048 sc1
  buffer_load_dwordx4 v[156:159], v6, s[48:51], s83 offen offset:2048 sc1
  buffer_load_dwordx4 v[132:135], v6, s[48:51], s82 offen offset:3072 sc1
  buffer_load_dwordx4 v[180:183], v6, s[48:51], s83 offen offset:3072 sc1
  s_add_u32 s82, s82, 4096
  s_add_u32 s83, s83, 4096
  s_waitcnt vmcnt(20)
  v_mfma_f32_16x16x32_bf16 v[192:195], v[88:91], v[136:139], 0
  v_mfma_f32_16x16x32_bf16 v[200:203], v[112:115], v[136:139], 0
  v_mfma_f32_16x16x32_bf16 v[196:199], v[88:91], v[160:163], 0
  v_mfma_f32_16x16x32_bf16 v[204:207], v[112:115], v[160:163], 0
  s_waitcnt vmcnt(16)
  v_mfma_f32_16x16x32_bf16 v[192:195], v[92:95], v[140:143], v[192:195]
  v_mfma_f32_16x16x32_bf16 v[200:203], v[116:119], v[140:143], v[200:203]
  v_mfma_f32_16x16x32_bf16 v[196:199], v[92:95], v[164:167], v[196:199]
  v_mfma_f32_16x16x32_bf16 v[204:207], v[116:119], v[164:167], v[204:207]
  s_waitcnt vmcnt(12)
  v_mfma_f32_16x16x32_bf16 v[192:195], v[96:99], v[144:147], v[192:195]
  v_mfma_f32_16x16x32_bf16 v[200:203], v[120:123], v[144:147], v[200:203]
  v_mfma_f32_16x16x32_bf16 v[196:199], v[96:99], v[168:171], v[196:199]
  v_mfma_f32_16x16x32_bf16 v[204:207], v[120:123], v[168:171], v[204:207]
  s_waitcnt vmcnt(8)
  v_mfma_f32_16x16x32_bf16 v[192:195], v[100:103], v[148:151], v[192:195]
  v_mfma_f32_16x16x32_bf16 v[200:203], v[124:127], v[148:151], v[200:203]
  v_mfma_f32_16x16x32_bf16 v[196:199], v[100:103], v[172:175], v[196:199]
  v_mfma_f32_16x16x32_bf16 v[204:207], v[124:127], v[172:175], v[204:207]
  s_waitcnt vmcnt(4)
  v_mfma_f32_16x16x32_bf16 v[192:195], v[104:107], v[152:155], v[192:195]
  v_mfma_f32_16x16x32_bf16 v[200:203], v[128:131], v[152:155], v[200:203]
  v_mfma_f32_16x16x32_bf16 v[196:199], v[104:107], v[176:179], v[196:199]
  v_mfma_f32_16x16x32_bf16 v[204:207], v[128:131], v[176:179], v[204:207]
  s_waitcnt vmcnt(0)
  v_mfma_f32_16x16x32_bf16 v[192:195], v[108:111], v[156:159], v[192:195]
  v_mfma_f32_16x16x32_bf16 v[200:203], v[132:135], v[156:159], v[200:203]
  v_mfma_f32_16x16x32_bf16 v[196:199], v[108:111], v[180:183], v[196:199]
  v_mfma_f32_16x16x32_bf16 v[204:207], v[132:135], v[180:183], v[204:207]
  s_lshl_b32 s82, s78, 13
  s_add_u32 s82, s82, 65536
  v_lshlrev_b32 v11, 7, v1
  s_mov_b32 s58, 0
  s_cmp_lg_u32 s56, 0
  s_cbranch_scc1 mai_w_recok
mai_w_recspin:
  buffer_load_dword v10, v11, s[48:51], s82 offen sc1
  s_waitcnt vmcnt(0)
  v_cmp_ne_u32 vcc, 1, v10
  s_cbranch_vccz mai_w_recok
  s_sleep 8
  s_add_u32 s58, s58, 1
  s_cmp_lt_u32 s58, 4194304
  s_cbranch_scc1 mai_w_recspin
mai_w_recok:
  s_barrier
  buffer_load_dwordx2 v[64:65], v5, s[48:51], s81 offen offset:0 sc1
  buffer_load_dwordx2 v[66:67], v5, s[48:51], s81 offen offset:512 sc1
  buffer_load_dwordx2 v[68:69], v5, s[48:51], s81 offen offset:1024 sc1
  buffer_load_dwordx2 v[70:71], v5, s[48:51], s81 offen offset:1536 sc1
  s_add_u32 s81, s81, 2048
  buffer_load_dwordx2 v[72:73], v5, s[48:51], s81 offen offset:0 sc1
  buffer_load_dwordx2 v[74:75], v5, s[48:51], s81 offen offset:512 sc1
  buffer_load_dwordx2 v[76:77], v5, s[48:51], s81 offen offset:1024 sc1
  buffer_load_dwordx2 v[78:79], v5, s[48:51], s81 offen offset:1536 sc1
  s_add_u32 s81, s81, 2048
  buffer_load_dwordx2 v[80:81], v5, s[48:51], s81 offen offset:0 sc1
  buffer_load_dwordx2 v[82:83], v5, s[48:51], s81 offen offset:512 sc1
  buffer_load_dwordx2 v[84:85], v5, s[48:51], s81 offen offset:1024 sc1
  buffer_load_dwordx2 v[86:87], v5, s[48:51], s81 offen offset:1536 sc1
  s_add_u32 s81, s81, 2048
  s_waitcnt vmcnt(10)
  v_mfma_f32_16x16x32_bf16 v[184:187], v[64:67], v[136:139], 0
  v_mfma_f32_16x16x32_bf16 v[188:191], v[64:67], v[160:163], 0
  s_waitcnt vmcnt(8)
  v_mfma_f32_16x16x32_bf16 v[184:187], v[68:71], v[140:143], v[184:187]
  v_mfma_f32_16x16x32_bf16 v[188:191], v[68:71], v[164:167], v[188:191]
  s_waitcnt vmcnt(6)
  v_mfma_f32_16x16x32_bf16 v[184:187], v[72:75], v[144:147], v[184:187]
  v_mfma_f32_16x16x32_bf16 v[188:191], v[72:75], v[168:171], v[188:191]
  s_waitcnt vmcnt(4)
  v_mfma_f32_16x16x32_bf16 v[184:187], v[76:79], v[148:151], v[184:187]
  v_mfma_f32_16x16x32_bf16 v[188:191], v[76:79], v[172:175], v[188:191]
  s_waitcnt vmcnt(2)
  v_mfma_f32_16x16x32_bf16 v[184:187], v[80:83], v[152:155], v[184:187]
  v_mfma_f32_16x16x32_bf16 v[188:191], v[80:83], v[176:179], v[188:191]
  s_waitcnt vmcnt(0)
  v_mfma_f32_16x16x32_bf16 v[184:187], v[84:87], v[156:159], v[184:187]
  v_mfma_f32_16x16x32_bf16 v[188:191], v[84:87], v[180:183], v[188:191]
  v_xor_b32 v10, 16, v1
  v_lshlrev_b32 v10, 2, v10
  v_xor_b32 v11, 32, v1
  v_lshlrev_b32 v11, 2, v11
  v_mov_b32 v12, 4286578688
  s_mov_b32 s59, 1037384597
  v_lshlrev_b32 v5, 4, v3
  v_lshl_add_u32 v5, v2, 3, v5
  s_mul_i32 s81, s78, 65536
  s_mul_i32 s57, s77, 2048
  s_add_u32 s81, s81, s57
  s_add_u32 s81, s81, 181874688
  s_mul_i32 s82, s78, 16384
  s_mul_i32 s57, s77, 512
  s_add_u32 s82, s82, s57
  s_add_u32 s82, s82, 186068992
  v_lshlrev_b32 v8, 3, v2
  v_sub_u32 v13, v4, v8
  v_cmp_gt_u32 vcc, 2, v2
  v_mul_f32 v184, s59, v184
  v_mul_f32 v185, s59, v185
  v_mul_f32 v186, s59, v186
  v_mul_f32 v187, s59, v187
  v_mul_f32 v192, s59, v192
  v_mul_f32 v193, s59, v193
  v_mul_f32 v194, s59, v194
  v_mul_f32 v195, s59, v195
  v_mul_f32 v200, s59, v200
  v_mul_f32 v201, s59, v201
  v_mul_f32 v202, s59, v202
  v_mul_f32 v203, s59, v203
  v_cndmask_b32 v184, v12, v184, vcc
  v_cndmask_b32 v185, v12, v185, vcc
  v_cndmask_b32 v186, v12, v186, vcc
  v_cndmask_b32 v187, v12, v187, vcc
  v_cmp_le_i32 vcc, 0, v13
  s_nop 1
  v_cndmask_b32 v192, v12, v192, vcc
  v_cmp_le_i32 vcc, 1, v13
  s_nop 1
  v_cndmask_b32 v193, v12, v193, vcc
  v_cmp_le_i32 vcc, 2, v13
  s_nop 1
  v_cndmask_b32 v194, v12, v194, vcc
  v_cmp_le_i32 vcc, 3, v13
  s_nop 1
  v_cndmask_b32 v195, v12, v195, vcc
  v_cmp_le_i32 vcc, 4, v13
  s_nop 1
  v_cndmask_b32 v200, v12, v200, vcc
  v_cmp_le_i32 vcc, 5, v13
  s_nop 1
  v_cndmask_b32 v201, v12, v201, vcc
  v_cmp_le_i32 vcc, 6, v13
  s_nop 1
  v_cndmask_b32 v202, v12, v202, vcc
  v_cmp_le_i32 vcc, 7, v13
  s_nop 1
  v_cndmask_b32 v203, v12, v203, vcc
  v_max3_f32 v14, v184, v185, v186
  v_max3_f32 v14, v14, v187, v192
  v_max3_f32 v14, v14, v193, v194
  v_max3_f32 v14, v14, v195, v200
  v_max3_f32 v14, v14, v201, v202
  v_max_f32 v14, v14, v203
  ds_bpermute_b32 v8, v10, v14
  s_waitcnt lgkmcnt(0)
  v_max_f32 v14, v14, v8
  ds_bpermute_b32 v8, v11, v14
  s_waitcnt lgkmcnt(0)
  v_max_f32 v14, v14, v8
  v_sub_f32 v184, v184, v14
  v_exp_f32 v184, v184
  v_sub_f32 v185, v185, v14
  v_exp_f32 v185, v185
  v_sub_f32 v186, v186, v14
  v_exp_f32 v186, v186
  v_sub_f32 v187, v187, v14
  v_exp_f32 v187, v187
  v_sub_f32 v192, v192, v14
  v_exp_f32 v192, v192
  v_sub_f32 v193, v193, v14
  v_exp_f32 v193, v193
  v_sub_f32 v194, v194, v14
  v_exp_f32 v194, v194
  v_sub_f32 v195, v195, v14
  v_exp_f32 v195, v195
  v_sub_f32 v200, v200, v14
  v_exp_f32 v200, v200
  v_sub_f32 v201, v201, v14
  v_exp_f32 v201, v201
  v_sub_f32 v202, v202, v14
  v_exp_f32 v202, v202
  v_sub_f32 v203, v203, v14
  v_exp_f32 v203, v203
  v_add_f32 v14, v184, v185
  v_add_f32 v14, v14, v186
  v_add_f32 v14, v14, v187
  v_add_f32 v14, v14, v192
  v_add_f32 v14, v14, v193
  v_add_f32 v14, v14, v194
  v_add_f32 v14, v14, v195
  v_add_f32 v14, v14, v200
  v_add_f32 v14, v14, v201
  v_add_f32 v14, v14, v202
  v_add_f32 v14, v14, v203
  ds_bpermute_b32 v8, v10, v14
  s_waitcnt lgkmcnt(0)
  v_add_f32 v14, v14, v8
  ds_bpermute_b32 v8, v11, v14
  s_waitcnt lgkmcnt(0)
  v_add_f32 v14, v14, v8
  v_rcp_f32 v14, v14
  s_nop 0
  v_mul_f32 v184, v184, v14
  v_mul_f32 v185, v185, v14
  v_mul_f32 v186, v186, v14
  v_mul_f32 v187, v187, v14
  v_mul_f32 v192, v192, v14
  v_mul_f32 v193, v193, v14
  v_mul_f32 v194, v194, v14
  v_mul_f32 v195, v195, v14
  v_mul_f32 v200, v200, v14
  v_mul_f32 v201, v201, v14
  v_mul_f32 v202, v202, v14
  v_mul_f32 v203, v203, v14
  v_cvt_pk_bf16_f32 v208, v192, v193
  v_cvt_pk_bf16_f32 v209, v194, v195
  v_cvt_pk_bf16_f32 v210, v200, v201
  v_cvt_pk_bf16_f32 v211, v202, v203
  v_cvt_pk_bf16_f32 v212, v184, v185
  v_cvt_pk_bf16_f32 v213, v186, v187
  buffer_store_dwordx4 v[208:211], v6, s[48:51], s81 offen offset:0 sc1
  s_mov_b32 s86, -1
  s_mov_b32 s87, 0
  s_mov_b64 exec, s[86:87]
  buffer_store_dwordx2 v[212:213], v5, s[48:51], s82 offen offset:0 sc1
  s_mov_b64 exec, -1
  v_lshlrev_b32 v8, 3, v2
  v_sub_u32 v13, v4, v8
  v_add_u32 v13, 4, v13
  v_cmp_gt_u32 vcc, 2, v2
  v_mul_f32 v188, s59, v188
  v_mul_f32 v189, s59, v189
  v_mul_f32 v190, s59, v190
  v_mul_f32 v191, s59, v191
  v_mul_f32 v196, s59, v196
  v_mul_f32 v197, s59, v197
  v_mul_f32 v198, s59, v198
  v_mul_f32 v199, s59, v199
  v_mul_f32 v204, s59, v204
  v_mul_f32 v205, s59, v205
  v_mul_f32 v206, s59, v206
  v_mul_f32 v207, s59, v207
  v_cndmask_b32 v188, v12, v188, vcc
  v_cndmask_b32 v189, v12, v189, vcc
  v_cndmask_b32 v190, v12, v190, vcc
  v_cndmask_b32 v191, v12, v191, vcc
  v_cmp_le_i32 vcc, 0, v13
  s_nop 1
  v_cndmask_b32 v196, v12, v196, vcc
  v_cmp_le_i32 vcc, 1, v13
  s_nop 1
  v_cndmask_b32 v197, v12, v197, vcc
  v_cmp_le_i32 vcc, 2, v13
  s_nop 1
  v_cndmask_b32 v198, v12, v198, vcc
  v_cmp_le_i32 vcc, 3, v13
  s_nop 1
  v_cndmask_b32 v199, v12, v199, vcc
  v_cmp_le_i32 vcc, 4, v13
  s_nop 1
  v_cndmask_b32 v204, v12, v204, vcc
  v_cmp_le_i32 vcc, 5, v13
  s_nop 1
  v_cndmask_b32 v205, v12, v205, vcc
  v_cmp_le_i32 vcc, 6, v13
  s_nop 1
  v_cndmask_b32 v206, v12, v206, vcc
  v_cmp_le_i32 vcc, 7, v13
  s_nop 1
  v_cndmask_b32 v207, v12, v207, vcc
  v_max3_f32 v14, v188, v189, v190
  v_max3_f32 v14, v14, v191, v196
  v_max3_f32 v14, v14, v197, v198
  v_max3_f32 v14, v14, v199, v204
  v_max3_f32 v14, v14, v205, v206
  v_max_f32 v14, v14, v207
  ds_bpermute_b32 v8, v10, v14
  s_waitcnt lgkmcnt(0)
  v_max_f32 v14, v14, v8
  ds_bpermute_b32 v8, v11, v14
  s_waitcnt lgkmcnt(0)
  v_max_f32 v14, v14, v8
  v_sub_f32 v188, v188, v14
  v_exp_f32 v188, v188
  v_sub_f32 v189, v189, v14
  v_exp_f32 v189, v189
  v_sub_f32 v190, v190, v14
  v_exp_f32 v190, v190
  v_sub_f32 v191, v191, v14
  v_exp_f32 v191, v191
  v_sub_f32 v196, v196, v14
  v_exp_f32 v196, v196
  v_sub_f32 v197, v197, v14
  v_exp_f32 v197, v197
  v_sub_f32 v198, v198, v14
  v_exp_f32 v198, v198
  v_sub_f32 v199, v199, v14
  v_exp_f32 v199, v199
  v_sub_f32 v204, v204, v14
  v_exp_f32 v204, v204
  v_sub_f32 v205, v205, v14
  v_exp_f32 v205, v205
  v_sub_f32 v206, v206, v14
  v_exp_f32 v206, v206
  v_sub_f32 v207, v207, v14
  v_exp_f32 v207, v207
  v_add_f32 v14, v188, v189
  v_add_f32 v14, v14, v190
  v_add_f32 v14, v14, v191
  v_add_f32 v14, v14, v196
  v_add_f32 v14, v14, v197
  v_add_f32 v14, v14, v198
  v_add_f32 v14, v14, v199
  v_add_f32 v14, v14, v204
  v_add_f32 v14, v14, v205
  v_add_f32 v14, v14, v206
  v_add_f32 v14, v14, v207
  ds_bpermute_b32 v8, v10, v14
  s_waitcnt lgkmcnt(0)
  v_add_f32 v14, v14, v8
  ds_bpermute_b32 v8, v11, v14
  s_waitcnt lgkmcnt(0)
  v_add_f32 v14, v14, v8
  v_rcp_f32 v14, v14
  s_nop 0
  v_mul_f32 v188, v188, v14
  v_mul_f32 v189, v189, v14
  v_mul_f32 v190, v190, v14
  v_mul_f32 v191, v191, v14
  v_mul_f32 v196, v196, v14
  v_mul_f32 v197, v197, v14
  v_mul_f32 v198, v198, v14
  v_mul_f32 v199, v199, v14
  v_mul_f32 v204, v204, v14
  v_mul_f32 v205, v205, v14
  v_mul_f32 v206, v206, v14
  v_mul_f32 v207, v207, v14
  v_cvt_pk_bf16_f32 v216, v196, v197
  v_cvt_pk_bf16_f32 v217, v198, v199
  v_cvt_pk_bf16_f32 v218, v204, v205
  v_cvt_pk_bf16_f32 v219, v206, v207
  v_cvt_pk_bf16_f32 v220, v188, v189
  v_cvt_pk_bf16_f32 v221, v190, v191
  buffer_store_dwordx4 v[216:219], v6, s[48:51], s81 offen offset:1024 sc1
  s_mov_b32 s86, -1
  s_mov_b32 s87, 0
  s_mov_b64 exec, s[86:87]
  buffer_store_dwordx2 v[220:221], v5, s[48:51], s82 offen offset:256 sc1
  s_mov_b64 exec, -1
  s_branch mai_w_signal
mai_w_out:
  s_sub_u32 s79, s79, 8
  s_lshr_b32 s81, s78, 2
  s_lshl_b32 s81, s81, 7
  s_add_u32 s82, s81, 6144
  s_cmp_lg_u32 s56, 0
  s_cbranch_scc1 mai_spindog_53
  s_mov_b32 s58, 0
mai_spinog_52:
  buffer_load_dword v2, off, s[48:51], s82 sc1
  s_waitcnt vmcnt(0)
  v_readfirstlane_b32 s57, v2
  s_cmp_ge_u32 s57, 5
  s_cbranch_scc1 mai_spindog_53
  s_sleep 10
  s_add_u32 s58, s58, 1
  s_cmp_lt_u32 s58, 4194304
  s_cbranch_scc1 mai_spinog_52
mai_spindog_53:
  s_add_u32 s82, s81, 0
  s_cmp_lg_u32 s56, 0
  s_cbranch_scc1 mai_spindok_55
  s_mov_b32 s58, 0
mai_spinok_54:
  buffer_load_dword v2, off, s[48:51], s82 sc1
  s_waitcnt vmcnt(0)
  v_readfirstlane_b32 s57, v2
  s_cmp_ge_u32 s57, 320
  s_cbranch_scc1 mai_spindok_55
  s_sleep 10
  s_add_u32 s58, s58, 1
  s_cmp_lt_u32 s58, 4194304
  s_cbranch_scc1 mai_spinok_54
mai_spindok_55:
  s_barrier
  v_lshrrev_b32 v2, 4, v1
  v_and_b32 v3, 15, v1
  s_lshl_b32 s74, s79, 6
  v_bfe_u32 v9, v1, 3, 1
  v_and_b32 v4, 7, v1
  v_mul_u32_u24 v5, 16384, v9
  v_lshl_add_u32 v5, v4, 6, v5
  v_lshl_add_u32 v5, v2, 4, v5
  v_lshlrev_b32 v6, 4, v1
  v_lshlrev_b32 v7, 12, v9
  v_lshl_add_u32 v7, v2, 7, v7
  v_lshl_add_u32 v7, v4, 4, v7
  v_lshlrev_b32 v8, 9, v2
  v_lshl_add_u32 v8, v3, 4, v8
  s_lshl_b32 s57, s79, 3
  s_mul_i32 s81, s78, 1310720
  s_mul_i32 s58, s57, 16384
  s_add_u32 s81, s81, s58
  s_lshl_b32 s58, s56, 12
  s_add_u32 s81, s81, s58
  s_add_u32 s81, s81, 89075712
  s_mul_i32 s82, s78, 65536
  s_lshl_b32 s58, s56, 14
  s_add_u32 s82, s82, s58
  s_add_u32 s82, s82, 181874688
  s_mul_i32 s83, s78, 327680
  s_lshl_b32 s58, s57, 12
  s_add_u32 s83, s83, s58
  s_lshl_b32 s58, s56, 10
  s_add_u32 s83, s83, s58
  s_add_u32 s83, s83, 2568192
  s_mul_i32 s84, s78, 16384
  s_lshl_b32 s58, s56, 12
  s_add_u32 s84, s84, s58
  s_add_u32 s84, s84, 186068992
  s_add_u32 s57, s81, 0
  buffer_load_dwordx4 v[64:67], v5, s[48:51], s57 offen offset:0 sc1
  s_add_u32 s57, s81, 32768
  buffer_load_dwordx4 v[68:71], v5, s[48:51], s57 offen offset:0 sc1
  s_add_u32 s57, s81, 65536
  buffer_load_dwordx4 v[72:75], v5, s[48:51], s57 offen offset:0 sc1
  s_add_u32 s57, s81, 98304
  buffer_load_dwordx4 v[76:79], v5, s[48:51], s57 offen offset:0 sc1
  s_add_u32 s57, s81, 0
  buffer_load_dwordx4 v[88:91], v5, s[48:51], s57 offen offset:512 sc1
  s_add_u32 s57, s81, 32768
  buffer_load_dwordx4 v[92:95], v5, s[48:51], s57 offen offset:512 sc1
  s_add_u32 s57, s81, 65536
  buffer_load_dwordx4 v[96:99], v5, s[48:51], s57 offen offset:512 sc1
  s_add_u32 s57, s81, 98304
  buffer_load_dwordx4 v[100:103], v5, s[48:51], s57 offen offset:512 sc1
  s_add_u32 s57, s81, 0
  buffer_load_dwordx4 v[112:115], v5, s[48:51], s57 offen offset:1024 sc1
  s_add_u32 s57, s81, 32768
  buffer_load_dwordx4 v[116:119], v5, s[48:51], s57 offen offset:1024 sc1
  s_add_u32 s57, s81, 65536
  buffer_load_dwordx4 v[120:123], v5, s[48:51], s57 offen offset:1024 sc1
  s_add_u32 s57, s81, 98304
  buffer_load_dwordx4 v[124:127], v5, s[48:51], s57 offen offset:1024 sc1
  s_add_u32 s57, s81, 0
  buffer_load_dwordx4 v[136:139], v5, s[48:51], s57 offen offset:1536 sc1
  s_add_u32 s57, s81, 32768
  buffer_load_dwordx4 v[140:143], v5, s[48:51], s57 offen offset:1536 sc1
  s_add_u32 s57, s81, 65536
  buffer_load_dwordx4 v[144:147], v5, s[48:51], s57 offen offset:1536 sc1
  s_add_u32 s57, s81, 98304
  buffer_load_dwordx4 v[148:151], v5, s[48:51], s57 offen offset:1536 sc1
  s_add_u32 s57, s81, 0
  buffer_load_dwordx4 v[160:163], v5, s[48:51], s57 offen offset:2048 sc1
  s_add_u32 s57, s81, 32768
  buffer_load_dwordx4 v[164:167], v5, s[48:51], s57 offen offset:2048 sc1
  s_add_u32 s57, s81, 65536
  buffer_load_dwordx4 v[168:171], v5, s[48:51], s57 offen offset:2048 sc1
  s_add_u32 s57, s81, 98304
  buffer_load_dwordx4 v[172:175], v5, s[48:51], s57 offen offset:2048 sc1
  s_add_u32 s57, s81, 0
  buffer_load_dwordx4 v[184:187], v5, s[48:51], s57 offen offset:2560 sc1
  s_add_u32 s57, s81, 32768
  buffer_load_dwordx4 v[188:191], v5, s[48:51], s57 offen offset:2560 sc1
  s_add_u32 s57, s81, 65536
  buffer_load_dwordx4 v[192:195], v5, s[48:51], s57 offen offset:2560 sc1
  s_add_u32 s57, s81, 98304
  buffer_load_dwordx4 v[196:199], v5, s[48:51], s57 offen offset:2560 sc1
  s_add_u32 s57, s81, 0
  buffer_load_dwordx4 v[208:211], v5, s[48:51], s57 offen offset:3072 sc1
  s_add_u32 s57, s81, 32768
  buffer_load_dwordx4 v[212:215], v5, s[48:51], s57 offen offset:3072 sc1
  s_add_u32 s57, s81, 65536
  buffer_load_dwordx4 v[216:219], v5, s[48:51], s57 offen offset:3072 sc1
  s_add_u32 s57, s81, 98304
  buffer_load_dwordx4 v[220:223], v5, s[48:51], s57 offen offset:3072 sc1
  s_add_u32 s57, s81, 0
  buffer_load_dwordx4 v[232:235], v5, s[48:51], s57 offen offset:3584 sc1
  s_add_u32 s57, s81, 32768
  buffer_load_dwordx4 v[236:239], v5, s[48:51], s57 offen offset:3584 sc1
  s_add_u32 s57, s81, 65536
  buffer_load_dwordx4 v[240:243], v5, s[48:51], s57 offen offset:3584 sc1
  s_add_u32 s57, s81, 98304
  buffer_load_dwordx4 v[244:247], v5, s[48:51], s57 offen offset:3584 sc1
  s_lshl_b32 s85, s78, 7
  s_add_u32 s85, s85, 16384
  s_cmp_lg_u32 s56, 0
  s_cbranch_scc1 mai_spindoa_57
  s_mov_b32 s58, 0
mai_spinoa_56:
  buffer_load_dword v10, off, s[48:51], s85 sc1
  s_waitcnt vmcnt(0)
  v_readfirstlane_b32 s57, v10
  s_cmp_ge_u32 s57, 8
  s_cbranch_scc1 mai_spindoa_57
  s_sleep 10
  s_add_u32 s58, s58, 1
  s_cmp_lt_u32 s58, 4194304
  s_cbranch_scc1 mai_spinoa_56
mai_spindoa_57:
  s_barrier
  buffer_load_dwordx4 v[80:83], v6, s[48:51], s82 offen offset:0 sc1
  buffer_load_dwordx4 v[84:87], v6, s[48:51], s82 offen offset:1024 sc1
  buffer_load_dwordx4 v[104:107], v6, s[48:51], s82 offen offset:2048 sc1
  buffer_load_dwordx4 v[108:111], v6, s[48:51], s82 offen offset:3072 sc1
  s_add_u32 s82, s82, 4096
  buffer_load_dwordx4 v[128:131], v6, s[48:51], s82 offen offset:0 sc1
  buffer_load_dwordx4 v[132:135], v6, s[48:51], s82 offen offset:1024 sc1
  buffer_load_dwordx4 v[152:155], v6, s[48:51], s82 offen offset:2048 sc1
  buffer_load_dwordx4 v[156:159], v6, s[48:51], s82 offen offset:3072 sc1
  s_add_u32 s82, s82, 4096
  buffer_load_dwordx4 v[176:179], v6, s[48:51], s82 offen offset:0 sc1
  buffer_load_dwordx4 v[180:183], v6, s[48:51], s82 offen offset:1024 sc1
  buffer_load_dwordx4 v[200:203], v6, s[48:51], s82 offen offset:2048 sc1
  buffer_load_dwordx4 v[204:207], v6, s[48:51], s82 offen offset:3072 sc1
  s_add_u32 s82, s82, 4096
  buffer_load_dwordx4 v[224:227], v6, s[48:51], s82 offen offset:0 sc1
  buffer_load_dwordx4 v[228:231], v6, s[48:51], s82 offen offset:1024 sc1
  buffer_load_dwordx4 v[248:251], v6, s[48:51], s82 offen offset:2048 sc1
  buffer_load_dwordx4 v[252:255], v6, s[48:51], s82 offen offset:3072 sc1
  s_add_u32 s82, s82, 4096
  buffer_load_dwordx4 a[16:19], v8, s[48:51], s84 offen offset:0 sc1
  buffer_load_dwordx4 a[20:23], v8, s[48:51], s84 offen offset:256 sc1
  s_add_u32 s57, s83, 0
  buffer_load_dwordx4 a[0:3], v7, s[48:51], s57 offen offset:0 sc1
  s_add_u32 s57, s83, 8192
  buffer_load_dwordx4 a[4:7], v7, s[48:51], s57 offen offset:0 sc1
  s_add_u32 s57, s83, 16384
  buffer_load_dwordx4 a[8:11], v7, s[48:51], s57 offen offset:0 sc1
  s_add_u32 s57, s83, 24576
  buffer_load_dwordx4 a[12:15], v7, s[48:51], s57 offen offset:0 sc1
  buffer_load_dwordx4 a[40:43], v8, s[48:51], s84 offen offset:2048 sc1
  buffer_load_dwordx4 a[44:47], v8, s[48:51], s84 offen offset:2304 sc1
  s_add_u32 s57, s83, 0
  buffer_load_dwordx4 a[24:27], v7, s[48:51], s57 offen offset:512 sc1
  s_add_u32 s57, s83, 8192
  buffer_load_dwordx4 a[28:31], v7, s[48:51], s57 offen offset:512 sc1
  s_add_u32 s57, s83, 16384
  buffer_load_dwordx4 a[32:35], v7, s[48:51], s57 offen offset:512 sc1
  s_add_u32 s57, s83, 24576
  buffer_load_dwordx4 a[36:39], v7, s[48:51], s57 offen offset:512 sc1
  s_waitcnt vmcnt(26)
  v_mfma_f32_16x16x32_bf16 v[32:35], v[64:67], v[80:83], 0
  v_mfma_f32_16x16x32_bf16 v[36:39], v[64:67], v[84:87], 0
  v_mfma_f32_16x16x32_bf16 v[40:43], v[68:71], v[80:83], 0
  v_mfma_f32_16x16x32_bf16 v[44:47], v[68:71], v[84:87], 0
  v_mfma_f32_16x16x32_bf16 v[48:51], v[72:75], v[80:83], 0
  v_mfma_f32_16x16x32_bf16 v[52:55], v[72:75], v[84:87], 0
  v_mfma_f32_16x16x32_bf16 v[56:59], v[76:79], v[80:83], 0
  v_mfma_f32_16x16x32_bf16 v[60:63], v[76:79], v[84:87], 0
  s_waitcnt vmcnt(24)
  v_mfma_f32_16x16x32_bf16 v[32:35], v[88:91], v[104:107], v[32:35]
  v_mfma_f32_16x16x32_bf16 v[36:39], v[88:91], v[108:111], v[36:39]
  v_mfma_f32_16x16x32_bf16 v[40:43], v[92:95], v[104:107], v[40:43]
  v_mfma_f32_16x16x32_bf16 v[44:47], v[92:95], v[108:111], v[44:47]
  v_mfma_f32_16x16x32_bf16 v[48:51], v[96:99], v[104:107], v[48:51]
  v_mfma_f32_16x16x32_bf16 v[52:55], v[96:99], v[108:111], v[52:55]
  v_mfma_f32_16x16x32_bf16 v[56:59], v[100:103], v[104:107], v[56:59]
  v_mfma_f32_16x16x32_bf16 v[60:63], v[100:103], v[108:111], v[60:63]
  s_waitcnt vmcnt(22)
  v_mfma_f32_16x16x32_bf16 v[32:35], v[112:115], v[128:131], v[32:35]
  v_mfma_f32_16x16x32_bf16 v[36:39], v[112:115], v[132:135], v[36:39]
  v_mfma_f32_16x16x32_bf16 v[40:43], v[116:119], v[128:131], v[40:43]
  v_mfma_f32_16x16x32_bf16 v[44:47], v[116:119], v[132:135], v[44:47]
  v_mfma_f32_16x16x32_bf16 v[48:51], v[120:123], v[128:131], v[48:51]
  v_mfma_f32_16x16x32_bf16 v[52:55], v[120:123], v[132:135], v[52:55]
  v_mfma_f32_16x16x32_bf16 v[56:59], v[124:127], v[128:131], v[56:59]
  v_mfma_f32_16x16x32_bf16 v[60:63], v[124:127], v[132:135], v[60:63]
  s_waitcnt vmcnt(20)
  v_mfma_f32_16x16x32_bf16 v[32:35], v[136:139], v[152:155], v[32:35]
  v_mfma_f32_16x16x32_bf16 v[36:39], v[136:139], v[156:159], v[36:39]
  v_mfma_f32_16x16x32_bf16 v[40:43], v[140:143], v[152:155], v[40:43]
  v_mfma_f32_16x16x32_bf16 v[44:47], v[140:143], v[156:159], v[44:47]
  v_mfma_f32_16x16x32_bf16 v[48:51], v[144:147], v[152:155], v[48:51]
  v_mfma_f32_16x16x32_bf16 v[52:55], v[144:147], v[156:159], v[52:55]
  v_mfma_f32_16x16x32_bf16 v[56:59], v[148:151], v[152:155], v[56:59]
  v_mfma_f32_16x16x32_bf16 v[60:63], v[148:151], v[156:159], v[60:63]
  s_waitcnt vmcnt(18)
  v_mfma_f32_16x16x32_bf16 v[32:35], v[160:163], v[176:179], v[32:35]
  v_mfma_f32_16x16x32_bf16 v[36:39], v[160:163], v[180:183], v[36:39]
  v_mfma_f32_16x16x32_bf16 v[40:43], v[164:167], v[176:179], v[40:43]
  v_mfma_f32_16x16x32_bf16 v[44:47], v[164:167], v[180:183], v[44:47]
  v_mfma_f32_16x16x32_bf16 v[48:51], v[168:171], v[176:179], v[48:51]
  v_mfma_f32_16x16x32_bf16 v[52:55], v[168:171], v[180:183], v[52:55]
  v_mfma_f32_16x16x32_bf16 v[56:59], v[172:175], v[176:179], v[56:59]
  v_mfma_f32_16x16x32_bf16 v[60:63], v[172:175], v[180:183], v[60:63]
  s_waitcnt vmcnt(16)
  v_mfma_f32_16x16x32_bf16 v[32:35], v[184:187], v[200:203], v[32:35]
  v_mfma_f32_16x16x32_bf16 v[36:39], v[184:187], v[204:207], v[36:39]
  v_mfma_f32_16x16x32_bf16 v[40:43], v[188:191], v[200:203], v[40:43]
  v_mfma_f32_16x16x32_bf16 v[44:47], v[188:191], v[204:207], v[44:47]
  v_mfma_f32_16x16x32_bf16 v[48:51], v[192:195], v[200:203], v[48:51]
  v_mfma_f32_16x16x32_bf16 v[52:55], v[192:195], v[204:207], v[52:55]
  v_mfma_f32_16x16x32_bf16 v[56:59], v[196:199], v[200:203], v[56:59]
  v_mfma_f32_16x16x32_bf16 v[60:63], v[196:199], v[204:207], v[60:63]
  s_waitcnt vmcnt(14)
  v_mfma_f32_16x16x32_bf16 v[32:35], v[208:211], v[224:227], v[32:35]
  v_mfma_f32_16x16x32_bf16 v[36:39], v[208:211], v[228:231], v[36:39]
  v_mfma_f32_16x16x32_bf16 v[40:43], v[212:215], v[224:227], v[40:43]
  v_mfma_f32_16x16x32_bf16 v[44:47], v[212:215], v[228:231], v[44:47]
  v_mfma_f32_16x16x32_bf16 v[48:51], v[216:219], v[224:227], v[48:51]
  v_mfma_f32_16x16x32_bf16 v[52:55], v[216:219], v[228:231], v[52:55]
  v_mfma_f32_16x16x32_bf16 v[56:59], v[220:223], v[224:227], v[56:59]
  v_mfma_f32_16x16x32_bf16 v[60:63], v[220:223], v[228:231], v[60:63]
  s_waitcnt vmcnt(12)
  v_mfma_f32_16x16x32_bf16 v[32:35], v[232:235], v[248:251], v[32:35]
  v_mfma_f32_16x16x32_bf16 v[36:39], v[232:235], v[252:255], v[36:39]
  v_mfma_f32_16x16x32_bf16 v[40:43], v[236:239], v[248:251], v[40:43]
  v_mfma_f32_16x16x32_bf16 v[44:47], v[236:239], v[252:255], v[44:47]
  v_mfma_f32_16x16x32_bf16 v[48:51], v[240:243], v[248:251], v[48:51]
  v_mfma_f32_16x16x32_bf16 v[52:55], v[240:243], v[252:255], v[52:55]
  v_mfma_f32_16x16x32_bf16 v[56:59], v[244:247], v[248:251], v[56:59]
  v_mfma_f32_16x16x32_bf16 v[60:63], v[244:247], v[252:255], v[60:63]
  s_waitcnt vmcnt(6)
  v_mfma_f32_16x16x32_bf16 v[32:35], a[0:3], a[16:19], v[32:35]
  v_mfma_f32_16x16x32_bf16 v[36:39], a[0:3], a[20:23], v[36:39]
  v_mfma_f32_16x16x32_bf16 v[40:43], a[4:7], a[16:19], v[40:43]
  v_mfma_f32_16x16x32_bf16 v[44:47], a[4:7], a[20:23], v[44:47]
  v_mfma_f32_16x16x32_bf16 v[48:51], a[8:11], a[16:19], v[48:51]
  v_mfma_f32_16x16x32_bf16 v[52:55], a[8:11], a[20:23], v[52:55]
  v_mfma_f32_16x16x32_bf16 v[56:59], a[12:15], a[16:19], v[56:59]
  v_mfma_f32_16x16x32_bf16 v[60:63], a[12:15], a[20:23], v[60:63]
  s_waitcnt vmcnt(0)
  v_mfma_f32_16x16x32_bf16 v[32:35], a[24:27], a[40:43], v[32:35]
  v_mfma_f32_16x16x32_bf16 v[36:39], a[24:27], a[44:47], v[36:39]
  v_mfma_f32_16x16x32_bf16 v[40:43], a[28:31], a[40:43], v[40:43]
  v_mfma_f32_16x16x32_bf16 v[44:47], a[28:31], a[44:47], v[44:47]
  v_mfma_f32_16x16x32_bf16 v[48:51], a[32:35], a[40:43], v[48:51]
  v_mfma_f32_16x16x32_bf16 v[52:55], a[32:35], a[44:47], v[52:55]
  v_mfma_f32_16x16x32_bf16 v[56:59], a[36:39], a[40:43], v[56:59]
  v_mfma_f32_16x16x32_bf16 v[60:63], a[36:39], a[44:47], v[60:63]
  v_lshrrev_b32 v9, 2, v3
  v_and_b32 v4, 3, v3
  v_lshl_add_u32 v9, v9, 3, v4
  v_mul_u32_u24 v5, 1280, v9
  v_lshl_add_u32 v5, v2, 3, v5
  s_lshl_b32 s58, s56, 4
  s_add_u32 s74, s74, s58
  s_mul_i32 s81, s78, 40960
  s_lshl_b32 s57, s74, 1
  s_add_u32 s81, s81, s57
  s_add_u32 s83, s81, 5120
  s_mul_i32 s82, s78, 40960
  s_lshl_b32 s57, s74, 6
  s_add_u32 s82, s82, s57
  s_add_u32 s82, s82, 179253248
  buffer_load_dwordx4 v[64:67], v6, s[48:51], s82 offen sc1
  buffer_load_dwordx2 v[72:73], v5, s[4:7], s81 offen
  buffer_load_dwordx2 v[74:75], v5, s[4:7], s83 offen
  s_lshl_b32 s57, s56, 13
  v_add_u32 v9, s57, v6
  ds_write_b128 v9, v[32:35] offset:0
  ds_write_b128 v9, v[36:39] offset:1024
  ds_write_b128 v9, v[40:43] offset:2048
  ds_write_b128 v9, v[44:47] offset:3072
  ds_write_b128 v9, v[48:51] offset:4096
  ds_write_b128 v9, v[52:55] offset:5120
  ds_write_b128 v9, v[56:59] offset:6144
  ds_write_b128 v9, v[60:63] offset:7168
  s_lshl_b32 s57, s56, 11
  v_add_u32 v9, s57, v6
  s_waitcnt lgkmcnt(0)
  s_barrier
  ds_read_b128 v[96:99], v9 offset:0
  ds_read_b128 v[100:103], v9 offset:8192
  ds_read_b128 v[104:107], v9 offset:16384
  ds_read_b128 v[108:111], v9 offset:24576
  ds_read_b128 v[112:115], v9 offset:1024
  ds_read_b128 v[116:119], v9 offset:9216
  ds_read_b128 v[120:123], v9 offset:17408
  ds_read_b128 v[124:127], v9 offset:25600
  s_waitcnt vmcnt(0) lgkmcnt(0)
  v_add_f32 v96, v96, v100
  v_add_f32 v10, v104, v108
  v_add_f32 v96, v96, v10
  v_cvt_pk_bf16_f32 v96, v96, v96
  v_lshlrev_b32 v96, 16, v96
  v_lshlrev_b32 v10, 16, v64
  v_lshlrev_b32 v11, 16, v72
  v_mul_f32 v96, v96, v10
  v_cvt_pk_bf16_f32 v96, v96, v96
  v_lshlrev_b32 v96, 16, v96
  v_add_f32 v96, v96, v11
  v_add_f32 v97, v97, v101
  v_add_f32 v10, v105, v109
  v_add_f32 v97, v97, v10
  v_cvt_pk_bf16_f32 v97, v97, v97
  v_lshlrev_b32 v97, 16, v97
  v_and_b32 v10, 4294901760, v64
  v_and_b32 v11, 4294901760, v72
  v_mul_f32 v97, v97, v10
  v_cvt_pk_bf16_f32 v97, v97, v97
  v_lshlrev_b32 v97, 16, v97
  v_add_f32 v97, v97, v11
  v_add_f32 v98, v98, v102
  v_add_f32 v10, v106, v110
  v_add_f32 v98, v98, v10
  v_cvt_pk_bf16_f32 v98, v98, v98
  v_lshlrev_b32 v98, 16, v98
  v_lshlrev_b32 v10, 16, v65
  v_lshlrev_b32 v11, 16, v73
  v_mul_f32 v98, v98, v10
  v_cvt_pk_bf16_f32 v98, v98, v98
  v_lshlrev_b32 v98, 16, v98
  v_add_f32 v98, v98, v11
  v_add_f32 v99, v99, v103
  v_add_f32 v10, v107, v111
  v_add_f32 v99, v99, v10
  v_cvt_pk_bf16_f32 v99, v99, v99
  v_lshlrev_b32 v99, 16, v99
  v_and_b32 v10, 4294901760, v65
  v_and_b32 v11, 4294901760, v73
  v_mul_f32 v99, v99, v10
  v_cvt_pk_bf16_f32 v99, v99, v99
  v_lshlrev_b32 v99, 16, v99
  v_add_f32 v99, v99, v11
  v_cvt_pk_bf16_f32 v80, v96, v97
  v_cvt_pk_bf16_f32 v81, v98, v99
  buffer_store_dwordx2 v[80:81], v5, s[44:47], s81 offen
  v_add_f32 v112, v112, v116
  v_add_f32 v10, v120, v124
  v_add_f32 v112, v112, v10
  v_cvt_pk_bf16_f32 v112, v112, v112
  v_lshlrev_b32 v112, 16, v112
  v_lshlrev_b32 v10, 16, v66
  v_lshlrev_b32 v11, 16, v74
  v_mul_f32 v112, v112, v10
  v_cvt_pk_bf16_f32 v112, v112, v112
  v_lshlrev_b32 v112, 16, v112
  v_add_f32 v112, v112, v11
  v_add_f32 v113, v113, v117
  v_add_f32 v10, v121, v125
  v_add_f32 v113, v113, v10
  v_cvt_pk_bf16_f32 v113, v113, v113
  v_lshlrev_b32 v113, 16, v113
  v_and_b32 v10, 4294901760, v66
  v_and_b32 v11, 4294901760, v74
  v_mul_f32 v113, v113, v10
  v_cvt_pk_bf16_f32 v113, v113, v113
  v_lshlrev_b32 v113, 16, v113
  v_add_f32 v113, v113, v11
  v_add_f32 v114, v114, v118
  v_add_f32 v10, v122, v126
  v_add_f32 v114, v114, v10
  v_cvt_pk_bf16_f32 v114, v114, v114
  v_lshlrev_b32 v114, 16, v114
  v_lshlrev_b32 v10, 16, v67
  v_lshlrev_b32 v11, 16, v75
  v_mul_f32 v114, v114, v10
  v_cvt_pk_bf16_f32 v114, v114, v114
  v_lshlrev_b32 v114, 16, v114
  v_add_f32 v114, v114, v11
  v_add_f32 v115, v115, v119
  v_add_f32 v10, v123, v127
  v_add_f32 v115, v115, v10
  v_cvt_pk_bf16_f32 v115, v115, v115
  v_lshlrev_b32 v115, 16, v115
  v_and_b32 v10, 4294901760, v67
  v_and_b32 v11, 4294901760, v75
  v_mul_f32 v115, v115, v10
  v_cvt_pk_bf16_f32 v115, v115, v115
  v_lshlrev_b32 v115, 16, v115
  v_add_f32 v115, v115, v11
  v_cvt_pk_bf16_f32 v82, v112, v113
  v_cvt_pk_bf16_f32 v83, v114, v115
  buffer_store_dwordx2 v[82:83], v5, s[44:47], s83 offen
  s_branch mai_w_next
mai_w_fin:
  s_branch mai_k_exit
mai_k_exit:
  s_endpgm
.section .rodata,"a"
.p2align 6
.amdhsa_kernel prep_kernel
  .amdhsa_next_free_vgpr 64
  .amdhsa_next_free_sgpr 102
  .amdhsa_accum_offset 64
  .amdhsa_group_segment_fixed_size 0
  .amdhsa_kernarg_size 120
  .amdhsa_user_sgpr_count 2
  .amdhsa_user_sgpr_kernarg_segment_ptr 1
  .amdhsa_system_sgpr_workgroup_id_x 1
.end_amdhsa_kernel
.text
.section .rodata,"a"
.p2align 6
.amdhsa_kernel main_kernel
  .amdhsa_next_free_vgpr 512
  .amdhsa_next_free_sgpr 102
  .amdhsa_accum_offset 256
  .amdhsa_group_segment_fixed_size 0
  .amdhsa_kernarg_size 120
  .amdhsa_user_sgpr_count 2
  .amdhsa_user_sgpr_kernarg_segment_ptr 1
  .amdhsa_system_sgpr_workgroup_id_x 1
.end_amdhsa_kernel
.text
```
